```python
import torch

def _softmax(x, axis=-1):
    return torch.softmax(x, dim=axis)

def _gelu(x):
    return torch.nn.functional.gelu(x, approximate='tanh')

def _silu(x):
    return torch.nn.functional.silu(x)

def _sigmoid(x):
    return torch.sigmoid(x)

def _layernorm(x, axis=-1, eps=1e-05):
    m = x.mean(dim=axis, keepdim=True)
    v = x.var(dim=axis, keepdim=True, unbiased=False)
    return (x - m) / torch.sqrt(v + eps)

def _scatter_add(tgt, idx, src, axis=0):
    return tgt.clone().index_add_(axis, idx, src)

def _segment_sum(src, seg, n):
    out = torch.zeros((n,) + src.shape[1:], dtype=src.dtype)
    return out.index_add_(0, seg, src)

def _pad(x, pw):
    flat = tuple((v for pair in reversed(pw) for v in pair))
    return torch.nn.functional.pad(x, flat)
kernel_name = 'adaLN_cond__mha_block__glu_gated_bilinear__prompt'

def setup_inputs():

    _w = lambda a: (lambda t: t.to(torch.bfloat16) if t.is_floating_point() else t)(torch.as_tensor(a))

    def _A_setup():
        B, S, D, H = (1, 2048, 1024, 32)
        return {'x': _w((lambda *s: torch.randn(*s, dtype=torch.bfloat16) * 0.05)(B, S, D)), 'wqkv': _w((lambda *s: torch.randn(*s, dtype=torch.bfloat16) * 0.05)(D, 3 * D)), 'wo': _w((lambda *s: torch.randn(*s, dtype=torch.bfloat16) * 0.05)(D, D))}
    _A_in = _A_setup()

    def _B_setup():
        B, S, D, F = (1, 2048, 1024, 3584)
        return {'x': _w((lambda *s: torch.randn(*s, dtype=torch.bfloat16) * 0.05)(B, S, D)), 'w_gate': _w((lambda *s: torch.randn(*s, dtype=torch.bfloat16) * 1.6)(D, F) * D ** (-0.5)), 'w_up': _w((lambda *s: torch.randn(*s, dtype=torch.bfloat16) * 1.6)(D, F) * D ** (-0.5)), 'w_down': _w((lambda *s: torch.randn(*s, dtype=torch.bfloat16) * 1.6)(F, D) * F ** (-0.5))}
    _B_in = _B_setup()
    return {'A_x': _A_in['x'], 'A_wqkv': _A_in['wqkv'], 'A_wo': _A_in['wo'], 'B_x': _B_in['x'], 'B_w_gate': _B_in['w_gate'], 'B_w_up': _B_in['w_up'], 'B_w_down': _B_in['w_down'], 'c': _w((lambda *s: torch.randn(*s, dtype=torch.bfloat16) * 0.2)(1, 1024) * 8.0), 'w_mod': _w((lambda *s: torch.randn(*s, dtype=torch.bfloat16) * 0.2)(1024, 6 * 1024) * 1024 ** (-0.5) * 8.0)}

def reference(A_x, A_wqkv, A_wo, B_x, B_w_gate, B_w_up, B_w_down, c, w_mod):

    def _A_ref(x, wqkv, wo):
        B, S, D = x.shape
        H = 32
        Dh = D // H
        qkv = (lambda x, *d: x.permute(*d))((x @ wqkv).reshape(B, S, 3, H, Dh), 2, 0, 3, 1, 4)
        q, k, v = (qkv[0], qkv[1], qkv[2])
        scores = torch.einsum('bhqd,bhkd->bhqk', q, k) * Dh ** (-0.5)
        p = _softmax(scores, axis=-1)
        o = torch.einsum('bhqk,bhkd->bhqd', p, v)
        return (lambda x, *d: x.permute(*d))(o, 0, 2, 1, 3).reshape(B, S, D) @ wo

    def _B_ref(x, w_gate, w_up, w_down):
        g = torch.einsum('bsd,df->bsf', x, w_gate)
        u = torch.einsum('bsd,df->bsf', x, w_up)
        h = g * u
        return torch.einsum('bsf,fd->bsd', h, w_down)
    x = A_x
    mod = (_silu(c) @ w_mod).reshape(c.shape[0], 6, 1, -1)
    sa, ca, ga, sb, cb, gb = (mod[:, 0].clone(), mod[:, 1].clone(), mod[:, 2].clone(), mod[:, 3].clone(), mod[:, 4].clone(), mod[:, 5].clone())
    h = _layernorm(x, axis=-1) * (1 + ca) + sa
    x = x + ga * _A_ref(h, A_wqkv, A_wo)
    h = _layernorm(x, axis=-1) * (1 + cb) + sb
    x = x + gb * _B_ref(h, B_w_gate, B_w_up, B_w_down)
    return x
```

```asm
; @launch kernel=mod_kernel grid=(192,1,1) block=(256,1,1) lds=16384
; @launch kernel=ln1_kernel grid=(512,1,1) block=(256,1,1) lds=0
; @launch kernel=qkv_kernel grid=(256,1,1) block=(512,1,1) lds=163840
; @launch kernel=attn_kernel grid=(256,1,1) block=(512,1,1) lds=98304
; @launch kernel=wo_kernel grid=(256,1,1) block=(512,1,1) lds=98304
; @launch kernel=ln2_kernel grid=(512,1,1) block=(256,1,1) lds=0
; @launch kernel=gateup_kernel grid=(256,1,1) block=(512,1,1) lds=147456
; @launch kernel=down_kernel grid=(256,1,1) block=(512,1,1) lds=98304
.amdgcn_target "amdgcn-amd-amdhsa--gfx950"
.text
.p2align 8
.globl mod_kernel
.type mod_kernel,@function
mod_kernel:
    s_cmp_ge_u32 s2, 192
    s_cbranch_scc1 mod_kernel_end
    s_load_dwordx16 s[16:31], s[0:1], 0
    s_load_dwordx8 s[32:39], s[0:1], 64
    s_and_b32 s3, s2, 7
    s_mul_i32 s3, s3, 24
    s_lshr_b32 s4, s2, 3
    s_add_u32 s3, s3, s4
    s_waitcnt lgkmcnt(0)
    s_add_u32 s40, s30, 0
    s_addc_u32 s41, s31, 0
    s_and_b32 s41, s41, 0xffff
    s_mov_b32 s42, 2048
    s_mov_b32 s43, 0x00020000
    s_add_u32 s44, s32, 0
    s_addc_u32 s45, s33, 0
    s_and_b32 s45, s45, 0xffff
    s_mov_b32 s46, 12582912
    s_mov_b32 s47, 0x00020000
    s_add_u32 s48, s38, 0
    s_addc_u32 s49, s39, 0
    s_and_b32 s49, s49, 0xffff
    s_mov_b32 s50, 24576
    s_mov_b32 s51, 0x00020000
    v_lshlrev_b32 v1, 3, v0
    buffer_load_dwordx2 v[2:3], v1, s[40:43], 0 offen
    v_lshrrev_b32 v4, 2, v0
    v_and_b32 v5, 3, v0
    s_mov_b32 s5, 12288
    v_mul_lo_u32 v6, v4, s5
    v_lshlrev_b32 v7, 4, v5
    v_add_u32 v6, v6, v7
    s_lshl_b32 s6, s3, 6
    s_add_u32 s7, s6, 0
    buffer_load_dwordx4 v[64:67], v6, s[44:47], s7 offen
    s_add_u32 s7, s6, 786432
    buffer_load_dwordx4 v[68:71], v6, s[44:47], s7 offen
    s_add_u32 s7, s6, 1572864
    buffer_load_dwordx4 v[72:75], v6, s[44:47], s7 offen
    s_add_u32 s7, s6, 2359296
    buffer_load_dwordx4 v[76:79], v6, s[44:47], s7 offen
    s_add_u32 s7, s6, 3145728
    buffer_load_dwordx4 v[80:83], v6, s[44:47], s7 offen
    s_add_u32 s7, s6, 3932160
    buffer_load_dwordx4 v[84:87], v6, s[44:47], s7 offen
    s_add_u32 s7, s6, 4718592
    buffer_load_dwordx4 v[88:91], v6, s[44:47], s7 offen
    s_add_u32 s7, s6, 5505024
    buffer_load_dwordx4 v[92:95], v6, s[44:47], s7 offen
    s_add_u32 s7, s6, 6291456
    buffer_load_dwordx4 v[96:99], v6, s[44:47], s7 offen
    s_add_u32 s7, s6, 7077888
    buffer_load_dwordx4 v[100:103], v6, s[44:47], s7 offen
    s_add_u32 s7, s6, 7864320
    buffer_load_dwordx4 v[104:107], v6, s[44:47], s7 offen
    s_add_u32 s7, s6, 8650752
    buffer_load_dwordx4 v[108:111], v6, s[44:47], s7 offen
    s_add_u32 s7, s6, 9437184
    buffer_load_dwordx4 v[112:115], v6, s[44:47], s7 offen
    s_add_u32 s7, s6, 10223616
    buffer_load_dwordx4 v[116:119], v6, s[44:47], s7 offen
    s_add_u32 s7, s6, 11010048
    buffer_load_dwordx4 v[120:123], v6, s[44:47], s7 offen
    s_add_u32 s7, s6, 11796480
    buffer_load_dwordx4 v[124:127], v6, s[44:47], s7 offen
    s_waitcnt vmcnt(16)
    v_lshlrev_b32 v8, 16, v2
    v_and_b32 v9, 0xffff0000, v2
    v_lshlrev_b32 v10, 16, v3
    v_and_b32 v11, 0xffff0000, v3
    s_mov_b32 s8, 0xbfb8aa3b
    v_mul_f32 v12, s8, v8
    v_mul_f32 v13, s8, v9
    v_mul_f32 v14, s8, v10
    v_mul_f32 v15, s8, v11
    v_exp_f32 v12, v12
    v_exp_f32 v13, v13
    v_exp_f32 v14, v14
    v_exp_f32 v15, v15
    v_add_f32 v12, 1.0, v12
    v_add_f32 v13, 1.0, v13
    v_add_f32 v14, 1.0, v14
    v_add_f32 v15, 1.0, v15
    v_rcp_f32 v12, v12
    v_rcp_f32 v13, v13
    v_rcp_f32 v14, v14
    v_rcp_f32 v15, v15
    v_mul_f32 v12, v8, v12
    v_mul_f32 v13, v9, v13
    v_mul_f32 v14, v10, v14
    v_mul_f32 v15, v11, v15
    v_cvt_pk_bf16_f32 v12, v12, v12
    v_and_b32 v12, 0xffff0000, v12
    v_cvt_pk_bf16_f32 v13, v13, v13
    v_and_b32 v13, 0xffff0000, v13
    v_cvt_pk_bf16_f32 v14, v14, v14
    v_and_b32 v14, 0xffff0000, v14
    v_cvt_pk_bf16_f32 v15, v15, v15
    v_and_b32 v15, 0xffff0000, v15
    v_lshlrev_b32 v16, 4, v0
    ds_write_b128 v16, v[12:15]
    s_waitcnt lgkmcnt(0)
    s_barrier
    v_lshlrev_b32 v17, 2, v4
    ds_read_b32 v24, v17
    ds_read_b32 v25, v17 offset:256
    ds_read_b32 v26, v17 offset:512
    ds_read_b32 v27, v17 offset:768
    ds_read_b32 v28, v17 offset:1024
    ds_read_b32 v29, v17 offset:1280
    ds_read_b32 v30, v17 offset:1536
    ds_read_b32 v31, v17 offset:1792
    ds_read_b32 v32, v17 offset:2048
    ds_read_b32 v33, v17 offset:2304
    ds_read_b32 v34, v17 offset:2560
    ds_read_b32 v35, v17 offset:2816
    ds_read_b32 v36, v17 offset:3072
    ds_read_b32 v37, v17 offset:3328
    ds_read_b32 v38, v17 offset:3584
    ds_read_b32 v39, v17 offset:3840
    v_mov_b32 v40, 0
    v_mov_b32 v41, 0
    v_mov_b32 v42, 0
    v_mov_b32 v43, 0
    v_mov_b32 v44, 0
    v_mov_b32 v45, 0
    v_mov_b32 v46, 0
    v_mov_b32 v47, 0
    s_waitcnt vmcnt(0) lgkmcnt(0)
    v_lshlrev_b32 v48, 16, v64
    v_and_b32 v49, 0xffff0000, v64
    v_fmac_f32 v40, v24, v48
    v_fmac_f32 v41, v24, v49
    v_lshlrev_b32 v48, 16, v65
    v_and_b32 v49, 0xffff0000, v65
    v_fmac_f32 v42, v24, v48
    v_fmac_f32 v43, v24, v49
    v_lshlrev_b32 v48, 16, v66
    v_and_b32 v49, 0xffff0000, v66
    v_fmac_f32 v44, v24, v48
    v_fmac_f32 v45, v24, v49
    v_lshlrev_b32 v48, 16, v67
    v_and_b32 v49, 0xffff0000, v67
    v_fmac_f32 v46, v24, v48
    v_fmac_f32 v47, v24, v49
    v_lshlrev_b32 v48, 16, v68
    v_and_b32 v49, 0xffff0000, v68
    v_fmac_f32 v40, v25, v48
    v_fmac_f32 v41, v25, v49
    v_lshlrev_b32 v48, 16, v69
    v_and_b32 v49, 0xffff0000, v69
    v_fmac_f32 v42, v25, v48
    v_fmac_f32 v43, v25, v49
    v_lshlrev_b32 v48, 16, v70
    v_and_b32 v49, 0xffff0000, v70
    v_fmac_f32 v44, v25, v48
    v_fmac_f32 v45, v25, v49
    v_lshlrev_b32 v48, 16, v71
    v_and_b32 v49, 0xffff0000, v71
    v_fmac_f32 v46, v25, v48
    v_fmac_f32 v47, v25, v49
    v_lshlrev_b32 v48, 16, v72
    v_and_b32 v49, 0xffff0000, v72
    v_fmac_f32 v40, v26, v48
    v_fmac_f32 v41, v26, v49
    v_lshlrev_b32 v48, 16, v73
    v_and_b32 v49, 0xffff0000, v73
    v_fmac_f32 v42, v26, v48
    v_fmac_f32 v43, v26, v49
    v_lshlrev_b32 v48, 16, v74
    v_and_b32 v49, 0xffff0000, v74
    v_fmac_f32 v44, v26, v48
    v_fmac_f32 v45, v26, v49
    v_lshlrev_b32 v48, 16, v75
    v_and_b32 v49, 0xffff0000, v75
    v_fmac_f32 v46, v26, v48
    v_fmac_f32 v47, v26, v49
    v_lshlrev_b32 v48, 16, v76
    v_and_b32 v49, 0xffff0000, v76
    v_fmac_f32 v40, v27, v48
    v_fmac_f32 v41, v27, v49
    v_lshlrev_b32 v48, 16, v77
    v_and_b32 v49, 0xffff0000, v77
    v_fmac_f32 v42, v27, v48
    v_fmac_f32 v43, v27, v49
    v_lshlrev_b32 v48, 16, v78
    v_and_b32 v49, 0xffff0000, v78
    v_fmac_f32 v44, v27, v48
    v_fmac_f32 v45, v27, v49
    v_lshlrev_b32 v48, 16, v79
    v_and_b32 v49, 0xffff0000, v79
    v_fmac_f32 v46, v27, v48
    v_fmac_f32 v47, v27, v49
    v_lshlrev_b32 v48, 16, v80
    v_and_b32 v49, 0xffff0000, v80
    v_fmac_f32 v40, v28, v48
    v_fmac_f32 v41, v28, v49
    v_lshlrev_b32 v48, 16, v81
    v_and_b32 v49, 0xffff0000, v81
    v_fmac_f32 v42, v28, v48
    v_fmac_f32 v43, v28, v49
    v_lshlrev_b32 v48, 16, v82
    v_and_b32 v49, 0xffff0000, v82
    v_fmac_f32 v44, v28, v48
    v_fmac_f32 v45, v28, v49
    v_lshlrev_b32 v48, 16, v83
    v_and_b32 v49, 0xffff0000, v83
    v_fmac_f32 v46, v28, v48
    v_fmac_f32 v47, v28, v49
    v_lshlrev_b32 v48, 16, v84
    v_and_b32 v49, 0xffff0000, v84
    v_fmac_f32 v40, v29, v48
    v_fmac_f32 v41, v29, v49
    v_lshlrev_b32 v48, 16, v85
    v_and_b32 v49, 0xffff0000, v85
    v_fmac_f32 v42, v29, v48
    v_fmac_f32 v43, v29, v49
    v_lshlrev_b32 v48, 16, v86
    v_and_b32 v49, 0xffff0000, v86
    v_fmac_f32 v44, v29, v48
    v_fmac_f32 v45, v29, v49
    v_lshlrev_b32 v48, 16, v87
    v_and_b32 v49, 0xffff0000, v87
    v_fmac_f32 v46, v29, v48
    v_fmac_f32 v47, v29, v49
    v_lshlrev_b32 v48, 16, v88
    v_and_b32 v49, 0xffff0000, v88
    v_fmac_f32 v40, v30, v48
    v_fmac_f32 v41, v30, v49
    v_lshlrev_b32 v48, 16, v89
    v_and_b32 v49, 0xffff0000, v89
    v_fmac_f32 v42, v30, v48
    v_fmac_f32 v43, v30, v49
    v_lshlrev_b32 v48, 16, v90
    v_and_b32 v49, 0xffff0000, v90
    v_fmac_f32 v44, v30, v48
    v_fmac_f32 v45, v30, v49
    v_lshlrev_b32 v48, 16, v91
    v_and_b32 v49, 0xffff0000, v91
    v_fmac_f32 v46, v30, v48
    v_fmac_f32 v47, v30, v49
    v_lshlrev_b32 v48, 16, v92
    v_and_b32 v49, 0xffff0000, v92
    v_fmac_f32 v40, v31, v48
    v_fmac_f32 v41, v31, v49
    v_lshlrev_b32 v48, 16, v93
    v_and_b32 v49, 0xffff0000, v93
    v_fmac_f32 v42, v31, v48
    v_fmac_f32 v43, v31, v49
    v_lshlrev_b32 v48, 16, v94
    v_and_b32 v49, 0xffff0000, v94
    v_fmac_f32 v44, v31, v48
    v_fmac_f32 v45, v31, v49
    v_lshlrev_b32 v48, 16, v95
    v_and_b32 v49, 0xffff0000, v95
    v_fmac_f32 v46, v31, v48
    v_fmac_f32 v47, v31, v49
    v_lshlrev_b32 v48, 16, v96
    v_and_b32 v49, 0xffff0000, v96
    v_fmac_f32 v40, v32, v48
    v_fmac_f32 v41, v32, v49
    v_lshlrev_b32 v48, 16, v97
    v_and_b32 v49, 0xffff0000, v97
    v_fmac_f32 v42, v32, v48
    v_fmac_f32 v43, v32, v49
    v_lshlrev_b32 v48, 16, v98
    v_and_b32 v49, 0xffff0000, v98
    v_fmac_f32 v44, v32, v48
    v_fmac_f32 v45, v32, v49
    v_lshlrev_b32 v48, 16, v99
    v_and_b32 v49, 0xffff0000, v99
    v_fmac_f32 v46, v32, v48
    v_fmac_f32 v47, v32, v49
    v_lshlrev_b32 v48, 16, v100
    v_and_b32 v49, 0xffff0000, v100
    v_fmac_f32 v40, v33, v48
    v_fmac_f32 v41, v33, v49
    v_lshlrev_b32 v48, 16, v101
    v_and_b32 v49, 0xffff0000, v101
    v_fmac_f32 v42, v33, v48
    v_fmac_f32 v43, v33, v49
    v_lshlrev_b32 v48, 16, v102
    v_and_b32 v49, 0xffff0000, v102
    v_fmac_f32 v44, v33, v48
    v_fmac_f32 v45, v33, v49
    v_lshlrev_b32 v48, 16, v103
    v_and_b32 v49, 0xffff0000, v103
    v_fmac_f32 v46, v33, v48
    v_fmac_f32 v47, v33, v49
    v_lshlrev_b32 v48, 16, v104
    v_and_b32 v49, 0xffff0000, v104
    v_fmac_f32 v40, v34, v48
    v_fmac_f32 v41, v34, v49
    v_lshlrev_b32 v48, 16, v105
    v_and_b32 v49, 0xffff0000, v105
    v_fmac_f32 v42, v34, v48
    v_fmac_f32 v43, v34, v49
    v_lshlrev_b32 v48, 16, v106
    v_and_b32 v49, 0xffff0000, v106
    v_fmac_f32 v44, v34, v48
    v_fmac_f32 v45, v34, v49
    v_lshlrev_b32 v48, 16, v107
    v_and_b32 v49, 0xffff0000, v107
    v_fmac_f32 v46, v34, v48
    v_fmac_f32 v47, v34, v49
    v_lshlrev_b32 v48, 16, v108
    v_and_b32 v49, 0xffff0000, v108
    v_fmac_f32 v40, v35, v48
    v_fmac_f32 v41, v35, v49
    v_lshlrev_b32 v48, 16, v109
    v_and_b32 v49, 0xffff0000, v109
    v_fmac_f32 v42, v35, v48
    v_fmac_f32 v43, v35, v49
    v_lshlrev_b32 v48, 16, v110
    v_and_b32 v49, 0xffff0000, v110
    v_fmac_f32 v44, v35, v48
    v_fmac_f32 v45, v35, v49
    v_lshlrev_b32 v48, 16, v111
    v_and_b32 v49, 0xffff0000, v111
    v_fmac_f32 v46, v35, v48
    v_fmac_f32 v47, v35, v49
    v_lshlrev_b32 v48, 16, v112
    v_and_b32 v49, 0xffff0000, v112
    v_fmac_f32 v40, v36, v48
    v_fmac_f32 v41, v36, v49
    v_lshlrev_b32 v48, 16, v113
    v_and_b32 v49, 0xffff0000, v113
    v_fmac_f32 v42, v36, v48
    v_fmac_f32 v43, v36, v49
    v_lshlrev_b32 v48, 16, v114
    v_and_b32 v49, 0xffff0000, v114
    v_fmac_f32 v44, v36, v48
    v_fmac_f32 v45, v36, v49
    v_lshlrev_b32 v48, 16, v115
    v_and_b32 v49, 0xffff0000, v115
    v_fmac_f32 v46, v36, v48
    v_fmac_f32 v47, v36, v49
    v_lshlrev_b32 v48, 16, v116
    v_and_b32 v49, 0xffff0000, v116
    v_fmac_f32 v40, v37, v48
    v_fmac_f32 v41, v37, v49
    v_lshlrev_b32 v48, 16, v117
    v_and_b32 v49, 0xffff0000, v117
    v_fmac_f32 v42, v37, v48
    v_fmac_f32 v43, v37, v49
    v_lshlrev_b32 v48, 16, v118
    v_and_b32 v49, 0xffff0000, v118
    v_fmac_f32 v44, v37, v48
    v_fmac_f32 v45, v37, v49
    v_lshlrev_b32 v48, 16, v119
    v_and_b32 v49, 0xffff0000, v119
    v_fmac_f32 v46, v37, v48
    v_fmac_f32 v47, v37, v49
    v_lshlrev_b32 v48, 16, v120
    v_and_b32 v49, 0xffff0000, v120
    v_fmac_f32 v40, v38, v48
    v_fmac_f32 v41, v38, v49
    v_lshlrev_b32 v48, 16, v121
    v_and_b32 v49, 0xffff0000, v121
    v_fmac_f32 v42, v38, v48
    v_fmac_f32 v43, v38, v49
    v_lshlrev_b32 v48, 16, v122
    v_and_b32 v49, 0xffff0000, v122
    v_fmac_f32 v44, v38, v48
    v_fmac_f32 v45, v38, v49
    v_lshlrev_b32 v48, 16, v123
    v_and_b32 v49, 0xffff0000, v123
    v_fmac_f32 v46, v38, v48
    v_fmac_f32 v47, v38, v49
    v_lshlrev_b32 v48, 16, v124
    v_and_b32 v49, 0xffff0000, v124
    v_fmac_f32 v40, v39, v48
    v_fmac_f32 v41, v39, v49
    v_lshlrev_b32 v48, 16, v125
    v_and_b32 v49, 0xffff0000, v125
    v_fmac_f32 v42, v39, v48
    v_fmac_f32 v43, v39, v49
    v_lshlrev_b32 v48, 16, v126
    v_and_b32 v49, 0xffff0000, v126
    v_fmac_f32 v44, v39, v48
    v_fmac_f32 v45, v39, v49
    v_lshlrev_b32 v48, 16, v127
    v_and_b32 v49, 0xffff0000, v127
    v_fmac_f32 v46, v39, v48
    v_fmac_f32 v47, v39, v49
    v_lshlrev_b32 v18, 5, v0
    ds_write_b128 v18, v[40:43] offset:4096
    ds_write_b128 v18, v[44:47] offset:4112
    s_waitcnt lgkmcnt(0)
    s_barrier
    v_and_b32 v19, 31, v0
    v_lshrrev_b32 v20, 5, v0
    v_lshlrev_b32 v21, 10, v20
    v_lshl_add_u32 v21, v19, 2, v21
    ds_read_b32 v24, v21 offset:4096
    ds_read_b32 v25, v21 offset:4224
    ds_read_b32 v26, v21 offset:4352
    ds_read_b32 v27, v21 offset:4480
    ds_read_b32 v28, v21 offset:4608
    ds_read_b32 v29, v21 offset:4736
    ds_read_b32 v30, v21 offset:4864
    ds_read_b32 v31, v21 offset:4992
    s_waitcnt lgkmcnt(0)
    v_add_f32 v24, v24, v25
    v_add_f32 v24, v24, v26
    v_add_f32 v24, v24, v27
    v_add_f32 v24, v24, v28
    v_add_f32 v24, v24, v29
    v_add_f32 v24, v24, v30
    v_add_f32 v24, v24, v31
    v_lshlrev_b32 v22, 2, v0
    ds_write_b32 v22, v24 offset:12288
    s_waitcnt lgkmcnt(0)
    s_barrier
    v_lshlrev_b32 v22, 2, v19
    ds_read_b32 v24, v22 offset:12288
    ds_read_b32 v25, v22 offset:12416
    ds_read_b32 v26, v22 offset:12544
    ds_read_b32 v27, v22 offset:12672
    ds_read_b32 v28, v22 offset:12800
    ds_read_b32 v29, v22 offset:12928
    ds_read_b32 v30, v22 offset:13056
    ds_read_b32 v31, v22 offset:13184
    s_waitcnt lgkmcnt(0)
    v_add_f32 v24, v24, v25
    v_add_f32 v24, v24, v26
    v_add_f32 v24, v24, v27
    v_add_f32 v24, v24, v28
    v_add_f32 v24, v24, v29
    v_add_f32 v24, v24, v30
    v_add_f32 v24, v24, v31
    v_cvt_pk_bf16_f32 v24, v24, v24
    v_and_b32 v24, 0xffff0000, v24
    s_lshr_b32 s9, s3, 5
    s_cmp_eq_u32 s9, 1
    s_cbranch_scc1 mod_plus1
    s_cmp_eq_u32 s9, 4
    s_cbranch_scc0 mod_store
mod_plus1:
    s_nop 1
    v_add_f32 v24, 1.0, v24
    v_cvt_pk_bf16_f32 v24, v24, v24
    v_and_b32 v24, 0xffff0000, v24
mod_store:
    s_nop 1
    v_cmp_gt_u32 vcc, 32, v0
    s_and_saveexec_b64 s[10:11], vcc
    s_cbranch_execz mod_kernel_end
    s_lshl_b32 s9, s3, 7
    v_lshlrev_b32 v22, 2, v0
    buffer_store_dword v24, v22, s[48:51], s9 offen
mod_kernel_end:
    s_endpgm
.p2align 8
.globl ln1_kernel
.type ln1_kernel,@function
ln1_kernel:
    s_cmp_ge_u32 s2, 512
    s_cbranch_scc1 ln1_kernel_end
    s_load_dwordx16 s[16:31], s[0:1], 0
    s_load_dwordx8 s[32:39], s[0:1], 64
    v_lshrrev_b32 v1, 6, v0
    v_and_b32 v2, 63, v0
    s_lshl_b32 s3, s2, 2
    v_add_u32 v1, s3, v1
    v_lshlrev_b32 v3, 11, v1
    v_lshl_add_u32 v3, v2, 4, v3
    v_lshlrev_b32 v4, 5, v2
    s_waitcnt lgkmcnt(0)
    s_add_u32 s40, s16, 0
    s_addc_u32 s41, s17, 0
    s_and_b32 s41, s41, 0xffff
    s_mov_b32 s42, 4194304
    s_mov_b32 s43, 0x00020000
    s_add_u32 s44, s38, 1048576
    s_addc_u32 s45, s39, 0
    s_and_b32 s45, s45, 0xffff
    s_mov_b32 s46, 4194304
    s_mov_b32 s47, 0x00020000
    s_add_u32 s48, s38, 0
    s_addc_u32 s49, s39, 0
    s_and_b32 s49, s49, 0xffff
    s_mov_b32 s50, 24576
    s_mov_b32 s51, 0x00020000
    buffer_load_dwordx4 v[8:11], v3, s[40:43], 0 offen
    buffer_load_dwordx4 v[12:15], v3, s[40:43], 0 offen offset:1024
    s_mov_b32 s4, 4096
    s_mov_b32 s5, 0
    buffer_load_dwordx4 v[64:67], v4, s[48:51], s4 offen
    buffer_load_dwordx4 v[68:71], v4, s[48:51], s4 offen offset:16
    buffer_load_dwordx4 v[72:75], v4, s[48:51], s4 offen offset:2048
    buffer_load_dwordx4 v[76:79], v4, s[48:51], s4 offen offset:2064
    buffer_load_dwordx4 v[80:83], v4, s[48:51], s5 offen
    buffer_load_dwordx4 v[84:87], v4, s[48:51], s5 offen offset:16
    buffer_load_dwordx4 v[88:91], v4, s[48:51], s5 offen offset:2048
    buffer_load_dwordx4 v[92:95], v4, s[48:51], s5 offen offset:2064
    v_lshrrev_b32 v40, 6, v0
    s_nop 0
    v_readfirstlane_b32 s78, v40
    s_lshl_b32 s79, s2, 2
    s_add_u32 s78, s78, s79
    s_add_u32 s52, s18, 0
    s_addc_u32 s53, s19, 0
    s_and_b32 s53, s53, 0xffff
    s_mov_b32 s54, 6291456
    s_mov_b32 s55, 0x00020000
    s_mul_i32 s77, s78, 3072
    v_lshlrev_b32 v40, 7, v2
    v_add_u32 v40, s77, v40
    v_cmp_gt_u32 vcc, 24, v2
    v_mov_b32 v41, 0x7f000000
    s_nop 0
    v_cndmask_b32 v40, v41, v40, vcc
    buffer_load_dword v42, v40, s[52:55], 0 offen
    s_waitcnt vmcnt(9)
    v_lshlrev_b32 v16, 16, v8
    v_and_b32 v17, 0xffff0000, v8
    v_lshlrev_b32 v18, 16, v9
    v_and_b32 v19, 0xffff0000, v9
    v_lshlrev_b32 v20, 16, v10
    v_and_b32 v21, 0xffff0000, v10
    v_lshlrev_b32 v22, 16, v11
    v_and_b32 v23, 0xffff0000, v11
    v_lshlrev_b32 v24, 16, v12
    v_and_b32 v25, 0xffff0000, v12
    v_lshlrev_b32 v26, 16, v13
    v_and_b32 v27, 0xffff0000, v13
    v_lshlrev_b32 v28, 16, v14
    v_and_b32 v29, 0xffff0000, v14
    v_lshlrev_b32 v30, 16, v15
    v_and_b32 v31, 0xffff0000, v15
    v_add_f32 v32, v16, v17
    v_add_f32 v32, v32, v18
    v_add_f32 v32, v32, v19
    v_add_f32 v32, v32, v20
    v_add_f32 v32, v32, v21
    v_add_f32 v32, v32, v22
    v_add_f32 v32, v32, v23
    v_add_f32 v32, v32, v24
    v_add_f32 v32, v32, v25
    v_add_f32 v32, v32, v26
    v_add_f32 v32, v32, v27
    v_add_f32 v32, v32, v28
    v_add_f32 v32, v32, v29
    v_add_f32 v32, v32, v30
    v_add_f32 v32, v32, v31
    s_nop 1
    v_add_f32 v33, v32, v32 quad_perm:[1,0,3,2] row_mask:0xf bank_mask:0xf
    s_nop 1
    v_add_f32 v32, v33, v33 quad_perm:[2,3,0,1] row_mask:0xf bank_mask:0xf
    s_nop 1
    v_add_f32 v33, v32, v32 row_half_mirror row_mask:0xf bank_mask:0xf
    s_nop 1
    v_add_f32 v32, v33, v33 row_mirror row_mask:0xf bank_mask:0xf
    s_nop 0
    v_readlane_b32 s8, v32, 0
    v_readlane_b32 s9, v32, 16
    v_readlane_b32 s10, v32, 32
    v_readlane_b32 s11, v32, 48
    v_mov_b32 v32, s8
    v_add_f32 v32, s9, v32
    v_add_f32 v32, s10, v32
    v_add_f32 v32, s11, v32
    v_mul_f32 v32, 0x3a800000, v32
    v_sub_f32 v34, v16, v32
    v_mul_f32 v35, v34, v34
    v_sub_f32 v34, v17, v32
    v_fmac_f32 v35, v34, v34
    v_sub_f32 v34, v18, v32
    v_fmac_f32 v35, v34, v34
    v_sub_f32 v34, v19, v32
    v_fmac_f32 v35, v34, v34
    v_sub_f32 v34, v20, v32
    v_fmac_f32 v35, v34, v34
    v_sub_f32 v34, v21, v32
    v_fmac_f32 v35, v34, v34
    v_sub_f32 v34, v22, v32
    v_fmac_f32 v35, v34, v34
    v_sub_f32 v34, v23, v32
    v_fmac_f32 v35, v34, v34
    v_sub_f32 v34, v24, v32
    v_fmac_f32 v35, v34, v34
    v_sub_f32 v34, v25, v32
    v_fmac_f32 v35, v34, v34
    v_sub_f32 v34, v26, v32
    v_fmac_f32 v35, v34, v34
    v_sub_f32 v34, v27, v32
    v_fmac_f32 v35, v34, v34
    v_sub_f32 v34, v28, v32
    v_fmac_f32 v35, v34, v34
    v_sub_f32 v34, v29, v32
    v_fmac_f32 v35, v34, v34
    v_sub_f32 v34, v30, v32
    v_fmac_f32 v35, v34, v34
    v_sub_f32 v34, v31, v32
    v_fmac_f32 v35, v34, v34
    s_nop 1
    v_add_f32 v33, v35, v35 quad_perm:[1,0,3,2] row_mask:0xf bank_mask:0xf
    s_nop 1
    v_add_f32 v35, v33, v33 quad_perm:[2,3,0,1] row_mask:0xf bank_mask:0xf
    s_nop 1
    v_add_f32 v33, v35, v35 row_half_mirror row_mask:0xf bank_mask:0xf
    s_nop 1
    v_add_f32 v35, v33, v33 row_mirror row_mask:0xf bank_mask:0xf
    s_nop 0
    v_readlane_b32 s8, v35, 0
    v_readlane_b32 s9, v35, 16
    v_readlane_b32 s10, v35, 32
    v_readlane_b32 s11, v35, 48
    v_mov_b32 v35, s8
    v_add_f32 v35, s9, v35
    v_add_f32 v35, s10, v35
    v_add_f32 v35, s11, v35
    v_mul_f32 v35, 0x3a800000, v35
    v_cvt_pk_bf16_f32 v32, v32, v32
    v_and_b32 v32, 0xffff0000, v32
    v_cvt_pk_bf16_f32 v35, v35, v35
    v_and_b32 v35, 0xffff0000, v35
    v_add_f32 v35, 0x3727c5ac, v35
    v_cvt_pk_bf16_f32 v35, v35, v35
    v_and_b32 v35, 0xffff0000, v35
    v_sqrt_f32 v35, v35
    s_nop 0
    v_cvt_pk_bf16_f32 v35, v35, v35
    v_and_b32 v35, 0xffff0000, v35
    v_rcp_f32 v36, v35
    s_waitcnt vmcnt(1)
    v_sub_f32 v16, v16, v32
    v_cvt_pk_bf16_f32 v16, v16, v16
    v_and_b32 v16, 0xffff0000, v16
    v_mul_f32 v16, v16, v36
    v_cvt_pk_bf16_f32 v16, v16, v16
    v_and_b32 v16, 0xffff0000, v16
    v_mul_f32 v16, v16, v64
    v_cvt_pk_bf16_f32 v16, v16, v16
    v_and_b32 v16, 0xffff0000, v16
    v_add_f32 v16, v16, v80
    v_sub_f32 v17, v17, v32
    v_cvt_pk_bf16_f32 v17, v17, v17
    v_and_b32 v17, 0xffff0000, v17
    v_mul_f32 v17, v17, v36
    v_cvt_pk_bf16_f32 v17, v17, v17
    v_and_b32 v17, 0xffff0000, v17
    v_mul_f32 v17, v17, v65
    v_cvt_pk_bf16_f32 v17, v17, v17
    v_and_b32 v17, 0xffff0000, v17
    v_add_f32 v17, v17, v81
    v_sub_f32 v18, v18, v32
    v_cvt_pk_bf16_f32 v18, v18, v18
    v_and_b32 v18, 0xffff0000, v18
    v_mul_f32 v18, v18, v36
    v_cvt_pk_bf16_f32 v18, v18, v18
    v_and_b32 v18, 0xffff0000, v18
    v_mul_f32 v18, v18, v66
    v_cvt_pk_bf16_f32 v18, v18, v18
    v_and_b32 v18, 0xffff0000, v18
    v_add_f32 v18, v18, v82
    v_sub_f32 v19, v19, v32
    v_cvt_pk_bf16_f32 v19, v19, v19
    v_and_b32 v19, 0xffff0000, v19
    v_mul_f32 v19, v19, v36
    v_cvt_pk_bf16_f32 v19, v19, v19
    v_and_b32 v19, 0xffff0000, v19
    v_mul_f32 v19, v19, v67
    v_cvt_pk_bf16_f32 v19, v19, v19
    v_and_b32 v19, 0xffff0000, v19
    v_add_f32 v19, v19, v83
    v_sub_f32 v20, v20, v32
    v_cvt_pk_bf16_f32 v20, v20, v20
    v_and_b32 v20, 0xffff0000, v20
    v_mul_f32 v20, v20, v36
    v_cvt_pk_bf16_f32 v20, v20, v20
    v_and_b32 v20, 0xffff0000, v20
    v_mul_f32 v20, v20, v68
    v_cvt_pk_bf16_f32 v20, v20, v20
    v_and_b32 v20, 0xffff0000, v20
    v_add_f32 v20, v20, v84
    v_sub_f32 v21, v21, v32
    v_cvt_pk_bf16_f32 v21, v21, v21
    v_and_b32 v21, 0xffff0000, v21
    v_mul_f32 v21, v21, v36
    v_cvt_pk_bf16_f32 v21, v21, v21
    v_and_b32 v21, 0xffff0000, v21
    v_mul_f32 v21, v21, v69
    v_cvt_pk_bf16_f32 v21, v21, v21
    v_and_b32 v21, 0xffff0000, v21
    v_add_f32 v21, v21, v85
    v_sub_f32 v22, v22, v32
    v_cvt_pk_bf16_f32 v22, v22, v22
    v_and_b32 v22, 0xffff0000, v22
    v_mul_f32 v22, v22, v36
    v_cvt_pk_bf16_f32 v22, v22, v22
    v_and_b32 v22, 0xffff0000, v22
    v_mul_f32 v22, v22, v70
    v_cvt_pk_bf16_f32 v22, v22, v22
    v_and_b32 v22, 0xffff0000, v22
    v_add_f32 v22, v22, v86
    v_sub_f32 v23, v23, v32
    v_cvt_pk_bf16_f32 v23, v23, v23
    v_and_b32 v23, 0xffff0000, v23
    v_mul_f32 v23, v23, v36
    v_cvt_pk_bf16_f32 v23, v23, v23
    v_and_b32 v23, 0xffff0000, v23
    v_mul_f32 v23, v23, v71
    v_cvt_pk_bf16_f32 v23, v23, v23
    v_and_b32 v23, 0xffff0000, v23
    v_add_f32 v23, v23, v87
    v_sub_f32 v24, v24, v32
    v_cvt_pk_bf16_f32 v24, v24, v24
    v_and_b32 v24, 0xffff0000, v24
    v_mul_f32 v24, v24, v36
    v_cvt_pk_bf16_f32 v24, v24, v24
    v_and_b32 v24, 0xffff0000, v24
    v_mul_f32 v24, v24, v72
    v_cvt_pk_bf16_f32 v24, v24, v24
    v_and_b32 v24, 0xffff0000, v24
    v_add_f32 v24, v24, v88
    v_sub_f32 v25, v25, v32
    v_cvt_pk_bf16_f32 v25, v25, v25
    v_and_b32 v25, 0xffff0000, v25
    v_mul_f32 v25, v25, v36
    v_cvt_pk_bf16_f32 v25, v25, v25
    v_and_b32 v25, 0xffff0000, v25
    v_mul_f32 v25, v25, v73
    v_cvt_pk_bf16_f32 v25, v25, v25
    v_and_b32 v25, 0xffff0000, v25
    v_add_f32 v25, v25, v89
    v_sub_f32 v26, v26, v32
    v_cvt_pk_bf16_f32 v26, v26, v26
    v_and_b32 v26, 0xffff0000, v26
    v_mul_f32 v26, v26, v36
    v_cvt_pk_bf16_f32 v26, v26, v26
    v_and_b32 v26, 0xffff0000, v26
    v_mul_f32 v26, v26, v74
    v_cvt_pk_bf16_f32 v26, v26, v26
    v_and_b32 v26, 0xffff0000, v26
    v_add_f32 v26, v26, v90
    v_sub_f32 v27, v27, v32
    v_cvt_pk_bf16_f32 v27, v27, v27
    v_and_b32 v27, 0xffff0000, v27
    v_mul_f32 v27, v27, v36
    v_cvt_pk_bf16_f32 v27, v27, v27
    v_and_b32 v27, 0xffff0000, v27
    v_mul_f32 v27, v27, v75
    v_cvt_pk_bf16_f32 v27, v27, v27
    v_and_b32 v27, 0xffff0000, v27
    v_add_f32 v27, v27, v91
    v_sub_f32 v28, v28, v32
    v_cvt_pk_bf16_f32 v28, v28, v28
    v_and_b32 v28, 0xffff0000, v28
    v_mul_f32 v28, v28, v36
    v_cvt_pk_bf16_f32 v28, v28, v28
    v_and_b32 v28, 0xffff0000, v28
    v_mul_f32 v28, v28, v76
    v_cvt_pk_bf16_f32 v28, v28, v28
    v_and_b32 v28, 0xffff0000, v28
    v_add_f32 v28, v28, v92
    v_sub_f32 v29, v29, v32
    v_cvt_pk_bf16_f32 v29, v29, v29
    v_and_b32 v29, 0xffff0000, v29
    v_mul_f32 v29, v29, v36
    v_cvt_pk_bf16_f32 v29, v29, v29
    v_and_b32 v29, 0xffff0000, v29
    v_mul_f32 v29, v29, v77
    v_cvt_pk_bf16_f32 v29, v29, v29
    v_and_b32 v29, 0xffff0000, v29
    v_add_f32 v29, v29, v93
    v_sub_f32 v30, v30, v32
    v_cvt_pk_bf16_f32 v30, v30, v30
    v_and_b32 v30, 0xffff0000, v30
    v_mul_f32 v30, v30, v36
    v_cvt_pk_bf16_f32 v30, v30, v30
    v_and_b32 v30, 0xffff0000, v30
    v_mul_f32 v30, v30, v78
    v_cvt_pk_bf16_f32 v30, v30, v30
    v_and_b32 v30, 0xffff0000, v30
    v_add_f32 v30, v30, v94
    v_sub_f32 v31, v31, v32
    v_cvt_pk_bf16_f32 v31, v31, v31
    v_and_b32 v31, 0xffff0000, v31
    v_mul_f32 v31, v31, v36
    v_cvt_pk_bf16_f32 v31, v31, v31
    v_and_b32 v31, 0xffff0000, v31
    v_mul_f32 v31, v31, v79
    v_cvt_pk_bf16_f32 v31, v31, v31
    v_and_b32 v31, 0xffff0000, v31
    v_add_f32 v31, v31, v95
    v_cvt_pk_bf16_f32 v8, v16, v17
    v_cvt_pk_bf16_f32 v9, v18, v19
    v_cvt_pk_bf16_f32 v10, v20, v21
    v_cvt_pk_bf16_f32 v11, v22, v23
    v_cvt_pk_bf16_f32 v12, v24, v25
    v_cvt_pk_bf16_f32 v13, v26, v27
    v_cvt_pk_bf16_f32 v14, v28, v29
    v_cvt_pk_bf16_f32 v15, v30, v31
    buffer_store_dwordx4 v[8:11], v3, s[44:47], 0 offen
    buffer_store_dwordx4 v[12:15], v3, s[44:47], 0 offen offset:1024
ln1_kernel_end:
    s_endpgm
.p2align 8
.globl qkv_kernel
.type qkv_kernel,@function
qkv_kernel:
    s_cmp_ge_u32 s2, 256
    s_cbranch_scc1 qkv_kernel_end
    s_load_dwordx16 s[16:31], s[0:1], 0
    s_load_dwordx8 s[32:39], s[0:1], 64
    s_and_b32 s3, s2, 3
    s_lshl_b32 s3, s3, 2
    s_bfe_u32 s4, s2, 0x20003
    s_add_u32 s3, s3, s4
    s_bfe_u32 s4, s2, 0x10002
    s_lshl_b32 s4, s4, 3
    s_lshr_b32 s5, s2, 5
    s_add_u32 s4, s4, s5
    v_lshrrev_b32 v1, 6, v0
    s_nop 0
    v_readfirstlane_b32 s6, v1
    v_and_b32 v2, 63, v0
    s_and_b32 s7, s6, 3
    s_lshr_b32 s8, s6, 2
    s_waitcnt lgkmcnt(0)
    s_mul_i32 s9, s3, 262144
    s_add_u32 s10, s9, 1048576
    s_sub_u32 s11, 4194304, s9
    s_add_u32 s40, s38, s10
    s_addc_u32 s41, s39, 0
    s_and_b32 s41, s41, 0xffff
    s_mov_b32 s42, s11
    s_mov_b32 s43, 0x00020000
    s_mul_i32 s9, s4, 128
    s_add_u32 s9, s9, 0
    s_sub_u32 s11, 6291456, s9
    s_add_u32 s44, s18, s9
    s_addc_u32 s45, s19, 0
    s_and_b32 s45, s45, 0xffff
    s_mov_b32 s46, s11
    s_mov_b32 s47, 0x00020000
    s_mul_i32 s9, s4, 128
    s_add_u32 s9, s9, 2048
    s_sub_u32 s11, 6291456, s9
    s_add_u32 s48, s18, s9
    s_addc_u32 s49, s19, 0
    s_and_b32 s49, s49, 0xffff
    s_mov_b32 s50, s11
    s_mov_b32 s51, 0x00020000
    s_mul_i32 s9, s4, 128
    s_add_u32 s9, s9, 4096
    s_sub_u32 s11, 6291456, s9
    s_add_u32 s52, s18, s9
    s_addc_u32 s53, s19, 0
    s_and_b32 s53, s53, 0xffff
    s_mov_b32 s54, s11
    s_mov_b32 s55, 0x00020000
    v_lshrrev_b32 v10, 3, v2
    v_lshrrev_b32 v11, 4, v2
    v_bfe_u32 v12, v2, 2, 2
    v_and_b32 v15, 3, v2
    s_and_b32 s9, s6, 1
    s_lshl_b32 s9, s9, 2
    v_add_u32 v13, s9, v11
    v_and_b32 v14, 7, v2
    v_xor_b32 v13, v13, v14
    s_lshl_b32 s9, s6, 3
    v_add_u32 v14, s9, v10
    s_mov_b32 s9, 2048
    v_mul_lo_u32 v14, v14, s9
    v_lshl_add_u32 v4, v13, 4, v14
    v_add_u32 v5, 131072, v4
    v_and_b32 v13, 1, v11
    s_and_b32 s9, s6, 1
    s_lshl_b32 s9, s9, 1
    v_add_u32 v13, s9, v13
    v_bfe_u32 v14, v2, 1, 2
    v_xor_b32 v13, v13, v14
    v_lshlrev_b32 v13, 5, v13
    v_and_b32 v14, 1, v2
    v_lshl_add_u32 v13, v14, 4, v13
    s_lshl_b32 s9, s6, 3
    v_add_u32 v14, s9, v10
    s_mov_b32 s9, 6144
    v_mul_lo_u32 v14, v14, s9
    v_add_u32 v32, v13, v14
    s_lshl_b32 s75, s6, 10
    v_and_b32 v13, 15, v2
    v_lshrrev_b32 v14, 1, v13
    v_xor_b32 v14, v14, v11
    v_lshlrev_b32 v13, 7, v13
    v_lshl_add_u32 v13, v14, 4, v13
    s_lshl_b32 s9, s7, 12
    v_add_u32 v13, s9, v13
    v_add_u32 v16, 0, v13
    v_xor_b32 v17, 64, v16
    v_add_u32 v18, 40960, v13
    v_xor_b32 v19, 64, v18
    v_add_u32 v20, 81920, v13
    v_xor_b32 v21, 64, v20
    v_add_u32 v22, 122880, v13
    v_xor_b32 v23, 64, v22
    v_lshrrev_b32 v13, 1, v12
    v_and_b32 v14, 1, v11
    v_lshl_add_u32 v13, v14, 1, v13
    s_lshl_b32 s9, s8, 1
    v_xor_b32 v13, s9, v13
    v_lshl_add_u32 v14, v11, 3, v12
    v_lshlrev_b32 v14, 7, v14
    v_lshl_add_u32 v14, v15, 3, v14
    v_lshl_add_u32 v24, v13, 5, v14
    v_xor_b32 v25, 32, v24
    v_add_u32 v40, 16384, v24
    v_add_u32 v41, 16384, v25
    v_add_u32 v42, 57344, v24
    v_add_u32 v43, 57344, v25
    v_add_u32 v44, 98304, v24
    v_add_u32 v45, 98304, v25
    v_add_u32 v46, 139264, v24
    v_add_u32 v47, 139264, v25
    s_lshl_b32 s12, s6, 10
    s_mov_b32 s13, 0
    s_mov_b32 s14, 0
    s_add_u32 m0, s12, 0
    s_nop 0
    buffer_load_dwordx4 v4, s[40:43], s13 offen lds
    s_add_u32 m0, s12, 8192
    s_nop 0
    buffer_load_dwordx4 v5, s[40:43], s13 offen lds
    s_add_u32 m0, s75, 16384
    s_nop 0
    buffer_load_dwordx4 v32, s[44:47], s14 offen lds
    s_add_u32 m0, s75, 24576
    s_nop 0
    buffer_load_dwordx4 v32, s[48:51], s14 offen lds
    s_add_u32 m0, s75, 32768
    s_nop 0
    buffer_load_dwordx4 v32, s[52:55], s14 offen lds
    s_add_u32 s13, s13, 128
    s_add_u32 s14, s14, 393216
    s_add_u32 m0, s12, 40960
    s_nop 0
    buffer_load_dwordx4 v4, s[40:43], s13 offen lds
    s_add_u32 m0, s12, 49152
    s_nop 0
    buffer_load_dwordx4 v5, s[40:43], s13 offen lds
    s_add_u32 m0, s75, 57344
    s_nop 0
    buffer_load_dwordx4 v32, s[44:47], s14 offen lds
    s_add_u32 m0, s75, 65536
    s_nop 0
    buffer_load_dwordx4 v32, s[48:51], s14 offen lds
    s_add_u32 m0, s75, 73728
    s_nop 0
    buffer_load_dwordx4 v32, s[52:55], s14 offen lds
    s_add_u32 s13, s13, 128
    s_add_u32 s14, s14, 393216
    s_add_u32 m0, s12, 81920
    s_nop 0
    buffer_load_dwordx4 v4, s[40:43], s13 offen lds
    s_add_u32 m0, s12, 90112
    s_nop 0
    buffer_load_dwordx4 v5, s[40:43], s13 offen lds
    s_add_u32 m0, s75, 98304
    s_nop 0
    buffer_load_dwordx4 v32, s[44:47], s14 offen lds
    s_add_u32 m0, s75, 106496
    s_nop 0
    buffer_load_dwordx4 v32, s[48:51], s14 offen lds
    s_add_u32 m0, s75, 114688
    s_nop 0
    buffer_load_dwordx4 v32, s[52:55], s14 offen lds
    s_add_u32 s13, s13, 128
    s_add_u32 s14, s14, 393216
    s_add_u32 m0, s12, 122880
    s_nop 0
    buffer_load_dwordx4 v4, s[40:43], s13 offen lds
    s_add_u32 m0, s12, 131072
    s_nop 0
    buffer_load_dwordx4 v5, s[40:43], s13 offen lds
    s_add_u32 m0, s75, 139264
    s_nop 0
    buffer_load_dwordx4 v32, s[44:47], s14 offen lds
    s_add_u32 m0, s75, 147456
    s_nop 0
    buffer_load_dwordx4 v32, s[48:51], s14 offen lds
    s_add_u32 m0, s75, 155648
    s_nop 0
    buffer_load_dwordx4 v32, s[52:55], s14 offen lds
    s_add_u32 s13, s13, 128
    s_add_u32 s14, s14, 393216
    v_accvgpr_write_b32 a0, 0
    v_accvgpr_write_b32 a1, 0
    v_accvgpr_write_b32 a2, 0
    v_accvgpr_write_b32 a3, 0
    v_accvgpr_write_b32 a4, 0
    v_accvgpr_write_b32 a5, 0
    v_accvgpr_write_b32 a6, 0
    v_accvgpr_write_b32 a7, 0
    v_accvgpr_write_b32 a8, 0
    v_accvgpr_write_b32 a9, 0
    v_accvgpr_write_b32 a10, 0
    v_accvgpr_write_b32 a11, 0
    v_accvgpr_write_b32 a12, 0
    v_accvgpr_write_b32 a13, 0
    v_accvgpr_write_b32 a14, 0
    v_accvgpr_write_b32 a15, 0
    v_accvgpr_write_b32 a16, 0
    v_accvgpr_write_b32 a17, 0
    v_accvgpr_write_b32 a18, 0
    v_accvgpr_write_b32 a19, 0
    v_accvgpr_write_b32 a20, 0
    v_accvgpr_write_b32 a21, 0
    v_accvgpr_write_b32 a22, 0
    v_accvgpr_write_b32 a23, 0
    v_accvgpr_write_b32 a24, 0
    v_accvgpr_write_b32 a25, 0
    v_accvgpr_write_b32 a26, 0
    v_accvgpr_write_b32 a27, 0
    v_accvgpr_write_b32 a28, 0
    v_accvgpr_write_b32 a29, 0
    v_accvgpr_write_b32 a30, 0
    v_accvgpr_write_b32 a31, 0
    v_accvgpr_write_b32 a32, 0
    v_accvgpr_write_b32 a33, 0
    v_accvgpr_write_b32 a34, 0
    v_accvgpr_write_b32 a35, 0
    v_accvgpr_write_b32 a36, 0
    v_accvgpr_write_b32 a37, 0
    v_accvgpr_write_b32 a38, 0
    v_accvgpr_write_b32 a39, 0
    v_accvgpr_write_b32 a40, 0
    v_accvgpr_write_b32 a41, 0
    v_accvgpr_write_b32 a42, 0
    v_accvgpr_write_b32 a43, 0
    v_accvgpr_write_b32 a44, 0
    v_accvgpr_write_b32 a45, 0
    v_accvgpr_write_b32 a46, 0
    v_accvgpr_write_b32 a47, 0
    s_waitcnt vmcnt(15)
    s_barrier
    ds_read_b128 v[64:67], v16
    ds_read_b128 v[68:71], v16 offset:2048
    ds_read_b64_tr_b16 v[72:73], v40
    ds_read_b64_tr_b16 v[74:75], v40 offset:512
    ds_read_b64_tr_b16 v[76:77], v41
    ds_read_b64_tr_b16 v[78:79], v41 offset:512
    ds_read_b64_tr_b16 v[80:81], v40 offset:8192
    ds_read_b64_tr_b16 v[82:83], v40 offset:8704
    ds_read_b64_tr_b16 v[84:85], v41 offset:8192
    ds_read_b64_tr_b16 v[86:87], v41 offset:8704
    ds_read_b64_tr_b16 v[88:89], v40 offset:16384
    ds_read_b64_tr_b16 v[90:91], v40 offset:16896
    ds_read_b64_tr_b16 v[92:93], v41 offset:16384
    ds_read_b64_tr_b16 v[94:95], v41 offset:16896
    ds_read_b128 v[96:99], v17
    ds_read_b128 v[100:103], v17 offset:2048
    ds_read_b64_tr_b16 v[104:105], v40 offset:4096
    ds_read_b64_tr_b16 v[106:107], v40 offset:4608
    ds_read_b64_tr_b16 v[108:109], v41 offset:4096
    ds_read_b64_tr_b16 v[110:111], v41 offset:4608
    ds_read_b64_tr_b16 v[112:113], v40 offset:12288
    ds_read_b64_tr_b16 v[114:115], v40 offset:12800
    ds_read_b64_tr_b16 v[116:117], v41 offset:12288
    ds_read_b64_tr_b16 v[118:119], v41 offset:12800
    ds_read_b64_tr_b16 v[120:121], v40 offset:20480
    ds_read_b64_tr_b16 v[122:123], v40 offset:20992
    ds_read_b64_tr_b16 v[124:125], v41 offset:20480
    ds_read_b64_tr_b16 v[126:127], v41 offset:20992
    s_mov_b32 s15, 3
qkv_kernel_loop:
    s_waitcnt vmcnt(10) lgkmcnt(0)
    s_barrier
    v_mfma_f32_16x16x32_bf16 a[0:3], v[72:75], v[64:67], a[0:3]
    ds_read_b128 v[128:131], v18
    ds_read_b128 v[132:135], v18 offset:2048
    v_mfma_f32_16x16x32_bf16 a[4:7], v[72:75], v[68:71], a[4:7]
    ds_read_b64_tr_b16 v[136:137], v42
    ds_read_b64_tr_b16 v[138:139], v42 offset:512
    v_mfma_f32_16x16x32_bf16 a[8:11], v[76:79], v[64:67], a[8:11]
    ds_read_b64_tr_b16 v[140:141], v43
    s_add_u32 m0, s12, 0
    s_nop 0
    buffer_load_dwordx4 v4, s[40:43], s13 offen lds
    v_mfma_f32_16x16x32_bf16 a[12:15], v[76:79], v[68:71], a[12:15]
    ds_read_b64_tr_b16 v[142:143], v43 offset:512
    ds_read_b64_tr_b16 v[144:145], v42 offset:8192
    v_mfma_f32_16x16x32_bf16 a[16:19], v[80:83], v[64:67], a[16:19]
    ds_read_b64_tr_b16 v[146:147], v42 offset:8704
    ds_read_b64_tr_b16 v[148:149], v43 offset:8192
    v_mfma_f32_16x16x32_bf16 a[20:23], v[80:83], v[68:71], a[20:23]
    ds_read_b64_tr_b16 v[150:151], v43 offset:8704
    s_add_u32 m0, s12, 8192
    s_nop 0
    buffer_load_dwordx4 v5, s[40:43], s13 offen lds
    v_mfma_f32_16x16x32_bf16 a[24:27], v[84:87], v[64:67], a[24:27]
    ds_read_b64_tr_b16 v[152:153], v42 offset:16384
    ds_read_b64_tr_b16 v[154:155], v42 offset:16896
    v_mfma_f32_16x16x32_bf16 a[28:31], v[84:87], v[68:71], a[28:31]
    ds_read_b64_tr_b16 v[156:157], v43 offset:16384
    ds_read_b64_tr_b16 v[158:159], v43 offset:16896
    v_mfma_f32_16x16x32_bf16 a[32:35], v[64:67], v[88:91], a[32:35]
    s_add_u32 m0, s75, 16384
    s_nop 0
    buffer_load_dwordx4 v32, s[44:47], s14 offen lds
    ds_read_b128 v[160:163], v19
    v_mfma_f32_16x16x32_bf16 a[36:39], v[68:71], v[88:91], a[36:39]
    ds_read_b128 v[164:167], v19 offset:2048
    ds_read_b64_tr_b16 v[168:169], v42 offset:4096
    v_mfma_f32_16x16x32_bf16 a[40:43], v[64:67], v[92:95], a[40:43]
    ds_read_b64_tr_b16 v[170:171], v42 offset:4608
    v_mfma_f32_16x16x32_bf16 a[44:47], v[68:71], v[92:95], a[44:47]
    ds_read_b64_tr_b16 v[172:173], v43 offset:4096
    v_mfma_f32_16x16x32_bf16 a[0:3], v[104:107], v[96:99], a[0:3]
    s_add_u32 m0, s75, 24576
    s_nop 0
    buffer_load_dwordx4 v32, s[48:51], s14 offen lds
    v_mfma_f32_16x16x32_bf16 a[4:7], v[104:107], v[100:103], a[4:7]
    ds_read_b64_tr_b16 v[174:175], v43 offset:4608
    v_mfma_f32_16x16x32_bf16 a[8:11], v[108:111], v[96:99], a[8:11]
    ds_read_b64_tr_b16 v[176:177], v42 offset:12288
    v_mfma_f32_16x16x32_bf16 a[12:15], v[108:111], v[100:103], a[12:15]
    ds_read_b64_tr_b16 v[178:179], v42 offset:12800
    v_mfma_f32_16x16x32_bf16 a[16:19], v[112:115], v[96:99], a[16:19]
    ds_read_b64_tr_b16 v[180:181], v43 offset:12288
    v_mfma_f32_16x16x32_bf16 a[20:23], v[112:115], v[100:103], a[20:23]
    ds_read_b64_tr_b16 v[182:183], v43 offset:12800
    v_mfma_f32_16x16x32_bf16 a[24:27], v[116:119], v[96:99], a[24:27]
    s_add_u32 m0, s75, 32768
    s_nop 0
    buffer_load_dwordx4 v32, s[52:55], s14 offen lds
    v_mfma_f32_16x16x32_bf16 a[28:31], v[116:119], v[100:103], a[28:31]
    ds_read_b64_tr_b16 v[184:185], v42 offset:20480
    v_mfma_f32_16x16x32_bf16 a[32:35], v[96:99], v[120:123], a[32:35]
    ds_read_b64_tr_b16 v[186:187], v42 offset:20992
    v_mfma_f32_16x16x32_bf16 a[36:39], v[100:103], v[120:123], a[36:39]
    ds_read_b64_tr_b16 v[188:189], v43 offset:20480
    v_mfma_f32_16x16x32_bf16 a[40:43], v[96:99], v[124:127], a[40:43]
    ds_read_b64_tr_b16 v[190:191], v43 offset:20992
    v_mfma_f32_16x16x32_bf16 a[44:47], v[100:103], v[124:127], a[44:47]
    s_add_u32 s13, s13, 128
    s_add_u32 s14, s14, 393216
    s_waitcnt vmcnt(10) lgkmcnt(0)
    s_barrier
    v_mfma_f32_16x16x32_bf16 a[0:3], v[136:139], v[128:131], a[0:3]
    ds_read_b128 v[64:67], v20
    ds_read_b128 v[68:71], v20 offset:2048
    v_mfma_f32_16x16x32_bf16 a[4:7], v[136:139], v[132:135], a[4:7]
    ds_read_b64_tr_b16 v[72:73], v44
    ds_read_b64_tr_b16 v[74:75], v44 offset:512
    v_mfma_f32_16x16x32_bf16 a[8:11], v[140:143], v[128:131], a[8:11]
    ds_read_b64_tr_b16 v[76:77], v45
    s_add_u32 m0, s12, 40960
    s_nop 0
    buffer_load_dwordx4 v4, s[40:43], s13 offen lds
    v_mfma_f32_16x16x32_bf16 a[12:15], v[140:143], v[132:135], a[12:15]
    ds_read_b64_tr_b16 v[78:79], v45 offset:512
    ds_read_b64_tr_b16 v[80:81], v44 offset:8192
    v_mfma_f32_16x16x32_bf16 a[16:19], v[144:147], v[128:131], a[16:19]
    ds_read_b64_tr_b16 v[82:83], v44 offset:8704
    ds_read_b64_tr_b16 v[84:85], v45 offset:8192
    v_mfma_f32_16x16x32_bf16 a[20:23], v[144:147], v[132:135], a[20:23]
    ds_read_b64_tr_b16 v[86:87], v45 offset:8704
    s_add_u32 m0, s12, 49152
    s_nop 0
    buffer_load_dwordx4 v5, s[40:43], s13 offen lds
    v_mfma_f32_16x16x32_bf16 a[24:27], v[148:151], v[128:131], a[24:27]
    ds_read_b64_tr_b16 v[88:89], v44 offset:16384
    ds_read_b64_tr_b16 v[90:91], v44 offset:16896
    v_mfma_f32_16x16x32_bf16 a[28:31], v[148:151], v[132:135], a[28:31]
    ds_read_b64_tr_b16 v[92:93], v45 offset:16384
    ds_read_b64_tr_b16 v[94:95], v45 offset:16896
    v_mfma_f32_16x16x32_bf16 a[32:35], v[128:131], v[152:155], a[32:35]
    s_add_u32 m0, s75, 57344
    s_nop 0
    buffer_load_dwordx4 v32, s[44:47], s14 offen lds
    ds_read_b128 v[96:99], v21
    v_mfma_f32_16x16x32_bf16 a[36:39], v[132:135], v[152:155], a[36:39]
    ds_read_b128 v[100:103], v21 offset:2048
    ds_read_b64_tr_b16 v[104:105], v44 offset:4096
    v_mfma_f32_16x16x32_bf16 a[40:43], v[128:131], v[156:159], a[40:43]
    ds_read_b64_tr_b16 v[106:107], v44 offset:4608
    v_mfma_f32_16x16x32_bf16 a[44:47], v[132:135], v[156:159], a[44:47]
    ds_read_b64_tr_b16 v[108:109], v45 offset:4096
    v_mfma_f32_16x16x32_bf16 a[0:3], v[168:171], v[160:163], a[0:3]
    s_add_u32 m0, s75, 65536
    s_nop 0
    buffer_load_dwordx4 v32, s[48:51], s14 offen lds
    v_mfma_f32_16x16x32_bf16 a[4:7], v[168:171], v[164:167], a[4:7]
    ds_read_b64_tr_b16 v[110:111], v45 offset:4608
    v_mfma_f32_16x16x32_bf16 a[8:11], v[172:175], v[160:163], a[8:11]
    ds_read_b64_tr_b16 v[112:113], v44 offset:12288
    v_mfma_f32_16x16x32_bf16 a[12:15], v[172:175], v[164:167], a[12:15]
    ds_read_b64_tr_b16 v[114:115], v44 offset:12800
    v_mfma_f32_16x16x32_bf16 a[16:19], v[176:179], v[160:163], a[16:19]
    ds_read_b64_tr_b16 v[116:117], v45 offset:12288
    v_mfma_f32_16x16x32_bf16 a[20:23], v[176:179], v[164:167], a[20:23]
    ds_read_b64_tr_b16 v[118:119], v45 offset:12800
    v_mfma_f32_16x16x32_bf16 a[24:27], v[180:183], v[160:163], a[24:27]
    s_add_u32 m0, s75, 73728
    s_nop 0
    buffer_load_dwordx4 v32, s[52:55], s14 offen lds
    v_mfma_f32_16x16x32_bf16 a[28:31], v[180:183], v[164:167], a[28:31]
    ds_read_b64_tr_b16 v[120:121], v44 offset:20480
    v_mfma_f32_16x16x32_bf16 a[32:35], v[160:163], v[184:187], a[32:35]
    ds_read_b64_tr_b16 v[122:123], v44 offset:20992
    v_mfma_f32_16x16x32_bf16 a[36:39], v[164:167], v[184:187], a[36:39]
    ds_read_b64_tr_b16 v[124:125], v45 offset:20480
    v_mfma_f32_16x16x32_bf16 a[40:43], v[160:163], v[188:191], a[40:43]
    ds_read_b64_tr_b16 v[126:127], v45 offset:20992
    v_mfma_f32_16x16x32_bf16 a[44:47], v[164:167], v[188:191], a[44:47]
    s_add_u32 s13, s13, 128
    s_add_u32 s14, s14, 393216
    s_waitcnt vmcnt(10) lgkmcnt(0)
    s_barrier
    v_mfma_f32_16x16x32_bf16 a[0:3], v[72:75], v[64:67], a[0:3]
    ds_read_b128 v[128:131], v22
    ds_read_b128 v[132:135], v22 offset:2048
    v_mfma_f32_16x16x32_bf16 a[4:7], v[72:75], v[68:71], a[4:7]
    ds_read_b64_tr_b16 v[136:137], v46
    ds_read_b64_tr_b16 v[138:139], v46 offset:512
    v_mfma_f32_16x16x32_bf16 a[8:11], v[76:79], v[64:67], a[8:11]
    ds_read_b64_tr_b16 v[140:141], v47
    s_add_u32 m0, s12, 81920
    s_nop 0
    buffer_load_dwordx4 v4, s[40:43], s13 offen lds
    v_mfma_f32_16x16x32_bf16 a[12:15], v[76:79], v[68:71], a[12:15]
    ds_read_b64_tr_b16 v[142:143], v47 offset:512
    ds_read_b64_tr_b16 v[144:145], v46 offset:8192
    v_mfma_f32_16x16x32_bf16 a[16:19], v[80:83], v[64:67], a[16:19]
    ds_read_b64_tr_b16 v[146:147], v46 offset:8704
    ds_read_b64_tr_b16 v[148:149], v47 offset:8192
    v_mfma_f32_16x16x32_bf16 a[20:23], v[80:83], v[68:71], a[20:23]
    ds_read_b64_tr_b16 v[150:151], v47 offset:8704
    s_add_u32 m0, s12, 90112
    s_nop 0
    buffer_load_dwordx4 v5, s[40:43], s13 offen lds
    v_mfma_f32_16x16x32_bf16 a[24:27], v[84:87], v[64:67], a[24:27]
    ds_read_b64_tr_b16 v[152:153], v46 offset:16384
    ds_read_b64_tr_b16 v[154:155], v46 offset:16896
    v_mfma_f32_16x16x32_bf16 a[28:31], v[84:87], v[68:71], a[28:31]
    ds_read_b64_tr_b16 v[156:157], v47 offset:16384
    ds_read_b64_tr_b16 v[158:159], v47 offset:16896
    v_mfma_f32_16x16x32_bf16 a[32:35], v[64:67], v[88:91], a[32:35]
    s_add_u32 m0, s75, 98304
    s_nop 0
    buffer_load_dwordx4 v32, s[44:47], s14 offen lds
    ds_read_b128 v[160:163], v23
    v_mfma_f32_16x16x32_bf16 a[36:39], v[68:71], v[88:91], a[36:39]
    ds_read_b128 v[164:167], v23 offset:2048
    ds_read_b64_tr_b16 v[168:169], v46 offset:4096
    v_mfma_f32_16x16x32_bf16 a[40:43], v[64:67], v[92:95], a[40:43]
    ds_read_b64_tr_b16 v[170:171], v46 offset:4608
    v_mfma_f32_16x16x32_bf16 a[44:47], v[68:71], v[92:95], a[44:47]
    ds_read_b64_tr_b16 v[172:173], v47 offset:4096
    v_mfma_f32_16x16x32_bf16 a[0:3], v[104:107], v[96:99], a[0:3]
    s_add_u32 m0, s75, 106496
    s_nop 0
    buffer_load_dwordx4 v32, s[48:51], s14 offen lds
    v_mfma_f32_16x16x32_bf16 a[4:7], v[104:107], v[100:103], a[4:7]
    ds_read_b64_tr_b16 v[174:175], v47 offset:4608
    v_mfma_f32_16x16x32_bf16 a[8:11], v[108:111], v[96:99], a[8:11]
    ds_read_b64_tr_b16 v[176:177], v46 offset:12288
    v_mfma_f32_16x16x32_bf16 a[12:15], v[108:111], v[100:103], a[12:15]
    ds_read_b64_tr_b16 v[178:179], v46 offset:12800
    v_mfma_f32_16x16x32_bf16 a[16:19], v[112:115], v[96:99], a[16:19]
    ds_read_b64_tr_b16 v[180:181], v47 offset:12288
    v_mfma_f32_16x16x32_bf16 a[20:23], v[112:115], v[100:103], a[20:23]
    ds_read_b64_tr_b16 v[182:183], v47 offset:12800
    v_mfma_f32_16x16x32_bf16 a[24:27], v[116:119], v[96:99], a[24:27]
    s_add_u32 m0, s75, 114688
    s_nop 0
    buffer_load_dwordx4 v32, s[52:55], s14 offen lds
    v_mfma_f32_16x16x32_bf16 a[28:31], v[116:119], v[100:103], a[28:31]
    ds_read_b64_tr_b16 v[184:185], v46 offset:20480
    v_mfma_f32_16x16x32_bf16 a[32:35], v[96:99], v[120:123], a[32:35]
    ds_read_b64_tr_b16 v[186:187], v46 offset:20992
    v_mfma_f32_16x16x32_bf16 a[36:39], v[100:103], v[120:123], a[36:39]
    ds_read_b64_tr_b16 v[188:189], v47 offset:20480
    v_mfma_f32_16x16x32_bf16 a[40:43], v[96:99], v[124:127], a[40:43]
    ds_read_b64_tr_b16 v[190:191], v47 offset:20992
    v_mfma_f32_16x16x32_bf16 a[44:47], v[100:103], v[124:127], a[44:47]
    s_add_u32 s13, s13, 128
    s_add_u32 s14, s14, 393216
    s_waitcnt vmcnt(10) lgkmcnt(0)
    s_barrier
    v_mfma_f32_16x16x32_bf16 a[0:3], v[136:139], v[128:131], a[0:3]
    ds_read_b128 v[64:67], v16
    ds_read_b128 v[68:71], v16 offset:2048
    v_mfma_f32_16x16x32_bf16 a[4:7], v[136:139], v[132:135], a[4:7]
    ds_read_b64_tr_b16 v[72:73], v40
    ds_read_b64_tr_b16 v[74:75], v40 offset:512
    v_mfma_f32_16x16x32_bf16 a[8:11], v[140:143], v[128:131], a[8:11]
    ds_read_b64_tr_b16 v[76:77], v41
    s_add_u32 m0, s12, 122880
    s_nop 0
    buffer_load_dwordx4 v4, s[40:43], s13 offen lds
    v_mfma_f32_16x16x32_bf16 a[12:15], v[140:143], v[132:135], a[12:15]
    ds_read_b64_tr_b16 v[78:79], v41 offset:512
    ds_read_b64_tr_b16 v[80:81], v40 offset:8192
    v_mfma_f32_16x16x32_bf16 a[16:19], v[144:147], v[128:131], a[16:19]
    ds_read_b64_tr_b16 v[82:83], v40 offset:8704
    ds_read_b64_tr_b16 v[84:85], v41 offset:8192
    v_mfma_f32_16x16x32_bf16 a[20:23], v[144:147], v[132:135], a[20:23]
    ds_read_b64_tr_b16 v[86:87], v41 offset:8704
    s_add_u32 m0, s12, 131072
    s_nop 0
    buffer_load_dwordx4 v5, s[40:43], s13 offen lds
    v_mfma_f32_16x16x32_bf16 a[24:27], v[148:151], v[128:131], a[24:27]
    ds_read_b64_tr_b16 v[88:89], v40 offset:16384
    ds_read_b64_tr_b16 v[90:91], v40 offset:16896
    v_mfma_f32_16x16x32_bf16 a[28:31], v[148:151], v[132:135], a[28:31]
    ds_read_b64_tr_b16 v[92:93], v41 offset:16384
    ds_read_b64_tr_b16 v[94:95], v41 offset:16896
    v_mfma_f32_16x16x32_bf16 a[32:35], v[128:131], v[152:155], a[32:35]
    s_add_u32 m0, s75, 139264
    s_nop 0
    buffer_load_dwordx4 v32, s[44:47], s14 offen lds
    ds_read_b128 v[96:99], v17
    v_mfma_f32_16x16x32_bf16 a[36:39], v[132:135], v[152:155], a[36:39]
    ds_read_b128 v[100:103], v17 offset:2048
    ds_read_b64_tr_b16 v[104:105], v40 offset:4096
    v_mfma_f32_16x16x32_bf16 a[40:43], v[128:131], v[156:159], a[40:43]
    ds_read_b64_tr_b16 v[106:107], v40 offset:4608
    v_mfma_f32_16x16x32_bf16 a[44:47], v[132:135], v[156:159], a[44:47]
    ds_read_b64_tr_b16 v[108:109], v41 offset:4096
    v_mfma_f32_16x16x32_bf16 a[0:3], v[168:171], v[160:163], a[0:3]
    s_add_u32 m0, s75, 147456
    s_nop 0
    buffer_load_dwordx4 v32, s[48:51], s14 offen lds
    v_mfma_f32_16x16x32_bf16 a[4:7], v[168:171], v[164:167], a[4:7]
    ds_read_b64_tr_b16 v[110:111], v41 offset:4608
    v_mfma_f32_16x16x32_bf16 a[8:11], v[172:175], v[160:163], a[8:11]
    ds_read_b64_tr_b16 v[112:113], v40 offset:12288
    v_mfma_f32_16x16x32_bf16 a[12:15], v[172:175], v[164:167], a[12:15]
    ds_read_b64_tr_b16 v[114:115], v40 offset:12800
    v_mfma_f32_16x16x32_bf16 a[16:19], v[176:179], v[160:163], a[16:19]
    ds_read_b64_tr_b16 v[116:117], v41 offset:12288
    v_mfma_f32_16x16x32_bf16 a[20:23], v[176:179], v[164:167], a[20:23]
    ds_read_b64_tr_b16 v[118:119], v41 offset:12800
    v_mfma_f32_16x16x32_bf16 a[24:27], v[180:183], v[160:163], a[24:27]
    s_add_u32 m0, s75, 155648
    s_nop 0
    buffer_load_dwordx4 v32, s[52:55], s14 offen lds
    v_mfma_f32_16x16x32_bf16 a[28:31], v[180:183], v[164:167], a[28:31]
    ds_read_b64_tr_b16 v[120:121], v40 offset:20480
    v_mfma_f32_16x16x32_bf16 a[32:35], v[160:163], v[184:187], a[32:35]
    ds_read_b64_tr_b16 v[122:123], v40 offset:20992
    v_mfma_f32_16x16x32_bf16 a[36:39], v[164:167], v[184:187], a[36:39]
    ds_read_b64_tr_b16 v[124:125], v41 offset:20480
    v_mfma_f32_16x16x32_bf16 a[40:43], v[160:163], v[188:191], a[40:43]
    ds_read_b64_tr_b16 v[126:127], v41 offset:20992
    v_mfma_f32_16x16x32_bf16 a[44:47], v[164:167], v[188:191], a[44:47]
    s_add_u32 s13, s13, 128
    s_add_u32 s14, s14, 393216
    s_sub_u32 s15, s15, 1
    s_cmp_lg_u32 s15, 0
    s_cbranch_scc1 qkv_kernel_loop
    s_waitcnt vmcnt(10) lgkmcnt(0)
    s_barrier
    v_mfma_f32_16x16x32_bf16 a[0:3], v[72:75], v[64:67], a[0:3]
    ds_read_b128 v[128:131], v18
    ds_read_b128 v[132:135], v18 offset:2048
    v_mfma_f32_16x16x32_bf16 a[4:7], v[72:75], v[68:71], a[4:7]
    ds_read_b64_tr_b16 v[136:137], v42
    ds_read_b64_tr_b16 v[138:139], v42 offset:512
    v_mfma_f32_16x16x32_bf16 a[8:11], v[76:79], v[64:67], a[8:11]
    ds_read_b64_tr_b16 v[140:141], v43
    ds_read_b64_tr_b16 v[142:143], v43 offset:512
    v_mfma_f32_16x16x32_bf16 a[12:15], v[76:79], v[68:71], a[12:15]
    ds_read_b64_tr_b16 v[144:145], v42 offset:8192
    ds_read_b64_tr_b16 v[146:147], v42 offset:8704
    v_mfma_f32_16x16x32_bf16 a[16:19], v[80:83], v[64:67], a[16:19]
    ds_read_b64_tr_b16 v[148:149], v43 offset:8192
    v_mfma_f32_16x16x32_bf16 a[20:23], v[80:83], v[68:71], a[20:23]
    ds_read_b64_tr_b16 v[150:151], v43 offset:8704
    v_mfma_f32_16x16x32_bf16 a[24:27], v[84:87], v[64:67], a[24:27]
    ds_read_b64_tr_b16 v[152:153], v42 offset:16384
    v_mfma_f32_16x16x32_bf16 a[28:31], v[84:87], v[68:71], a[28:31]
    ds_read_b64_tr_b16 v[154:155], v42 offset:16896
    v_mfma_f32_16x16x32_bf16 a[32:35], v[64:67], v[88:91], a[32:35]
    ds_read_b64_tr_b16 v[156:157], v43 offset:16384
    v_mfma_f32_16x16x32_bf16 a[36:39], v[68:71], v[88:91], a[36:39]
    ds_read_b64_tr_b16 v[158:159], v43 offset:16896
    v_mfma_f32_16x16x32_bf16 a[40:43], v[64:67], v[92:95], a[40:43]
    ds_read_b128 v[160:163], v19
    v_mfma_f32_16x16x32_bf16 a[44:47], v[68:71], v[92:95], a[44:47]
    ds_read_b128 v[164:167], v19 offset:2048
    v_mfma_f32_16x16x32_bf16 a[0:3], v[104:107], v[96:99], a[0:3]
    ds_read_b64_tr_b16 v[168:169], v42 offset:4096
    v_mfma_f32_16x16x32_bf16 a[4:7], v[104:107], v[100:103], a[4:7]
    ds_read_b64_tr_b16 v[170:171], v42 offset:4608
    v_mfma_f32_16x16x32_bf16 a[8:11], v[108:111], v[96:99], a[8:11]
    ds_read_b64_tr_b16 v[172:173], v43 offset:4096
    v_mfma_f32_16x16x32_bf16 a[12:15], v[108:111], v[100:103], a[12:15]
    ds_read_b64_tr_b16 v[174:175], v43 offset:4608
    v_mfma_f32_16x16x32_bf16 a[16:19], v[112:115], v[96:99], a[16:19]
    ds_read_b64_tr_b16 v[176:177], v42 offset:12288
    v_mfma_f32_16x16x32_bf16 a[20:23], v[112:115], v[100:103], a[20:23]
    ds_read_b64_tr_b16 v[178:179], v42 offset:12800
    v_mfma_f32_16x16x32_bf16 a[24:27], v[116:119], v[96:99], a[24:27]
    ds_read_b64_tr_b16 v[180:181], v43 offset:12288
    v_mfma_f32_16x16x32_bf16 a[28:31], v[116:119], v[100:103], a[28:31]
    ds_read_b64_tr_b16 v[182:183], v43 offset:12800
    v_mfma_f32_16x16x32_bf16 a[32:35], v[96:99], v[120:123], a[32:35]
    ds_read_b64_tr_b16 v[184:185], v42 offset:20480
    v_mfma_f32_16x16x32_bf16 a[36:39], v[100:103], v[120:123], a[36:39]
    ds_read_b64_tr_b16 v[186:187], v42 offset:20992
    v_mfma_f32_16x16x32_bf16 a[40:43], v[96:99], v[124:127], a[40:43]
    ds_read_b64_tr_b16 v[188:189], v43 offset:20480
    v_mfma_f32_16x16x32_bf16 a[44:47], v[100:103], v[124:127], a[44:47]
    ds_read_b64_tr_b16 v[190:191], v43 offset:20992
    s_waitcnt vmcnt(5) lgkmcnt(0)
    s_barrier
    v_mfma_f32_16x16x32_bf16 a[0:3], v[136:139], v[128:131], a[0:3]
    ds_read_b128 v[64:67], v20
    ds_read_b128 v[68:71], v20 offset:2048
    v_mfma_f32_16x16x32_bf16 a[4:7], v[136:139], v[132:135], a[4:7]
    ds_read_b64_tr_b16 v[72:73], v44
    ds_read_b64_tr_b16 v[74:75], v44 offset:512
    v_mfma_f32_16x16x32_bf16 a[8:11], v[140:143], v[128:131], a[8:11]
    ds_read_b64_tr_b16 v[76:77], v45
    ds_read_b64_tr_b16 v[78:79], v45 offset:512
    v_mfma_f32_16x16x32_bf16 a[12:15], v[140:143], v[132:135], a[12:15]
    ds_read_b64_tr_b16 v[80:81], v44 offset:8192
    ds_read_b64_tr_b16 v[82:83], v44 offset:8704
    v_mfma_f32_16x16x32_bf16 a[16:19], v[144:147], v[128:131], a[16:19]
    ds_read_b64_tr_b16 v[84:85], v45 offset:8192
    v_mfma_f32_16x16x32_bf16 a[20:23], v[144:147], v[132:135], a[20:23]
    ds_read_b64_tr_b16 v[86:87], v45 offset:8704
    v_mfma_f32_16x16x32_bf16 a[24:27], v[148:151], v[128:131], a[24:27]
    ds_read_b64_tr_b16 v[88:89], v44 offset:16384
    v_mfma_f32_16x16x32_bf16 a[28:31], v[148:151], v[132:135], a[28:31]
    ds_read_b64_tr_b16 v[90:91], v44 offset:16896
    v_mfma_f32_16x16x32_bf16 a[32:35], v[128:131], v[152:155], a[32:35]
    ds_read_b64_tr_b16 v[92:93], v45 offset:16384
    v_mfma_f32_16x16x32_bf16 a[36:39], v[132:135], v[152:155], a[36:39]
    ds_read_b64_tr_b16 v[94:95], v45 offset:16896
    v_mfma_f32_16x16x32_bf16 a[40:43], v[128:131], v[156:159], a[40:43]
    ds_read_b128 v[96:99], v21
    v_mfma_f32_16x16x32_bf16 a[44:47], v[132:135], v[156:159], a[44:47]
    ds_read_b128 v[100:103], v21 offset:2048
    v_mfma_f32_16x16x32_bf16 a[0:3], v[168:171], v[160:163], a[0:3]
    ds_read_b64_tr_b16 v[104:105], v44 offset:4096
    v_mfma_f32_16x16x32_bf16 a[4:7], v[168:171], v[164:167], a[4:7]
    ds_read_b64_tr_b16 v[106:107], v44 offset:4608
    v_mfma_f32_16x16x32_bf16 a[8:11], v[172:175], v[160:163], a[8:11]
    ds_read_b64_tr_b16 v[108:109], v45 offset:4096
    v_mfma_f32_16x16x32_bf16 a[12:15], v[172:175], v[164:167], a[12:15]
    ds_read_b64_tr_b16 v[110:111], v45 offset:4608
    v_mfma_f32_16x16x32_bf16 a[16:19], v[176:179], v[160:163], a[16:19]
    ds_read_b64_tr_b16 v[112:113], v44 offset:12288
    v_mfma_f32_16x16x32_bf16 a[20:23], v[176:179], v[164:167], a[20:23]
    ds_read_b64_tr_b16 v[114:115], v44 offset:12800
    v_mfma_f32_16x16x32_bf16 a[24:27], v[180:183], v[160:163], a[24:27]
    ds_read_b64_tr_b16 v[116:117], v45 offset:12288
    v_mfma_f32_16x16x32_bf16 a[28:31], v[180:183], v[164:167], a[28:31]
    ds_read_b64_tr_b16 v[118:119], v45 offset:12800
    v_mfma_f32_16x16x32_bf16 a[32:35], v[160:163], v[184:187], a[32:35]
    ds_read_b64_tr_b16 v[120:121], v44 offset:20480
    v_mfma_f32_16x16x32_bf16 a[36:39], v[164:167], v[184:187], a[36:39]
    ds_read_b64_tr_b16 v[122:123], v44 offset:20992
    v_mfma_f32_16x16x32_bf16 a[40:43], v[160:163], v[188:191], a[40:43]
    ds_read_b64_tr_b16 v[124:125], v45 offset:20480
    v_mfma_f32_16x16x32_bf16 a[44:47], v[164:167], v[188:191], a[44:47]
    ds_read_b64_tr_b16 v[126:127], v45 offset:20992
    s_waitcnt vmcnt(0) lgkmcnt(0)
    s_barrier
    v_mfma_f32_16x16x32_bf16 a[0:3], v[72:75], v[64:67], a[0:3]
    ds_read_b128 v[128:131], v22
    ds_read_b128 v[132:135], v22 offset:2048
    v_mfma_f32_16x16x32_bf16 a[4:7], v[72:75], v[68:71], a[4:7]
    ds_read_b64_tr_b16 v[136:137], v46
    ds_read_b64_tr_b16 v[138:139], v46 offset:512
    v_mfma_f32_16x16x32_bf16 a[8:11], v[76:79], v[64:67], a[8:11]
    ds_read_b64_tr_b16 v[140:141], v47
    ds_read_b64_tr_b16 v[142:143], v47 offset:512
    v_mfma_f32_16x16x32_bf16 a[12:15], v[76:79], v[68:71], a[12:15]
    ds_read_b64_tr_b16 v[144:145], v46 offset:8192
    ds_read_b64_tr_b16 v[146:147], v46 offset:8704
    v_mfma_f32_16x16x32_bf16 a[16:19], v[80:83], v[64:67], a[16:19]
    ds_read_b64_tr_b16 v[148:149], v47 offset:8192
    v_mfma_f32_16x16x32_bf16 a[20:23], v[80:83], v[68:71], a[20:23]
    ds_read_b64_tr_b16 v[150:151], v47 offset:8704
    v_mfma_f32_16x16x32_bf16 a[24:27], v[84:87], v[64:67], a[24:27]
    ds_read_b64_tr_b16 v[152:153], v46 offset:16384
    v_mfma_f32_16x16x32_bf16 a[28:31], v[84:87], v[68:71], a[28:31]
    ds_read_b64_tr_b16 v[154:155], v46 offset:16896
    v_mfma_f32_16x16x32_bf16 a[32:35], v[64:67], v[88:91], a[32:35]
    ds_read_b64_tr_b16 v[156:157], v47 offset:16384
    v_mfma_f32_16x16x32_bf16 a[36:39], v[68:71], v[88:91], a[36:39]
    ds_read_b64_tr_b16 v[158:159], v47 offset:16896
    v_mfma_f32_16x16x32_bf16 a[40:43], v[64:67], v[92:95], a[40:43]
    ds_read_b128 v[160:163], v23
    v_mfma_f32_16x16x32_bf16 a[44:47], v[68:71], v[92:95], a[44:47]
    ds_read_b128 v[164:167], v23 offset:2048
    v_mfma_f32_16x16x32_bf16 a[0:3], v[104:107], v[96:99], a[0:3]
    ds_read_b64_tr_b16 v[168:169], v46 offset:4096
    v_mfma_f32_16x16x32_bf16 a[4:7], v[104:107], v[100:103], a[4:7]
    ds_read_b64_tr_b16 v[170:171], v46 offset:4608
    v_mfma_f32_16x16x32_bf16 a[8:11], v[108:111], v[96:99], a[8:11]
    ds_read_b64_tr_b16 v[172:173], v47 offset:4096
    v_mfma_f32_16x16x32_bf16 a[12:15], v[108:111], v[100:103], a[12:15]
    ds_read_b64_tr_b16 v[174:175], v47 offset:4608
    v_mfma_f32_16x16x32_bf16 a[16:19], v[112:115], v[96:99], a[16:19]
    ds_read_b64_tr_b16 v[176:177], v46 offset:12288
    v_mfma_f32_16x16x32_bf16 a[20:23], v[112:115], v[100:103], a[20:23]
    ds_read_b64_tr_b16 v[178:179], v46 offset:12800
    v_mfma_f32_16x16x32_bf16 a[24:27], v[116:119], v[96:99], a[24:27]
    ds_read_b64_tr_b16 v[180:181], v47 offset:12288
    v_mfma_f32_16x16x32_bf16 a[28:31], v[116:119], v[100:103], a[28:31]
    ds_read_b64_tr_b16 v[182:183], v47 offset:12800
    v_mfma_f32_16x16x32_bf16 a[32:35], v[96:99], v[120:123], a[32:35]
    ds_read_b64_tr_b16 v[184:185], v46 offset:20480
    v_mfma_f32_16x16x32_bf16 a[36:39], v[100:103], v[120:123], a[36:39]
    ds_read_b64_tr_b16 v[186:187], v46 offset:20992
    v_mfma_f32_16x16x32_bf16 a[40:43], v[96:99], v[124:127], a[40:43]
    ds_read_b64_tr_b16 v[188:189], v47 offset:20480
    v_mfma_f32_16x16x32_bf16 a[44:47], v[100:103], v[124:127], a[44:47]
    ds_read_b64_tr_b16 v[190:191], v47 offset:20992
    s_waitcnt lgkmcnt(0)
    v_mfma_f32_16x16x32_bf16 a[0:3], v[136:139], v[128:131], a[0:3]
    v_mfma_f32_16x16x32_bf16 a[4:7], v[136:139], v[132:135], a[4:7]
    v_mfma_f32_16x16x32_bf16 a[8:11], v[140:143], v[128:131], a[8:11]
    v_mfma_f32_16x16x32_bf16 a[12:15], v[140:143], v[132:135], a[12:15]
    v_mfma_f32_16x16x32_bf16 a[16:19], v[144:147], v[128:131], a[16:19]
    v_mfma_f32_16x16x32_bf16 a[20:23], v[144:147], v[132:135], a[20:23]
    v_mfma_f32_16x16x32_bf16 a[24:27], v[148:151], v[128:131], a[24:27]
    v_mfma_f32_16x16x32_bf16 a[28:31], v[148:151], v[132:135], a[28:31]
    v_mfma_f32_16x16x32_bf16 a[32:35], v[128:131], v[152:155], a[32:35]
    v_mfma_f32_16x16x32_bf16 a[36:39], v[132:135], v[152:155], a[36:39]
    v_mfma_f32_16x16x32_bf16 a[40:43], v[128:131], v[156:159], a[40:43]
    v_mfma_f32_16x16x32_bf16 a[44:47], v[132:135], v[156:159], a[44:47]
    v_mfma_f32_16x16x32_bf16 a[0:3], v[168:171], v[160:163], a[0:3]
    v_mfma_f32_16x16x32_bf16 a[4:7], v[168:171], v[164:167], a[4:7]
    v_mfma_f32_16x16x32_bf16 a[8:11], v[172:175], v[160:163], a[8:11]
    v_mfma_f32_16x16x32_bf16 a[12:15], v[172:175], v[164:167], a[12:15]
    v_mfma_f32_16x16x32_bf16 a[16:19], v[176:179], v[160:163], a[16:19]
    v_mfma_f32_16x16x32_bf16 a[20:23], v[176:179], v[164:167], a[20:23]
    v_mfma_f32_16x16x32_bf16 a[24:27], v[180:183], v[160:163], a[24:27]
    v_mfma_f32_16x16x32_bf16 a[28:31], v[180:183], v[164:167], a[28:31]
    v_mfma_f32_16x16x32_bf16 a[32:35], v[160:163], v[184:187], a[32:35]
    v_mfma_f32_16x16x32_bf16 a[36:39], v[164:167], v[184:187], a[36:39]
    v_mfma_f32_16x16x32_bf16 a[40:43], v[160:163], v[188:191], a[40:43]
    v_mfma_f32_16x16x32_bf16 a[44:47], v[164:167], v[188:191], a[44:47]
    s_nop 11
    v_and_b32 v10, 15, v2
    v_lshrrev_b32 v11, 4, v2
    v_and_b32 v12, 1, v11
    v_lshlrev_b32 v12, 5, v12
    v_lshrrev_b32 v13, 1, v11
    v_lshl_add_u32 v12, v13, 4, v12
    s_lshl_b32 s9, s4, 1
    s_add_u32 s9, s9, s8
    s_lshl_b32 s10, s3, 7
    s_lshl_b32 s11, s7, 5
    s_add_u32 s10, s10, s11
    s_lshl_b32 s11, s9, 17
    s_add_u32 s60, s38, 8388608
    s_addc_u32 s61, s39, 0
    s_and_b32 s61, s61, 0xffff
    s_mov_b32 s62, 4194304
    s_mov_b32 s63, 0x00020000
    s_add_u32 s64, s38, 12582912
    s_addc_u32 s65, s39, 0
    s_and_b32 s65, s65, 0xffff
    s_mov_b32 s66, 4194304
    s_mov_b32 s67, 0x00020000
    s_add_u32 s68, s38, 16777216
    s_addc_u32 s69, s39, 0
    s_and_b32 s69, s69, 0xffff
    s_mov_b32 s70, 4194304
    s_mov_b32 s71, 0x00020000
    v_add_u32 v14, s10, v10
    v_lshlrev_b32 v14, 6, v14
    v_add_u32 v14, v14, v12
    v_add_u32 v14, s11, v14
    s_mov_b32 s12, 0x3e8293ee
    v_accvgpr_read_b32 v32, a0
    v_accvgpr_read_b32 v33, a1
    v_accvgpr_read_b32 v34, a2
    v_accvgpr_read_b32 v35, a3
    v_accvgpr_read_b32 v36, a8
    v_accvgpr_read_b32 v37, a9
    v_accvgpr_read_b32 v38, a10
    v_accvgpr_read_b32 v39, a11
    v_mul_f32 v32, s12, v32
    v_mul_f32 v33, s12, v33
    v_mul_f32 v34, s12, v34
    v_mul_f32 v35, s12, v35
    v_mul_f32 v36, s12, v36
    v_mul_f32 v37, s12, v37
    v_mul_f32 v38, s12, v38
    v_mul_f32 v39, s12, v39
    v_cvt_pk_bf16_f32 v40, v32, v33
    v_cvt_pk_bf16_f32 v41, v34, v35
    v_cvt_pk_bf16_f32 v42, v36, v37
    v_cvt_pk_bf16_f32 v43, v38, v39
    s_nop 0
    v_permlane16_swap_b32 v40, v42
    v_permlane16_swap_b32 v41, v43
    buffer_store_dwordx4 v[40:43], v14, s[60:63], 0 offen
    v_accvgpr_read_b32 v48, a4
    v_accvgpr_read_b32 v49, a5
    v_accvgpr_read_b32 v50, a6
    v_accvgpr_read_b32 v51, a7
    v_accvgpr_read_b32 v52, a12
    v_accvgpr_read_b32 v53, a13
    v_accvgpr_read_b32 v54, a14
    v_accvgpr_read_b32 v55, a15
    v_mul_f32 v48, s12, v48
    v_mul_f32 v49, s12, v49
    v_mul_f32 v50, s12, v50
    v_mul_f32 v51, s12, v51
    v_mul_f32 v52, s12, v52
    v_mul_f32 v53, s12, v53
    v_mul_f32 v54, s12, v54
    v_mul_f32 v55, s12, v55
    v_cvt_pk_bf16_f32 v56, v48, v49
    v_cvt_pk_bf16_f32 v57, v50, v51
    v_cvt_pk_bf16_f32 v58, v52, v53
    v_cvt_pk_bf16_f32 v59, v54, v55
    s_nop 0
    v_permlane16_swap_b32 v56, v58
    v_permlane16_swap_b32 v57, v59
    buffer_store_dwordx4 v[56:59], v14, s[60:63], 0 offen offset:1024
    v_accvgpr_read_b32 v64, a16
    v_accvgpr_read_b32 v65, a17
    v_accvgpr_read_b32 v66, a18
    v_accvgpr_read_b32 v67, a19
    v_accvgpr_read_b32 v68, a24
    v_accvgpr_read_b32 v69, a25
    v_accvgpr_read_b32 v70, a26
    v_accvgpr_read_b32 v71, a27
    v_cvt_pk_bf16_f32 v72, v64, v65
    v_cvt_pk_bf16_f32 v73, v66, v67
    v_cvt_pk_bf16_f32 v74, v68, v69
    v_cvt_pk_bf16_f32 v75, v70, v71
    s_nop 0
    v_permlane16_swap_b32 v72, v74
    v_permlane16_swap_b32 v73, v75
    buffer_store_dwordx4 v[72:75], v14, s[64:67], 0 offen
    v_accvgpr_read_b32 v80, a20
    v_accvgpr_read_b32 v81, a21
    v_accvgpr_read_b32 v82, a22
    v_accvgpr_read_b32 v83, a23
    v_accvgpr_read_b32 v84, a28
    v_accvgpr_read_b32 v85, a29
    v_accvgpr_read_b32 v86, a30
    v_accvgpr_read_b32 v87, a31
    v_cvt_pk_bf16_f32 v88, v80, v81
    v_cvt_pk_bf16_f32 v89, v82, v83
    v_cvt_pk_bf16_f32 v90, v84, v85
    v_cvt_pk_bf16_f32 v91, v86, v87
    s_nop 0
    v_permlane16_swap_b32 v88, v90
    v_permlane16_swap_b32 v89, v91
    buffer_store_dwordx4 v[88:91], v14, s[64:67], 0 offen offset:1024
    s_lshl_b32 s12, s10, 6
    s_add_u32 s12, s12, s11
    v_lshrrev_b32 v15, 1, v11
    v_lshlrev_b32 v15, 10, v15
    v_lshl_add_u32 v15, v10, 5, v15
    v_and_b32 v13, 1, v11
    v_lshl_add_u32 v15, v13, 4, v15
    v_add_u32 v15, s12, v15
    v_accvgpr_read_b32 v96, a32
    v_accvgpr_read_b32 v97, a33
    v_accvgpr_read_b32 v98, a34
    v_accvgpr_read_b32 v99, a35
    v_accvgpr_read_b32 v100, a36
    v_accvgpr_read_b32 v101, a37
    v_accvgpr_read_b32 v102, a38
    v_accvgpr_read_b32 v103, a39
    v_cvt_pk_bf16_f32 v104, v96, v97
    v_cvt_pk_bf16_f32 v105, v98, v99
    v_cvt_pk_bf16_f32 v106, v100, v101
    v_cvt_pk_bf16_f32 v107, v102, v103
    s_nop 0
    v_permlane32_swap_b32 v104, v106
    v_permlane32_swap_b32 v105, v107
    buffer_store_dwordx4 v[104:107], v15, s[68:71], 0 offen
    v_accvgpr_read_b32 v112, a40
    v_accvgpr_read_b32 v113, a41
    v_accvgpr_read_b32 v114, a42
    v_accvgpr_read_b32 v115, a43
    v_accvgpr_read_b32 v116, a44
    v_accvgpr_read_b32 v117, a45
    v_accvgpr_read_b32 v118, a46
    v_accvgpr_read_b32 v119, a47
    v_cvt_pk_bf16_f32 v120, v112, v113
    v_cvt_pk_bf16_f32 v121, v114, v115
    v_cvt_pk_bf16_f32 v122, v116, v117
    v_cvt_pk_bf16_f32 v123, v118, v119
    s_nop 0
    v_permlane32_swap_b32 v120, v122
    v_permlane32_swap_b32 v121, v123
    buffer_store_dwordx4 v[120:123], v15, s[68:71], 0 offen offset:512
    s_waitcnt vmcnt(0)
qkv_kernel_end:
    s_endpgm
.p2align 8
.globl attn_kernel
.type attn_kernel,@function
attn_kernel:
    s_cmp_ge_u32 s2, 256
    s_cbranch_scc1 attn_kernel_end
    s_load_dwordx16 s[16:31], s[0:1], 0
    s_load_dwordx8 s[32:39], s[0:1], 64
    s_and_b32 s3, s2, 7
    s_lshl_b32 s3, s3, 2
    s_bfe_u32 s4, s2, 0x20003
    s_add_u32 s3, s3, s4
    s_lshr_b32 s4, s2, 5
    v_lshrrev_b32 v1, 6, v0
    s_nop 0
    v_readfirstlane_b32 s6, v1
    v_and_b32 v2, 63, v0
    v_and_b32 v3, 31, v2
    v_lshrrev_b32 v4, 5, v2
    s_waitcnt lgkmcnt(0)
    s_lshl_b32 s7, s3, 17
    s_add_u32 s8, s7, 8388608
    s_add_u32 s40, s38, s8
    s_addc_u32 s41, s39, 0
    s_and_b32 s41, s41, 0xffff
    s_mov_b32 s42, 131072
    s_mov_b32 s43, 0x00020000
    s_add_u32 s8, s7, 12582912
    s_add_u32 s44, s38, s8
    s_addc_u32 s45, s39, 0
    s_and_b32 s45, s45, 0xffff
    s_mov_b32 s46, 131072
    s_mov_b32 s47, 0x00020000
    s_add_u32 s8, s7, 16777216
    s_add_u32 s48, s38, s8
    s_addc_u32 s49, s39, 0
    s_and_b32 s49, s49, 0xffff
    s_mov_b32 s50, 131072
    s_mov_b32 s51, 0x00020000
    s_add_u32 s52, s38, 20971520
    s_addc_u32 s53, s39, 0
    s_and_b32 s53, s53, 0xffff
    s_mov_b32 s54, 4194304
    s_mov_b32 s55, 0x00020000
    s_lshl_b32 s8, s4, 8
    s_lshl_b32 s9, s6, 5
    s_add_u32 s8, s8, s9
    v_add_u32 v5, s8, v3
    v_lshlrev_b32 v6, 6, v5
    v_lshl_add_u32 v6, v4, 4, v6
    buffer_load_dwordx4 v[16:19], v6, s[40:43], 0 offen
    buffer_load_dwordx4 v[20:23], v6, s[40:43], 0 offen offset:32
    v_lshrrev_b32 v7, 4, v2
    v_and_b32 v8, 3, v2
    v_xor_b32 v7, v7, v8
    v_lshrrev_b32 v8, 2, v2
    v_lshlrev_b32 v8, 6, v8
    v_lshl_add_u32 v8, v7, 4, v8
    s_lshl_b32 s9, s6, 10
    v_add_u32 v8, s9, v8
    v_add_u32 v9, 8192, v8
    v_lshrrev_b32 v10, 4, v2
    v_xor_b32 v10, v10, v2
    v_and_b32 v10, 1, v10
    v_lshrrev_b32 v11, 1, v2
    v_lshlrev_b32 v11, 5, v11
    v_lshl_add_u32 v10, v10, 4, v11
    v_add_u32 v10, s9, v10
    v_add_u32 v11, 8192, v10
    v_bfe_u32 v12, v3, 2, 2
    v_xor_b32 v12, v12, v4
    v_lshlrev_b32 v13, 6, v3
    v_lshl_add_u32 v12, v12, 4, v13
    v_xor_b32 v13, 32, v12
    v_bfe_u32 v14, v3, 3, 1
    v_xor_b32 v14, v14, v4
    v_lshlrev_b32 v15, 5, v3
    v_lshl_add_u32 v14, v14, 4, v15
    v_add_u32 v14, 16384, v14
    v_add_u32 v197, 65536, v12
    v_add_u32 v198, 65536, v13
    v_add_u32 v199, 65536, v14
    s_mov_b32 s10, 0
    s_mov_b32 s11, 0xff800000
    s_mov_b32 s12, 0xff800000
    s_mov_b32 s14, 0
    v_mov_b32 v56, 0x3f803f80
    v_mov_b32 v57, 0x3f803f80
    v_mov_b32 v58, 0x3f803f80
    v_mov_b32 v59, 0x3f803f80
    v_mov_b32 v76, 0
    v_mov_b32 v92, 0
    v_mov_b32 v108, 0
    v_mov_b32 v77, 0
    v_mov_b32 v93, 0
    v_mov_b32 v109, 0
    v_mov_b32 v78, 0
    v_mov_b32 v94, 0
    v_mov_b32 v110, 0
    v_mov_b32 v79, 0
    v_mov_b32 v95, 0
    v_mov_b32 v111, 0
    v_mov_b32 v80, 0
    v_mov_b32 v96, 0
    v_mov_b32 v112, 0
    v_mov_b32 v81, 0
    v_mov_b32 v97, 0
    v_mov_b32 v113, 0
    v_mov_b32 v82, 0
    v_mov_b32 v98, 0
    v_mov_b32 v114, 0
    v_mov_b32 v83, 0
    v_mov_b32 v99, 0
    v_mov_b32 v115, 0
    v_mov_b32 v84, 0
    v_mov_b32 v100, 0
    v_mov_b32 v116, 0
    v_mov_b32 v85, 0
    v_mov_b32 v101, 0
    v_mov_b32 v117, 0
    v_mov_b32 v86, 0
    v_mov_b32 v102, 0
    v_mov_b32 v118, 0
    v_mov_b32 v87, 0
    v_mov_b32 v103, 0
    v_mov_b32 v119, 0
    v_mov_b32 v88, 0
    v_mov_b32 v104, 0
    v_mov_b32 v120, 0
    v_mov_b32 v89, 0
    v_mov_b32 v105, 0
    v_mov_b32 v121, 0
    v_mov_b32 v90, 0
    v_mov_b32 v106, 0
    v_mov_b32 v122, 0
    v_mov_b32 v91, 0
    v_mov_b32 v107, 0
    v_mov_b32 v123, 0
    s_lshl_b32 s78, s2, 3
    s_add_u32 s78, s78, s6
    s_add_u32 s56, s20, 0
    s_addc_u32 s57, s21, 0
    s_and_b32 s57, s57, 0xffff
    s_mov_b32 s58, 2097152
    s_mov_b32 s59, 0x00020000
    s_mul_i32 s77, s78, 1024
    v_lshlrev_b32 v192, 7, v2
    v_add_u32 v192, s77, v192
    v_cmp_gt_u32 vcc, 8, v2
    v_mov_b32 v196, 0x7f000000
    s_nop 0
    v_cndmask_b32 v192, v196, v192, vcc
    s_add_u32 s60, s24, 0
    s_addc_u32 s61, s25, 0
    s_and_b32 s61, s61, 0xffff
    s_mov_b32 s62, 7340032
    s_mov_b32 s63, 0x00020000
    s_mul_i32 s77, s78, 3584
    v_lshlrev_b32 v193, 7, v2
    v_add_u32 v193, s77, v193
    v_cmp_gt_u32 vcc, 28, v2
    v_mov_b32 v196, 0x7f000000
    s_nop 0
    v_cndmask_b32 v193, v196, v193, vcc
    s_add_u32 s64, s26, 0
    s_addc_u32 s65, s27, 0
    s_and_b32 s65, s65, 0xffff
    s_mov_b32 s66, 7340032
    s_mov_b32 s67, 0x00020000
    s_mul_i32 s77, s78, 3584
    v_lshlrev_b32 v194, 7, v2
    v_add_u32 v194, s77, v194
    v_cmp_gt_u32 vcc, 28, v2
    v_mov_b32 v196, 0x7f000000
    s_nop 0
    v_cndmask_b32 v194, v196, v194, vcc
    s_add_u32 s68, s28, 0
    s_addc_u32 s69, s29, 0
    s_and_b32 s69, s69, 0xffff
    s_mov_b32 s70, 7340032
    s_mov_b32 s71, 0x00020000
    s_mul_i32 s77, s78, 3584
    v_lshlrev_b32 v195, 7, v2
    v_add_u32 v195, s77, v195
    v_cmp_gt_u32 vcc, 28, v2
    v_mov_b32 v196, 0x7f000000
    s_nop 0
    v_cndmask_b32 v195, v196, v195, vcc
    s_add_u32 m0, s9, 0
    s_nop 0
    buffer_load_dwordx4 v8, s[44:47], s10 offen lds
    s_add_u32 m0, s9, 8192
    s_nop 0
    buffer_load_dwordx4 v9, s[44:47], s10 offen lds
    s_add_u32 m0, s9, 16384
    s_nop 0
    buffer_load_dwordx4 v10, s[48:51], s10 offen lds
    s_add_u32 m0, s9, 24576
    s_nop 0
    buffer_load_dwordx4 v11, s[48:51], s10 offen lds
    s_add_u32 s10, s10, 16384
    s_add_u32 m0, s9, 32768
    s_nop 0
    buffer_load_dwordx4 v8, s[44:47], s10 offen lds
    s_add_u32 m0, s9, 40960
    s_nop 0
    buffer_load_dwordx4 v9, s[44:47], s10 offen lds
    s_add_u32 m0, s9, 49152
    s_nop 0
    buffer_load_dwordx4 v10, s[48:51], s10 offen lds
    s_add_u32 m0, s9, 57344
    s_nop 0
    buffer_load_dwordx4 v11, s[48:51], s10 offen lds
    s_add_u32 s10, s10, 16384
    s_waitcnt vmcnt(4)
    s_barrier
    ds_read_b128 v[24:27], v12
    ds_read_b128 v[28:31], v13
    ds_read_b128 v[32:35], v12 offset:2048
    ds_read_b128 v[36:39], v13 offset:2048
    s_waitcnt lgkmcnt(0)
    v_mfma_f32_32x32x16_bf16 v[124:139], v[24:27], v[16:19], v[108:123]
    v_mfma_f32_32x32x16_bf16 v[124:139], v[28:31], v[20:23], v[124:139]
    v_mfma_f32_32x32x16_bf16 v[140:155], v[32:35], v[16:19], v[108:123]
    v_mfma_f32_32x32x16_bf16 v[140:155], v[36:39], v[20:23], v[140:155]
    ds_read_b128 v[24:27], v12 offset:4096
    ds_read_b128 v[28:31], v13 offset:4096
    ds_read_b128 v[32:35], v12 offset:6144
    ds_read_b128 v[36:39], v13 offset:6144
    ds_read_b128 v[40:43], v14
    ds_read_b128 v[44:47], v14 offset:1024
    ds_read_b128 v[48:51], v14 offset:2048
    ds_read_b128 v[52:55], v14 offset:3072
    s_nop 1
    v_max3_f32 v188, v124, v125, v126
    v_max3_f32 v189, v127, v128, v129
    v_max3_f32 v188, v188, v130, v131
    v_max3_f32 v189, v189, v132, v133
    v_max3_f32 v188, v188, v134, v135
    v_max3_f32 v189, v189, v136, v137
    v_max3_f32 v188, v188, v138, v139
    v_max3_f32 v189, v189, v140, v141
    v_max3_f32 v188, v188, v142, v143
    v_max3_f32 v189, v189, v144, v145
    v_max3_f32 v188, v188, v146, v147
    v_max3_f32 v189, v189, v148, v149
    v_max3_f32 v188, v188, v150, v151
    v_max3_f32 v189, v189, v152, v153
    v_max3_f32 v188, v188, v154, v155
    v_max_f32 v188, v188, v189
    v_cmp_lt_f32 vcc, s11, v188
    s_cbranch_vccnz attn_rare0
attn_back0:
    s_waitcnt lgkmcnt(0)
    v_mfma_f32_32x32x16_bf16 v[156:171], v[24:27], v[16:19], v[108:123]
    v_exp_f32 v124, v124
    v_exp_f32 v125, v125
    v_exp_f32 v126, v126
    v_cvt_pk_bf16_f32 v60, v124, v125
    v_exp_f32 v127, v127
    v_exp_f32 v128, v128
    v_cvt_pk_bf16_f32 v61, v126, v127
    v_exp_f32 v129, v129
    v_exp_f32 v130, v130
    v_cvt_pk_bf16_f32 v62, v128, v129
    v_exp_f32 v131, v131
    v_exp_f32 v132, v132
    v_mfma_f32_32x32x16_bf16 v[156:171], v[28:31], v[20:23], v[156:171]
    v_cvt_pk_bf16_f32 v63, v130, v131
    v_exp_f32 v133, v133
    v_exp_f32 v134, v134
    v_cvt_pk_bf16_f32 v64, v132, v133
    v_exp_f32 v135, v135
    v_exp_f32 v136, v136
    v_cvt_pk_bf16_f32 v65, v134, v135
    v_exp_f32 v137, v137
    v_exp_f32 v138, v138
    v_cvt_pk_bf16_f32 v66, v136, v137
    v_exp_f32 v139, v139
    v_exp_f32 v140, v140
    v_mfma_f32_32x32x16_bf16 v[172:187], v[32:35], v[16:19], v[108:123]
    v_cvt_pk_bf16_f32 v67, v138, v139
    v_exp_f32 v141, v141
    v_exp_f32 v142, v142
    v_cvt_pk_bf16_f32 v68, v140, v141
    v_exp_f32 v143, v143
    v_exp_f32 v144, v144
    v_cvt_pk_bf16_f32 v69, v142, v143
    v_exp_f32 v145, v145
    v_exp_f32 v146, v146
    v_cvt_pk_bf16_f32 v70, v144, v145
    v_exp_f32 v147, v147
    v_exp_f32 v148, v148
    v_mfma_f32_32x32x16_bf16 v[172:187], v[36:39], v[20:23], v[172:187]
    v_cvt_pk_bf16_f32 v71, v146, v147
    v_exp_f32 v149, v149
    v_exp_f32 v150, v150
    v_cvt_pk_bf16_f32 v72, v148, v149
    v_exp_f32 v151, v151
    v_exp_f32 v152, v152
    v_cvt_pk_bf16_f32 v73, v150, v151
    v_exp_f32 v153, v153
    v_exp_f32 v154, v154
    v_cvt_pk_bf16_f32 v74, v152, v153
    v_exp_f32 v155, v155
    s_nop 0
    v_cvt_pk_bf16_f32 v75, v154, v155
    ds_read_b128 v[24:27], v12 offset:8192
    ds_read_b128 v[28:31], v13 offset:8192
    ds_read_b128 v[32:35], v12 offset:10240
    ds_read_b128 v[36:39], v13 offset:10240
    s_mov_b32 s14, 0
    s_mov_b32 s13, 2
attn_loop:
    s_nop 15
    s_waitcnt lgkmcnt(4)
    v_mfma_f32_32x32x16_bf16 v[76:91], v[40:43], v[60:63], v[76:91]
    v_max3_f32 v188, v156, v157, v158
    v_max3_f32 v189, v159, v160, v161
    v_max3_f32 v188, v188, v162, v163
    v_max3_f32 v189, v189, v164, v165
    v_max3_f32 v188, v188, v166, v167
    v_max3_f32 v189, v189, v168, v169
    v_mfma_f32_32x32x16_bf16 v[92:107], v[56:59], v[60:63], v[92:107]
    v_max3_f32 v188, v188, v170, v171
    v_max3_f32 v189, v189, v172, v173
    v_max3_f32 v188, v188, v174, v175
    v_max3_f32 v189, v189, v176, v177
    v_max3_f32 v188, v188, v178, v179
    v_max3_f32 v189, v189, v180, v181
    v_mfma_f32_32x32x16_bf16 v[76:91], v[44:47], v[64:67], v[76:91]
    v_max3_f32 v188, v188, v182, v183
    v_max3_f32 v189, v189, v184, v185
    v_max3_f32 v188, v188, v186, v187
    v_max_f32 v188, v188, v189
    v_cmp_lt_f32 vcc, s11, v188
    s_cbranch_vccnz attn_rare1
attn_back1:
    s_waitcnt lgkmcnt(0)
    v_mfma_f32_32x32x16_bf16 v[92:107], v[56:59], v[64:67], v[92:107]
    v_exp_f32 v156, v156
    v_exp_f32 v157, v157
    v_exp_f32 v158, v158
    v_cvt_pk_bf16_f32 v200, v156, v157
    v_exp_f32 v159, v159
    v_mfma_f32_32x32x16_bf16 v[76:91], v[48:51], v[68:71], v[76:91]
    v_exp_f32 v160, v160
    v_cvt_pk_bf16_f32 v201, v158, v159
    v_exp_f32 v161, v161
    v_exp_f32 v162, v162
    v_cvt_pk_bf16_f32 v202, v160, v161
    v_mfma_f32_32x32x16_bf16 v[92:107], v[56:59], v[68:71], v[92:107]
    v_exp_f32 v163, v163
    v_exp_f32 v164, v164
    v_cvt_pk_bf16_f32 v203, v162, v163
    v_exp_f32 v165, v165
    v_exp_f32 v166, v166
    v_cvt_pk_bf16_f32 v204, v164, v165
    v_mfma_f32_32x32x16_bf16 v[76:91], v[52:55], v[72:75], v[76:91]
    v_exp_f32 v167, v167
    v_exp_f32 v168, v168
    v_cvt_pk_bf16_f32 v205, v166, v167
    v_exp_f32 v169, v169
    v_exp_f32 v170, v170
    v_mfma_f32_32x32x16_bf16 v[92:107], v[56:59], v[72:75], v[92:107]
    ds_read_b128 v[40:43], v14 offset:4096
    ds_read_b128 v[44:47], v14 offset:5120
    ds_read_b128 v[48:51], v14 offset:6144
    ds_read_b128 v[52:55], v14 offset:7168
    v_cvt_pk_bf16_f32 v206, v168, v169
    v_exp_f32 v171, v171
    v_exp_f32 v172, v172
    v_cvt_pk_bf16_f32 v207, v170, v171
    v_exp_f32 v173, v173
    v_mfma_f32_32x32x16_bf16 v[124:139], v[24:27], v[16:19], v[108:123]
    v_exp_f32 v174, v174
    v_cvt_pk_bf16_f32 v208, v172, v173
    v_exp_f32 v175, v175
    v_exp_f32 v176, v176
    v_cvt_pk_bf16_f32 v209, v174, v175
    v_exp_f32 v177, v177
    v_mfma_f32_32x32x16_bf16 v[124:139], v[28:31], v[20:23], v[124:139]
    v_exp_f32 v178, v178
    v_cvt_pk_bf16_f32 v210, v176, v177
    v_exp_f32 v179, v179
    v_exp_f32 v180, v180
    v_cvt_pk_bf16_f32 v211, v178, v179
    v_mfma_f32_32x32x16_bf16 v[140:155], v[32:35], v[16:19], v[108:123]
    v_exp_f32 v181, v181
    v_exp_f32 v182, v182
    v_cvt_pk_bf16_f32 v212, v180, v181
    v_exp_f32 v183, v183
    v_exp_f32 v184, v184
    v_mfma_f32_32x32x16_bf16 v[140:155], v[36:39], v[20:23], v[140:155]
    v_cvt_pk_bf16_f32 v213, v182, v183
    v_exp_f32 v185, v185
    v_exp_f32 v186, v186
    v_cvt_pk_bf16_f32 v214, v184, v185
    v_exp_f32 v187, v187
    s_nop 0
    v_cvt_pk_bf16_f32 v215, v186, v187
    ds_read_b128 v[24:27], v12 offset:12288
    ds_read_b128 v[28:31], v13 offset:12288
    ds_read_b128 v[32:35], v12 offset:14336
    ds_read_b128 v[36:39], v13 offset:14336
    s_cmp_eq_u32 s14, 0
    s_cbranch_scc0 attn_fix1
attn_fixb1:
    s_waitcnt vmcnt(0)
    s_barrier
    s_add_u32 m0, s9, 65536
    s_nop 0
    buffer_load_dwordx4 v8, s[44:47], s10 offen lds
    s_add_u32 m0, s9, 73728
    s_nop 0
    buffer_load_dwordx4 v9, s[44:47], s10 offen lds
    s_add_u32 m0, s9, 81920
    s_nop 0
    buffer_load_dwordx4 v10, s[48:51], s10 offen lds
    s_add_u32 m0, s9, 90112
    s_nop 0
    buffer_load_dwordx4 v11, s[48:51], s10 offen lds
    s_add_u32 s10, s10, 16384
    s_cmp_lg_u32 s13, 2
    s_cbranch_scc1 attn_nt0
    buffer_load_dword v196, v192, s[56:59], 0 offen
attn_nt0:
    s_waitcnt lgkmcnt(4)
    v_mfma_f32_32x32x16_bf16 v[76:91], v[40:43], v[200:203], v[76:91]
    v_max3_f32 v188, v124, v125, v126
    v_max3_f32 v189, v127, v128, v129
    v_max3_f32 v188, v188, v130, v131
    v_max3_f32 v189, v189, v132, v133
    v_max3_f32 v188, v188, v134, v135
    v_max3_f32 v189, v189, v136, v137
    v_mfma_f32_32x32x16_bf16 v[92:107], v[56:59], v[200:203], v[92:107]
    v_max3_f32 v188, v188, v138, v139
    v_max3_f32 v189, v189, v140, v141
    v_max3_f32 v188, v188, v142, v143
    v_max3_f32 v189, v189, v144, v145
    v_max3_f32 v188, v188, v146, v147
    v_max3_f32 v189, v189, v148, v149
    v_mfma_f32_32x32x16_bf16 v[76:91], v[44:47], v[204:207], v[76:91]
    v_max3_f32 v188, v188, v150, v151
    v_max3_f32 v189, v189, v152, v153
    v_max3_f32 v188, v188, v154, v155
    v_max_f32 v188, v188, v189
    v_cmp_lt_f32 vcc, s11, v188
    s_cbranch_vccnz attn_rare2
attn_back2:
    s_waitcnt lgkmcnt(0)
    v_mfma_f32_32x32x16_bf16 v[92:107], v[56:59], v[204:207], v[92:107]
    v_exp_f32 v124, v124
    v_exp_f32 v125, v125
    v_exp_f32 v126, v126
    v_cvt_pk_bf16_f32 v60, v124, v125
    v_exp_f32 v127, v127
    v_mfma_f32_32x32x16_bf16 v[76:91], v[48:51], v[208:211], v[76:91]
    v_exp_f32 v128, v128
    v_cvt_pk_bf16_f32 v61, v126, v127
    v_exp_f32 v129, v129
    v_exp_f32 v130, v130
    v_cvt_pk_bf16_f32 v62, v128, v129
    v_mfma_f32_32x32x16_bf16 v[92:107], v[56:59], v[208:211], v[92:107]
    v_exp_f32 v131, v131
    v_exp_f32 v132, v132
    v_cvt_pk_bf16_f32 v63, v130, v131
    v_exp_f32 v133, v133
    v_exp_f32 v134, v134
    v_cvt_pk_bf16_f32 v64, v132, v133
    v_mfma_f32_32x32x16_bf16 v[76:91], v[52:55], v[212:215], v[76:91]
    v_exp_f32 v135, v135
    v_exp_f32 v136, v136
    v_cvt_pk_bf16_f32 v65, v134, v135
    v_exp_f32 v137, v137
    v_exp_f32 v138, v138
    v_mfma_f32_32x32x16_bf16 v[92:107], v[56:59], v[212:215], v[92:107]
    ds_read_b128 v[40:43], v14 offset:8192
    ds_read_b128 v[44:47], v14 offset:9216
    ds_read_b128 v[48:51], v14 offset:10240
    ds_read_b128 v[52:55], v14 offset:11264
    v_cvt_pk_bf16_f32 v66, v136, v137
    v_exp_f32 v139, v139
    v_exp_f32 v140, v140
    v_cvt_pk_bf16_f32 v67, v138, v139
    v_exp_f32 v141, v141
    v_mfma_f32_32x32x16_bf16 v[156:171], v[24:27], v[16:19], v[108:123]
    v_exp_f32 v142, v142
    v_cvt_pk_bf16_f32 v68, v140, v141
    v_exp_f32 v143, v143
    v_exp_f32 v144, v144
    v_cvt_pk_bf16_f32 v69, v142, v143
    v_exp_f32 v145, v145
    v_mfma_f32_32x32x16_bf16 v[156:171], v[28:31], v[20:23], v[156:171]
    v_exp_f32 v146, v146
    v_cvt_pk_bf16_f32 v70, v144, v145
    v_exp_f32 v147, v147
    v_exp_f32 v148, v148
    v_cvt_pk_bf16_f32 v71, v146, v147
    v_mfma_f32_32x32x16_bf16 v[172:187], v[32:35], v[16:19], v[108:123]
    v_exp_f32 v149, v149
    v_exp_f32 v150, v150
    v_cvt_pk_bf16_f32 v72, v148, v149
    v_exp_f32 v151, v151
    v_exp_f32 v152, v152
    v_mfma_f32_32x32x16_bf16 v[172:187], v[36:39], v[20:23], v[172:187]
    v_cvt_pk_bf16_f32 v73, v150, v151
    v_exp_f32 v153, v153
    v_exp_f32 v154, v154
    v_cvt_pk_bf16_f32 v74, v152, v153
    v_exp_f32 v155, v155
    s_nop 0
    v_cvt_pk_bf16_f32 v75, v154, v155
    ds_read_b128 v[24:27], v12 offset:32768
    ds_read_b128 v[28:31], v13 offset:32768
    ds_read_b128 v[32:35], v12 offset:34816
    ds_read_b128 v[36:39], v13 offset:34816
    s_cmp_eq_u32 s14, 0
    s_cbranch_scc0 attn_fix2
attn_fixb2:
    s_waitcnt lgkmcnt(4)
    v_mfma_f32_32x32x16_bf16 v[76:91], v[40:43], v[60:63], v[76:91]
    v_max3_f32 v188, v156, v157, v158
    v_max3_f32 v189, v159, v160, v161
    v_max3_f32 v188, v188, v162, v163
    v_max3_f32 v189, v189, v164, v165
    v_max3_f32 v188, v188, v166, v167
    v_max3_f32 v189, v189, v168, v169
    v_mfma_f32_32x32x16_bf16 v[92:107], v[56:59], v[60:63], v[92:107]
    v_max3_f32 v188, v188, v170, v171
    v_max3_f32 v189, v189, v172, v173
    v_max3_f32 v188, v188, v174, v175
    v_max3_f32 v189, v189, v176, v177
    v_max3_f32 v188, v188, v178, v179
    v_max3_f32 v189, v189, v180, v181
    v_mfma_f32_32x32x16_bf16 v[76:91], v[44:47], v[64:67], v[76:91]
    v_max3_f32 v188, v188, v182, v183
    v_max3_f32 v189, v189, v184, v185
    v_max3_f32 v188, v188, v186, v187
    v_max_f32 v188, v188, v189
    v_cmp_lt_f32 vcc, s11, v188
    s_cbranch_vccnz attn_rare3
attn_back3:
    s_waitcnt lgkmcnt(0)
    v_mfma_f32_32x32x16_bf16 v[92:107], v[56:59], v[64:67], v[92:107]
    v_exp_f32 v156, v156
    v_exp_f32 v157, v157
    v_exp_f32 v158, v158
    v_cvt_pk_bf16_f32 v200, v156, v157
    v_exp_f32 v159, v159
    v_mfma_f32_32x32x16_bf16 v[76:91], v[48:51], v[68:71], v[76:91]
    v_exp_f32 v160, v160
    v_cvt_pk_bf16_f32 v201, v158, v159
    v_exp_f32 v161, v161
    v_exp_f32 v162, v162
    v_cvt_pk_bf16_f32 v202, v160, v161
    v_mfma_f32_32x32x16_bf16 v[92:107], v[56:59], v[68:71], v[92:107]
    v_exp_f32 v163, v163
    v_exp_f32 v164, v164
    v_cvt_pk_bf16_f32 v203, v162, v163
    v_exp_f32 v165, v165
    v_exp_f32 v166, v166
    v_cvt_pk_bf16_f32 v204, v164, v165
    v_mfma_f32_32x32x16_bf16 v[76:91], v[52:55], v[72:75], v[76:91]
    v_exp_f32 v167, v167
    v_exp_f32 v168, v168
    v_cvt_pk_bf16_f32 v205, v166, v167
    v_exp_f32 v169, v169
    v_exp_f32 v170, v170
    v_mfma_f32_32x32x16_bf16 v[92:107], v[56:59], v[72:75], v[92:107]
    ds_read_b128 v[40:43], v14 offset:12288
    ds_read_b128 v[44:47], v14 offset:13312
    ds_read_b128 v[48:51], v14 offset:14336
    ds_read_b128 v[52:55], v14 offset:15360
    v_cvt_pk_bf16_f32 v206, v168, v169
    v_exp_f32 v171, v171
    v_exp_f32 v172, v172
    v_cvt_pk_bf16_f32 v207, v170, v171
    v_exp_f32 v173, v173
    v_mfma_f32_32x32x16_bf16 v[124:139], v[24:27], v[16:19], v[108:123]
    v_exp_f32 v174, v174
    v_cvt_pk_bf16_f32 v208, v172, v173
    v_exp_f32 v175, v175
    v_exp_f32 v176, v176
    v_cvt_pk_bf16_f32 v209, v174, v175
    v_exp_f32 v177, v177
    v_mfma_f32_32x32x16_bf16 v[124:139], v[28:31], v[20:23], v[124:139]
    v_exp_f32 v178, v178
    v_cvt_pk_bf16_f32 v210, v176, v177
    v_exp_f32 v179, v179
    v_exp_f32 v180, v180
    v_cvt_pk_bf16_f32 v211, v178, v179
    v_mfma_f32_32x32x16_bf16 v[140:155], v[32:35], v[16:19], v[108:123]
    v_exp_f32 v181, v181
    v_exp_f32 v182, v182
    v_cvt_pk_bf16_f32 v212, v180, v181
    v_exp_f32 v183, v183
    v_exp_f32 v184, v184
    v_mfma_f32_32x32x16_bf16 v[140:155], v[36:39], v[20:23], v[140:155]
    v_cvt_pk_bf16_f32 v213, v182, v183
    v_exp_f32 v185, v185
    v_exp_f32 v186, v186
    v_cvt_pk_bf16_f32 v214, v184, v185
    v_exp_f32 v187, v187
    s_nop 0
    v_cvt_pk_bf16_f32 v215, v186, v187
    ds_read_b128 v[24:27], v12 offset:36864
    ds_read_b128 v[28:31], v13 offset:36864
    ds_read_b128 v[32:35], v12 offset:38912
    ds_read_b128 v[36:39], v13 offset:38912
    s_cmp_eq_u32 s14, 0
    s_cbranch_scc0 attn_fix3
attn_fixb3:
    s_waitcnt lgkmcnt(4)
    v_mfma_f32_32x32x16_bf16 v[76:91], v[40:43], v[200:203], v[76:91]
    v_max3_f32 v188, v124, v125, v126
    v_max3_f32 v189, v127, v128, v129
    v_max3_f32 v188, v188, v130, v131
    v_max3_f32 v189, v189, v132, v133
    v_max3_f32 v188, v188, v134, v135
    v_max3_f32 v189, v189, v136, v137
    v_mfma_f32_32x32x16_bf16 v[92:107], v[56:59], v[200:203], v[92:107]
    v_max3_f32 v188, v188, v138, v139
    v_max3_f32 v189, v189, v140, v141
    v_max3_f32 v188, v188, v142, v143
    v_max3_f32 v189, v189, v144, v145
    v_max3_f32 v188, v188, v146, v147
    v_max3_f32 v189, v189, v148, v149
    v_mfma_f32_32x32x16_bf16 v[76:91], v[44:47], v[204:207], v[76:91]
    v_max3_f32 v188, v188, v150, v151
    v_max3_f32 v189, v189, v152, v153
    v_max3_f32 v188, v188, v154, v155
    v_max_f32 v188, v188, v189
    v_cmp_lt_f32 vcc, s11, v188
    s_cbranch_vccnz attn_rare4
attn_back4:
    s_waitcnt lgkmcnt(0)
    v_mfma_f32_32x32x16_bf16 v[92:107], v[56:59], v[204:207], v[92:107]
    v_exp_f32 v124, v124
    v_exp_f32 v125, v125
    v_exp_f32 v126, v126
    v_cvt_pk_bf16_f32 v60, v124, v125
    v_exp_f32 v127, v127
    v_mfma_f32_32x32x16_bf16 v[76:91], v[48:51], v[208:211], v[76:91]
    v_exp_f32 v128, v128
    v_cvt_pk_bf16_f32 v61, v126, v127
    v_exp_f32 v129, v129
    v_exp_f32 v130, v130
    v_cvt_pk_bf16_f32 v62, v128, v129
    v_mfma_f32_32x32x16_bf16 v[92:107], v[56:59], v[208:211], v[92:107]
    v_exp_f32 v131, v131
    v_exp_f32 v132, v132
    v_cvt_pk_bf16_f32 v63, v130, v131
    v_exp_f32 v133, v133
    v_exp_f32 v134, v134
    v_cvt_pk_bf16_f32 v64, v132, v133
    v_mfma_f32_32x32x16_bf16 v[76:91], v[52:55], v[212:215], v[76:91]
    v_exp_f32 v135, v135
    v_exp_f32 v136, v136
    v_cvt_pk_bf16_f32 v65, v134, v135
    v_exp_f32 v137, v137
    v_exp_f32 v138, v138
    v_mfma_f32_32x32x16_bf16 v[92:107], v[56:59], v[212:215], v[92:107]
    ds_read_b128 v[40:43], v14 offset:32768
    ds_read_b128 v[44:47], v14 offset:33792
    ds_read_b128 v[48:51], v14 offset:34816
    ds_read_b128 v[52:55], v14 offset:35840
    v_cvt_pk_bf16_f32 v66, v136, v137
    v_exp_f32 v139, v139
    v_exp_f32 v140, v140
    v_cvt_pk_bf16_f32 v67, v138, v139
    v_exp_f32 v141, v141
    v_mfma_f32_32x32x16_bf16 v[156:171], v[24:27], v[16:19], v[108:123]
    v_exp_f32 v142, v142
    v_cvt_pk_bf16_f32 v68, v140, v141
    v_exp_f32 v143, v143
    v_exp_f32 v144, v144
    v_cvt_pk_bf16_f32 v69, v142, v143
    v_exp_f32 v145, v145
    v_mfma_f32_32x32x16_bf16 v[156:171], v[28:31], v[20:23], v[156:171]
    v_exp_f32 v146, v146
    v_cvt_pk_bf16_f32 v70, v144, v145
    v_exp_f32 v147, v147
    v_exp_f32 v148, v148
    v_cvt_pk_bf16_f32 v71, v146, v147
    v_mfma_f32_32x32x16_bf16 v[172:187], v[32:35], v[16:19], v[108:123]
    v_exp_f32 v149, v149
    v_exp_f32 v150, v150
    v_cvt_pk_bf16_f32 v72, v148, v149
    v_exp_f32 v151, v151
    v_exp_f32 v152, v152
    v_mfma_f32_32x32x16_bf16 v[172:187], v[36:39], v[20:23], v[172:187]
    v_cvt_pk_bf16_f32 v73, v150, v151
    v_exp_f32 v153, v153
    v_exp_f32 v154, v154
    v_cvt_pk_bf16_f32 v74, v152, v153
    v_exp_f32 v155, v155
    s_nop 0
    v_cvt_pk_bf16_f32 v75, v154, v155
    ds_read_b128 v[24:27], v12 offset:40960
    ds_read_b128 v[28:31], v13 offset:40960
    ds_read_b128 v[32:35], v12 offset:43008
    ds_read_b128 v[36:39], v13 offset:43008
    s_cmp_eq_u32 s14, 0
    s_cbranch_scc0 attn_fix4
attn_fixb4:
    s_waitcnt lgkmcnt(4)
    v_mfma_f32_32x32x16_bf16 v[76:91], v[40:43], v[60:63], v[76:91]
    v_max3_f32 v188, v156, v157, v158
    v_max3_f32 v189, v159, v160, v161
    v_max3_f32 v188, v188, v162, v163
    v_max3_f32 v189, v189, v164, v165
    v_max3_f32 v188, v188, v166, v167
    v_max3_f32 v189, v189, v168, v169
    v_mfma_f32_32x32x16_bf16 v[92:107], v[56:59], v[60:63], v[92:107]
    v_max3_f32 v188, v188, v170, v171
    v_max3_f32 v189, v189, v172, v173
    v_max3_f32 v188, v188, v174, v175
    v_max3_f32 v189, v189, v176, v177
    v_max3_f32 v188, v188, v178, v179
    v_max3_f32 v189, v189, v180, v181
    v_mfma_f32_32x32x16_bf16 v[76:91], v[44:47], v[64:67], v[76:91]
    v_max3_f32 v188, v188, v182, v183
    v_max3_f32 v189, v189, v184, v185
    v_max3_f32 v188, v188, v186, v187
    v_max_f32 v188, v188, v189
    v_cmp_lt_f32 vcc, s11, v188
    s_cbranch_vccnz attn_rare5
attn_back5:
    s_waitcnt lgkmcnt(0)
    v_mfma_f32_32x32x16_bf16 v[92:107], v[56:59], v[64:67], v[92:107]
    v_exp_f32 v156, v156
    v_exp_f32 v157, v157
    v_exp_f32 v158, v158
    v_cvt_pk_bf16_f32 v200, v156, v157
    v_exp_f32 v159, v159
    v_mfma_f32_32x32x16_bf16 v[76:91], v[48:51], v[68:71], v[76:91]
    v_exp_f32 v160, v160
    v_cvt_pk_bf16_f32 v201, v158, v159
    v_exp_f32 v161, v161
    v_exp_f32 v162, v162
    v_cvt_pk_bf16_f32 v202, v160, v161
    v_mfma_f32_32x32x16_bf16 v[92:107], v[56:59], v[68:71], v[92:107]
    v_exp_f32 v163, v163
    v_exp_f32 v164, v164
    v_cvt_pk_bf16_f32 v203, v162, v163
    v_exp_f32 v165, v165
    v_exp_f32 v166, v166
    v_cvt_pk_bf16_f32 v204, v164, v165
    v_mfma_f32_32x32x16_bf16 v[76:91], v[52:55], v[72:75], v[76:91]
    v_exp_f32 v167, v167
    v_exp_f32 v168, v168
    v_cvt_pk_bf16_f32 v205, v166, v167
    v_exp_f32 v169, v169
    v_exp_f32 v170, v170
    v_mfma_f32_32x32x16_bf16 v[92:107], v[56:59], v[72:75], v[92:107]
    ds_read_b128 v[40:43], v14 offset:36864
    ds_read_b128 v[44:47], v14 offset:37888
    ds_read_b128 v[48:51], v14 offset:38912
    ds_read_b128 v[52:55], v14 offset:39936
    v_cvt_pk_bf16_f32 v206, v168, v169
    v_exp_f32 v171, v171
    v_exp_f32 v172, v172
    v_cvt_pk_bf16_f32 v207, v170, v171
    v_exp_f32 v173, v173
    v_mfma_f32_32x32x16_bf16 v[124:139], v[24:27], v[16:19], v[108:123]
    v_exp_f32 v174, v174
    v_cvt_pk_bf16_f32 v208, v172, v173
    v_exp_f32 v175, v175
    v_exp_f32 v176, v176
    v_cvt_pk_bf16_f32 v209, v174, v175
    v_exp_f32 v177, v177
    v_mfma_f32_32x32x16_bf16 v[124:139], v[28:31], v[20:23], v[124:139]
    v_exp_f32 v178, v178
    v_cvt_pk_bf16_f32 v210, v176, v177
    v_exp_f32 v179, v179
    v_exp_f32 v180, v180
    v_cvt_pk_bf16_f32 v211, v178, v179
    v_mfma_f32_32x32x16_bf16 v[140:155], v[32:35], v[16:19], v[108:123]
    v_exp_f32 v181, v181
    v_exp_f32 v182, v182
    v_cvt_pk_bf16_f32 v212, v180, v181
    v_exp_f32 v183, v183
    v_exp_f32 v184, v184
    v_mfma_f32_32x32x16_bf16 v[140:155], v[36:39], v[20:23], v[140:155]
    v_cvt_pk_bf16_f32 v213, v182, v183
    v_exp_f32 v185, v185
    v_exp_f32 v186, v186
    v_cvt_pk_bf16_f32 v214, v184, v185
    v_exp_f32 v187, v187
    s_nop 0
    v_cvt_pk_bf16_f32 v215, v186, v187
    ds_read_b128 v[24:27], v12 offset:45056
    ds_read_b128 v[28:31], v13 offset:45056
    ds_read_b128 v[32:35], v12 offset:47104
    ds_read_b128 v[36:39], v13 offset:47104
    s_cmp_eq_u32 s14, 0
    s_cbranch_scc0 attn_fix5
attn_fixb5:
    s_waitcnt vmcnt(0)
    s_barrier
    s_add_u32 m0, s9, 0
    s_nop 0
    buffer_load_dwordx4 v8, s[44:47], s10 offen lds
    s_add_u32 m0, s9, 8192
    s_nop 0
    buffer_load_dwordx4 v9, s[44:47], s10 offen lds
    s_add_u32 m0, s9, 16384
    s_nop 0
    buffer_load_dwordx4 v10, s[48:51], s10 offen lds
    s_add_u32 m0, s9, 24576
    s_nop 0
    buffer_load_dwordx4 v11, s[48:51], s10 offen lds
    s_add_u32 s10, s10, 16384
    s_cmp_lg_u32 s13, 2
    s_cbranch_scc1 attn_nt1
    buffer_load_dword v196, v193, s[60:63], 0 offen
attn_nt1:
    s_waitcnt lgkmcnt(4)
    v_mfma_f32_32x32x16_bf16 v[76:91], v[40:43], v[200:203], v[76:91]
    v_max3_f32 v188, v124, v125, v126
    v_max3_f32 v189, v127, v128, v129
    v_max3_f32 v188, v188, v130, v131
    v_max3_f32 v189, v189, v132, v133
    v_max3_f32 v188, v188, v134, v135
    v_max3_f32 v189, v189, v136, v137
    v_mfma_f32_32x32x16_bf16 v[92:107], v[56:59], v[200:203], v[92:107]
    v_max3_f32 v188, v188, v138, v139
    v_max3_f32 v189, v189, v140, v141
    v_max3_f32 v188, v188, v142, v143
    v_max3_f32 v189, v189, v144, v145
    v_max3_f32 v188, v188, v146, v147
    v_max3_f32 v189, v189, v148, v149
    v_mfma_f32_32x32x16_bf16 v[76:91], v[44:47], v[204:207], v[76:91]
    v_max3_f32 v188, v188, v150, v151
    v_max3_f32 v189, v189, v152, v153
    v_max3_f32 v188, v188, v154, v155
    v_max_f32 v188, v188, v189
    v_cmp_lt_f32 vcc, s11, v188
    s_cbranch_vccnz attn_rare6
attn_back6:
    s_waitcnt lgkmcnt(0)
    v_mfma_f32_32x32x16_bf16 v[92:107], v[56:59], v[204:207], v[92:107]
    v_exp_f32 v124, v124
    v_exp_f32 v125, v125
    v_exp_f32 v126, v126
    v_cvt_pk_bf16_f32 v60, v124, v125
    v_exp_f32 v127, v127
    v_mfma_f32_32x32x16_bf16 v[76:91], v[48:51], v[208:211], v[76:91]
    v_exp_f32 v128, v128
    v_cvt_pk_bf16_f32 v61, v126, v127
    v_exp_f32 v129, v129
    v_exp_f32 v130, v130
    v_cvt_pk_bf16_f32 v62, v128, v129
    v_mfma_f32_32x32x16_bf16 v[92:107], v[56:59], v[208:211], v[92:107]
    v_exp_f32 v131, v131
    v_exp_f32 v132, v132
    v_cvt_pk_bf16_f32 v63, v130, v131
    v_exp_f32 v133, v133
    v_exp_f32 v134, v134
    v_cvt_pk_bf16_f32 v64, v132, v133
    v_mfma_f32_32x32x16_bf16 v[76:91], v[52:55], v[212:215], v[76:91]
    v_exp_f32 v135, v135
    v_exp_f32 v136, v136
    v_cvt_pk_bf16_f32 v65, v134, v135
    v_exp_f32 v137, v137
    v_exp_f32 v138, v138
    v_mfma_f32_32x32x16_bf16 v[92:107], v[56:59], v[212:215], v[92:107]
    ds_read_b128 v[40:43], v14 offset:40960
    ds_read_b128 v[44:47], v14 offset:41984
    ds_read_b128 v[48:51], v14 offset:43008
    ds_read_b128 v[52:55], v14 offset:44032
    v_cvt_pk_bf16_f32 v66, v136, v137
    v_exp_f32 v139, v139
    v_exp_f32 v140, v140
    v_cvt_pk_bf16_f32 v67, v138, v139
    v_exp_f32 v141, v141
    v_mfma_f32_32x32x16_bf16 v[156:171], v[24:27], v[16:19], v[108:123]
    v_exp_f32 v142, v142
    v_cvt_pk_bf16_f32 v68, v140, v141
    v_exp_f32 v143, v143
    v_exp_f32 v144, v144
    v_cvt_pk_bf16_f32 v69, v142, v143
    v_exp_f32 v145, v145
    v_mfma_f32_32x32x16_bf16 v[156:171], v[28:31], v[20:23], v[156:171]
    v_exp_f32 v146, v146
    v_cvt_pk_bf16_f32 v70, v144, v145
    v_exp_f32 v147, v147
    v_exp_f32 v148, v148
    v_cvt_pk_bf16_f32 v71, v146, v147
    v_mfma_f32_32x32x16_bf16 v[172:187], v[32:35], v[16:19], v[108:123]
    v_exp_f32 v149, v149
    v_exp_f32 v150, v150
    v_cvt_pk_bf16_f32 v72, v148, v149
    v_exp_f32 v151, v151
    v_exp_f32 v152, v152
    v_mfma_f32_32x32x16_bf16 v[172:187], v[36:39], v[20:23], v[172:187]
    v_cvt_pk_bf16_f32 v73, v150, v151
    v_exp_f32 v153, v153
    v_exp_f32 v154, v154
    v_cvt_pk_bf16_f32 v74, v152, v153
    v_exp_f32 v155, v155
    s_nop 0
    v_cvt_pk_bf16_f32 v75, v154, v155
    ds_read_b128 v[24:27], v197
    ds_read_b128 v[28:31], v198
    ds_read_b128 v[32:35], v197 offset:2048
    ds_read_b128 v[36:39], v198 offset:2048
    s_cmp_eq_u32 s14, 0
    s_cbranch_scc0 attn_fix6
attn_fixb6:
    s_waitcnt lgkmcnt(4)
    v_mfma_f32_32x32x16_bf16 v[76:91], v[40:43], v[60:63], v[76:91]
    v_max3_f32 v188, v156, v157, v158
    v_max3_f32 v189, v159, v160, v161
    v_max3_f32 v188, v188, v162, v163
    v_max3_f32 v189, v189, v164, v165
    v_max3_f32 v188, v188, v166, v167
    v_max3_f32 v189, v189, v168, v169
    v_mfma_f32_32x32x16_bf16 v[92:107], v[56:59], v[60:63], v[92:107]
    v_max3_f32 v188, v188, v170, v171
    v_max3_f32 v189, v189, v172, v173
    v_max3_f32 v188, v188, v174, v175
    v_max3_f32 v189, v189, v176, v177
    v_max3_f32 v188, v188, v178, v179
    v_max3_f32 v189, v189, v180, v181
    v_mfma_f32_32x32x16_bf16 v[76:91], v[44:47], v[64:67], v[76:91]
    v_max3_f32 v188, v188, v182, v183
    v_max3_f32 v189, v189, v184, v185
    v_max3_f32 v188, v188, v186, v187
    v_max_f32 v188, v188, v189
    v_cmp_lt_f32 vcc, s11, v188
    s_cbranch_vccnz attn_rare7
attn_back7:
    s_waitcnt lgkmcnt(0)
    v_mfma_f32_32x32x16_bf16 v[92:107], v[56:59], v[64:67], v[92:107]
    v_exp_f32 v156, v156
    v_exp_f32 v157, v157
    v_exp_f32 v158, v158
    v_cvt_pk_bf16_f32 v200, v156, v157
    v_exp_f32 v159, v159
    v_mfma_f32_32x32x16_bf16 v[76:91], v[48:51], v[68:71], v[76:91]
    v_exp_f32 v160, v160
    v_cvt_pk_bf16_f32 v201, v158, v159
    v_exp_f32 v161, v161
    v_exp_f32 v162, v162
    v_cvt_pk_bf16_f32 v202, v160, v161
    v_mfma_f32_32x32x16_bf16 v[92:107], v[56:59], v[68:71], v[92:107]
    v_exp_f32 v163, v163
    v_exp_f32 v164, v164
    v_cvt_pk_bf16_f32 v203, v162, v163
    v_exp_f32 v165, v165
    v_exp_f32 v166, v166
    v_cvt_pk_bf16_f32 v204, v164, v165
    v_mfma_f32_32x32x16_bf16 v[76:91], v[52:55], v[72:75], v[76:91]
    v_exp_f32 v167, v167
    v_exp_f32 v168, v168
    v_cvt_pk_bf16_f32 v205, v166, v167
    v_exp_f32 v169, v169
    v_exp_f32 v170, v170
    v_mfma_f32_32x32x16_bf16 v[92:107], v[56:59], v[72:75], v[92:107]
    ds_read_b128 v[40:43], v14 offset:45056
    ds_read_b128 v[44:47], v14 offset:46080
    ds_read_b128 v[48:51], v14 offset:47104
    ds_read_b128 v[52:55], v14 offset:48128
    v_cvt_pk_bf16_f32 v206, v168, v169
    v_exp_f32 v171, v171
    v_exp_f32 v172, v172
    v_cvt_pk_bf16_f32 v207, v170, v171
    v_exp_f32 v173, v173
    v_mfma_f32_32x32x16_bf16 v[124:139], v[24:27], v[16:19], v[108:123]
    v_exp_f32 v174, v174
    v_cvt_pk_bf16_f32 v208, v172, v173
    v_exp_f32 v175, v175
    v_exp_f32 v176, v176
    v_cvt_pk_bf16_f32 v209, v174, v175
    v_exp_f32 v177, v177
    v_mfma_f32_32x32x16_bf16 v[124:139], v[28:31], v[20:23], v[124:139]
    v_exp_f32 v178, v178
    v_cvt_pk_bf16_f32 v210, v176, v177
    v_exp_f32 v179, v179
    v_exp_f32 v180, v180
    v_cvt_pk_bf16_f32 v211, v178, v179
    v_mfma_f32_32x32x16_bf16 v[140:155], v[32:35], v[16:19], v[108:123]
    v_exp_f32 v181, v181
    v_exp_f32 v182, v182
    v_cvt_pk_bf16_f32 v212, v180, v181
    v_exp_f32 v183, v183
    v_exp_f32 v184, v184
    v_mfma_f32_32x32x16_bf16 v[140:155], v[36:39], v[20:23], v[140:155]
    v_cvt_pk_bf16_f32 v213, v182, v183
    v_exp_f32 v185, v185
    v_exp_f32 v186, v186
    v_cvt_pk_bf16_f32 v214, v184, v185
    v_exp_f32 v187, v187
    s_nop 0
    v_cvt_pk_bf16_f32 v215, v186, v187
    ds_read_b128 v[24:27], v197 offset:4096
    ds_read_b128 v[28:31], v198 offset:4096
    ds_read_b128 v[32:35], v197 offset:6144
    ds_read_b128 v[36:39], v198 offset:6144
    s_cmp_eq_u32 s14, 0
    s_cbranch_scc0 attn_fix7
attn_fixb7:
    s_waitcnt lgkmcnt(4)
    v_mfma_f32_32x32x16_bf16 v[76:91], v[40:43], v[200:203], v[76:91]
    v_max3_f32 v188, v124, v125, v126
    v_max3_f32 v189, v127, v128, v129
    v_max3_f32 v188, v188, v130, v131
    v_max3_f32 v189, v189, v132, v133
    v_max3_f32 v188, v188, v134, v135
    v_max3_f32 v189, v189, v136, v137
    v_mfma_f32_32x32x16_bf16 v[92:107], v[56:59], v[200:203], v[92:107]
    v_max3_f32 v188, v188, v138, v139
    v_max3_f32 v189, v189, v140, v141
    v_max3_f32 v188, v188, v142, v143
    v_max3_f32 v189, v189, v144, v145
    v_max3_f32 v188, v188, v146, v147
    v_max3_f32 v189, v189, v148, v149
    v_mfma_f32_32x32x16_bf16 v[76:91], v[44:47], v[204:207], v[76:91]
    v_max3_f32 v188, v188, v150, v151
    v_max3_f32 v189, v189, v152, v153
    v_max3_f32 v188, v188, v154, v155
    v_max_f32 v188, v188, v189
    v_cmp_lt_f32 vcc, s11, v188
    s_cbranch_vccnz attn_rare8
attn_back8:
    s_waitcnt lgkmcnt(0)
    v_mfma_f32_32x32x16_bf16 v[92:107], v[56:59], v[204:207], v[92:107]
    v_exp_f32 v124, v124
    v_exp_f32 v125, v125
    v_exp_f32 v126, v126
    v_cvt_pk_bf16_f32 v60, v124, v125
    v_exp_f32 v127, v127
    v_mfma_f32_32x32x16_bf16 v[76:91], v[48:51], v[208:211], v[76:91]
    v_exp_f32 v128, v128
    v_cvt_pk_bf16_f32 v61, v126, v127
    v_exp_f32 v129, v129
    v_exp_f32 v130, v130
    v_cvt_pk_bf16_f32 v62, v128, v129
    v_mfma_f32_32x32x16_bf16 v[92:107], v[56:59], v[208:211], v[92:107]
    v_exp_f32 v131, v131
    v_exp_f32 v132, v132
    v_cvt_pk_bf16_f32 v63, v130, v131
    v_exp_f32 v133, v133
    v_exp_f32 v134, v134
    v_cvt_pk_bf16_f32 v64, v132, v133
    v_mfma_f32_32x32x16_bf16 v[76:91], v[52:55], v[212:215], v[76:91]
    v_exp_f32 v135, v135
    v_exp_f32 v136, v136
    v_cvt_pk_bf16_f32 v65, v134, v135
    v_exp_f32 v137, v137
    v_exp_f32 v138, v138
    v_mfma_f32_32x32x16_bf16 v[92:107], v[56:59], v[212:215], v[92:107]
    ds_read_b128 v[40:43], v199
    ds_read_b128 v[44:47], v199 offset:1024
    ds_read_b128 v[48:51], v199 offset:2048
    ds_read_b128 v[52:55], v199 offset:3072
    v_cvt_pk_bf16_f32 v66, v136, v137
    v_exp_f32 v139, v139
    v_exp_f32 v140, v140
    v_cvt_pk_bf16_f32 v67, v138, v139
    v_exp_f32 v141, v141
    v_mfma_f32_32x32x16_bf16 v[156:171], v[24:27], v[16:19], v[108:123]
    v_exp_f32 v142, v142
    v_cvt_pk_bf16_f32 v68, v140, v141
    v_exp_f32 v143, v143
    v_exp_f32 v144, v144
    v_cvt_pk_bf16_f32 v69, v142, v143
    v_exp_f32 v145, v145
    v_mfma_f32_32x32x16_bf16 v[156:171], v[28:31], v[20:23], v[156:171]
    v_exp_f32 v146, v146
    v_cvt_pk_bf16_f32 v70, v144, v145
    v_exp_f32 v147, v147
    v_exp_f32 v148, v148
    v_cvt_pk_bf16_f32 v71, v146, v147
    v_mfma_f32_32x32x16_bf16 v[172:187], v[32:35], v[16:19], v[108:123]
    v_exp_f32 v149, v149
    v_exp_f32 v150, v150
    v_cvt_pk_bf16_f32 v72, v148, v149
    v_exp_f32 v151, v151
    v_exp_f32 v152, v152
    v_mfma_f32_32x32x16_bf16 v[172:187], v[36:39], v[20:23], v[172:187]
    v_cvt_pk_bf16_f32 v73, v150, v151
    v_exp_f32 v153, v153
    v_exp_f32 v154, v154
    v_cvt_pk_bf16_f32 v74, v152, v153
    v_exp_f32 v155, v155
    s_nop 0
    v_cvt_pk_bf16_f32 v75, v154, v155
    ds_read_b128 v[24:27], v197 offset:8192
    ds_read_b128 v[28:31], v198 offset:8192
    ds_read_b128 v[32:35], v197 offset:10240
    ds_read_b128 v[36:39], v198 offset:10240
    s_cmp_eq_u32 s14, 0
    s_cbranch_scc0 attn_fix8
attn_fixb8:
    s_waitcnt lgkmcnt(4)
    v_mfma_f32_32x32x16_bf16 v[76:91], v[40:43], v[60:63], v[76:91]
    v_max3_f32 v188, v156, v157, v158
    v_max3_f32 v189, v159, v160, v161
    v_max3_f32 v188, v188, v162, v163
    v_max3_f32 v189, v189, v164, v165
    v_max3_f32 v188, v188, v166, v167
    v_max3_f32 v189, v189, v168, v169
    v_mfma_f32_32x32x16_bf16 v[92:107], v[56:59], v[60:63], v[92:107]
    v_max3_f32 v188, v188, v170, v171
    v_max3_f32 v189, v189, v172, v173
    v_max3_f32 v188, v188, v174, v175
    v_max3_f32 v189, v189, v176, v177
    v_max3_f32 v188, v188, v178, v179
    v_max3_f32 v189, v189, v180, v181
    v_mfma_f32_32x32x16_bf16 v[76:91], v[44:47], v[64:67], v[76:91]
    v_max3_f32 v188, v188, v182, v183
    v_max3_f32 v189, v189, v184, v185
    v_max3_f32 v188, v188, v186, v187
    v_max_f32 v188, v188, v189
    v_cmp_lt_f32 vcc, s11, v188
    s_cbranch_vccnz attn_rare9
attn_back9:
    s_waitcnt lgkmcnt(0)
    v_mfma_f32_32x32x16_bf16 v[92:107], v[56:59], v[64:67], v[92:107]
    v_exp_f32 v156, v156
    v_exp_f32 v157, v157
    v_exp_f32 v158, v158
    v_cvt_pk_bf16_f32 v200, v156, v157
    v_exp_f32 v159, v159
    v_mfma_f32_32x32x16_bf16 v[76:91], v[48:51], v[68:71], v[76:91]
    v_exp_f32 v160, v160
    v_cvt_pk_bf16_f32 v201, v158, v159
    v_exp_f32 v161, v161
    v_exp_f32 v162, v162
    v_cvt_pk_bf16_f32 v202, v160, v161
    v_mfma_f32_32x32x16_bf16 v[92:107], v[56:59], v[68:71], v[92:107]
    v_exp_f32 v163, v163
    v_exp_f32 v164, v164
    v_cvt_pk_bf16_f32 v203, v162, v163
    v_exp_f32 v165, v165
    v_exp_f32 v166, v166
    v_cvt_pk_bf16_f32 v204, v164, v165
    v_mfma_f32_32x32x16_bf16 v[76:91], v[52:55], v[72:75], v[76:91]
    v_exp_f32 v167, v167
    v_exp_f32 v168, v168
    v_cvt_pk_bf16_f32 v205, v166, v167
    v_exp_f32 v169, v169
    v_exp_f32 v170, v170
    v_mfma_f32_32x32x16_bf16 v[92:107], v[56:59], v[72:75], v[92:107]
    ds_read_b128 v[40:43], v199 offset:4096
    ds_read_b128 v[44:47], v199 offset:5120
    ds_read_b128 v[48:51], v199 offset:6144
    ds_read_b128 v[52:55], v199 offset:7168
    v_cvt_pk_bf16_f32 v206, v168, v169
    v_exp_f32 v171, v171
    v_exp_f32 v172, v172
    v_cvt_pk_bf16_f32 v207, v170, v171
    v_exp_f32 v173, v173
    v_mfma_f32_32x32x16_bf16 v[124:139], v[24:27], v[16:19], v[108:123]
    v_exp_f32 v174, v174
    v_cvt_pk_bf16_f32 v208, v172, v173
    v_exp_f32 v175, v175
    v_exp_f32 v176, v176
    v_cvt_pk_bf16_f32 v209, v174, v175
    v_exp_f32 v177, v177
    v_mfma_f32_32x32x16_bf16 v[124:139], v[28:31], v[20:23], v[124:139]
    v_exp_f32 v178, v178
    v_cvt_pk_bf16_f32 v210, v176, v177
    v_exp_f32 v179, v179
    v_exp_f32 v180, v180
    v_cvt_pk_bf16_f32 v211, v178, v179
    v_mfma_f32_32x32x16_bf16 v[140:155], v[32:35], v[16:19], v[108:123]
    v_exp_f32 v181, v181
    v_exp_f32 v182, v182
    v_cvt_pk_bf16_f32 v212, v180, v181
    v_exp_f32 v183, v183
    v_exp_f32 v184, v184
    v_mfma_f32_32x32x16_bf16 v[140:155], v[36:39], v[20:23], v[140:155]
    v_cvt_pk_bf16_f32 v213, v182, v183
    v_exp_f32 v185, v185
    v_exp_f32 v186, v186
    v_cvt_pk_bf16_f32 v214, v184, v185
    v_exp_f32 v187, v187
    s_nop 0
    v_cvt_pk_bf16_f32 v215, v186, v187
    ds_read_b128 v[24:27], v197 offset:12288
    ds_read_b128 v[28:31], v198 offset:12288
    ds_read_b128 v[32:35], v197 offset:14336
    ds_read_b128 v[36:39], v198 offset:14336
    s_cmp_eq_u32 s14, 0
    s_cbranch_scc0 attn_fix9
attn_fixb9:
    s_waitcnt vmcnt(0)
    s_barrier
    s_add_u32 m0, s9, 32768
    s_nop 0
    buffer_load_dwordx4 v8, s[44:47], s10 offen lds
    s_add_u32 m0, s9, 40960
    s_nop 0
    buffer_load_dwordx4 v9, s[44:47], s10 offen lds
    s_add_u32 m0, s9, 49152
    s_nop 0
    buffer_load_dwordx4 v10, s[48:51], s10 offen lds
    s_add_u32 m0, s9, 57344
    s_nop 0
    buffer_load_dwordx4 v11, s[48:51], s10 offen lds
    s_add_u32 s10, s10, 16384
    s_cmp_lg_u32 s13, 2
    s_cbranch_scc1 attn_nt2
    buffer_load_dword v196, v194, s[64:67], 0 offen
    buffer_load_dword v196, v195, s[68:71], 0 offen
attn_nt2:
    s_waitcnt lgkmcnt(4)
    v_mfma_f32_32x32x16_bf16 v[76:91], v[40:43], v[200:203], v[76:91]
    v_max3_f32 v188, v124, v125, v126
    v_max3_f32 v189, v127, v128, v129
    v_max3_f32 v188, v188, v130, v131
    v_max3_f32 v189, v189, v132, v133
    v_max3_f32 v188, v188, v134, v135
    v_max3_f32 v189, v189, v136, v137
    v_mfma_f32_32x32x16_bf16 v[92:107], v[56:59], v[200:203], v[92:107]
    v_max3_f32 v188, v188, v138, v139
    v_max3_f32 v189, v189, v140, v141
    v_max3_f32 v188, v188, v142, v143
    v_max3_f32 v189, v189, v144, v145
    v_max3_f32 v188, v188, v146, v147
    v_max3_f32 v189, v189, v148, v149
    v_mfma_f32_32x32x16_bf16 v[76:91], v[44:47], v[204:207], v[76:91]
    v_max3_f32 v188, v188, v150, v151
    v_max3_f32 v189, v189, v152, v153
    v_max3_f32 v188, v188, v154, v155
    v_max_f32 v188, v188, v189
    v_cmp_lt_f32 vcc, s11, v188
    s_cbranch_vccnz attn_rare10
attn_back10:
    s_waitcnt lgkmcnt(0)
    v_mfma_f32_32x32x16_bf16 v[92:107], v[56:59], v[204:207], v[92:107]
    v_exp_f32 v124, v124
    v_exp_f32 v125, v125
    v_exp_f32 v126, v126
    v_cvt_pk_bf16_f32 v60, v124, v125
    v_exp_f32 v127, v127
    v_mfma_f32_32x32x16_bf16 v[76:91], v[48:51], v[208:211], v[76:91]
    v_exp_f32 v128, v128
    v_cvt_pk_bf16_f32 v61, v126, v127
    v_exp_f32 v129, v129
    v_exp_f32 v130, v130
    v_cvt_pk_bf16_f32 v62, v128, v129
    v_mfma_f32_32x32x16_bf16 v[92:107], v[56:59], v[208:211], v[92:107]
    v_exp_f32 v131, v131
    v_exp_f32 v132, v132
    v_cvt_pk_bf16_f32 v63, v130, v131
    v_exp_f32 v133, v133
    v_exp_f32 v134, v134
    v_cvt_pk_bf16_f32 v64, v132, v133
    v_mfma_f32_32x32x16_bf16 v[76:91], v[52:55], v[212:215], v[76:91]
    v_exp_f32 v135, v135
    v_exp_f32 v136, v136
    v_cvt_pk_bf16_f32 v65, v134, v135
    v_exp_f32 v137, v137
    v_exp_f32 v138, v138
    v_mfma_f32_32x32x16_bf16 v[92:107], v[56:59], v[212:215], v[92:107]
    ds_read_b128 v[40:43], v199 offset:8192
    ds_read_b128 v[44:47], v199 offset:9216
    ds_read_b128 v[48:51], v199 offset:10240
    ds_read_b128 v[52:55], v199 offset:11264
    v_cvt_pk_bf16_f32 v66, v136, v137
    v_exp_f32 v139, v139
    v_exp_f32 v140, v140
    v_cvt_pk_bf16_f32 v67, v138, v139
    v_exp_f32 v141, v141
    v_mfma_f32_32x32x16_bf16 v[156:171], v[24:27], v[16:19], v[108:123]
    v_exp_f32 v142, v142
    v_cvt_pk_bf16_f32 v68, v140, v141
    v_exp_f32 v143, v143
    v_exp_f32 v144, v144
    v_cvt_pk_bf16_f32 v69, v142, v143
    v_exp_f32 v145, v145
    v_mfma_f32_32x32x16_bf16 v[156:171], v[28:31], v[20:23], v[156:171]
    v_exp_f32 v146, v146
    v_cvt_pk_bf16_f32 v70, v144, v145
    v_exp_f32 v147, v147
    v_exp_f32 v148, v148
    v_cvt_pk_bf16_f32 v71, v146, v147
    v_mfma_f32_32x32x16_bf16 v[172:187], v[32:35], v[16:19], v[108:123]
    v_exp_f32 v149, v149
    v_exp_f32 v150, v150
    v_cvt_pk_bf16_f32 v72, v148, v149
    v_exp_f32 v151, v151
    v_exp_f32 v152, v152
    v_mfma_f32_32x32x16_bf16 v[172:187], v[36:39], v[20:23], v[172:187]
    v_cvt_pk_bf16_f32 v73, v150, v151
    v_exp_f32 v153, v153
    v_exp_f32 v154, v154
    v_cvt_pk_bf16_f32 v74, v152, v153
    v_exp_f32 v155, v155
    s_nop 0
    v_cvt_pk_bf16_f32 v75, v154, v155
    ds_read_b128 v[24:27], v12
    ds_read_b128 v[28:31], v13
    ds_read_b128 v[32:35], v12 offset:2048
    ds_read_b128 v[36:39], v13 offset:2048
    s_cmp_eq_u32 s14, 0
    s_cbranch_scc0 attn_fix10
attn_fixb10:
    s_waitcnt lgkmcnt(4)
    v_mfma_f32_32x32x16_bf16 v[76:91], v[40:43], v[60:63], v[76:91]
    v_max3_f32 v188, v156, v157, v158
    v_max3_f32 v189, v159, v160, v161
    v_max3_f32 v188, v188, v162, v163
    v_max3_f32 v189, v189, v164, v165
    v_max3_f32 v188, v188, v166, v167
    v_max3_f32 v189, v189, v168, v169
    v_mfma_f32_32x32x16_bf16 v[92:107], v[56:59], v[60:63], v[92:107]
    v_max3_f32 v188, v188, v170, v171
    v_max3_f32 v189, v189, v172, v173
    v_max3_f32 v188, v188, v174, v175
    v_max3_f32 v189, v189, v176, v177
    v_max3_f32 v188, v188, v178, v179
    v_max3_f32 v189, v189, v180, v181
    v_mfma_f32_32x32x16_bf16 v[76:91], v[44:47], v[64:67], v[76:91]
    v_max3_f32 v188, v188, v182, v183
    v_max3_f32 v189, v189, v184, v185
    v_max3_f32 v188, v188, v186, v187
    v_max_f32 v188, v188, v189
    v_cmp_lt_f32 vcc, s11, v188
    s_cbranch_vccnz attn_rare11
attn_back11:
    s_waitcnt lgkmcnt(0)
    v_mfma_f32_32x32x16_bf16 v[92:107], v[56:59], v[64:67], v[92:107]
    v_exp_f32 v156, v156
    v_exp_f32 v157, v157
    v_exp_f32 v158, v158
    v_cvt_pk_bf16_f32 v200, v156, v157
    v_exp_f32 v159, v159
    v_mfma_f32_32x32x16_bf16 v[76:91], v[48:51], v[68:71], v[76:91]
    v_exp_f32 v160, v160
    v_cvt_pk_bf16_f32 v201, v158, v159
    v_exp_f32 v161, v161
    v_exp_f32 v162, v162
    v_cvt_pk_bf16_f32 v202, v160, v161
    v_mfma_f32_32x32x16_bf16 v[92:107], v[56:59], v[68:71], v[92:107]
    v_exp_f32 v163, v163
    v_exp_f32 v164, v164
    v_cvt_pk_bf16_f32 v203, v162, v163
    v_exp_f32 v165, v165
    v_exp_f32 v166, v166
    v_cvt_pk_bf16_f32 v204, v164, v165
    v_mfma_f32_32x32x16_bf16 v[76:91], v[52:55], v[72:75], v[76:91]
    v_exp_f32 v167, v167
    v_exp_f32 v168, v168
    v_cvt_pk_bf16_f32 v205, v166, v167
    v_exp_f32 v169, v169
    v_exp_f32 v170, v170
    v_mfma_f32_32x32x16_bf16 v[92:107], v[56:59], v[72:75], v[92:107]
    ds_read_b128 v[40:43], v199 offset:12288
    ds_read_b128 v[44:47], v199 offset:13312
    ds_read_b128 v[48:51], v199 offset:14336
    ds_read_b128 v[52:55], v199 offset:15360
    v_cvt_pk_bf16_f32 v206, v168, v169
    v_exp_f32 v171, v171
    v_exp_f32 v172, v172
    v_cvt_pk_bf16_f32 v207, v170, v171
    v_exp_f32 v173, v173
    v_mfma_f32_32x32x16_bf16 v[124:139], v[24:27], v[16:19], v[108:123]
    v_exp_f32 v174, v174
    v_cvt_pk_bf16_f32 v208, v172, v173
    v_exp_f32 v175, v175
    v_exp_f32 v176, v176
    v_cvt_pk_bf16_f32 v209, v174, v175
    v_exp_f32 v177, v177
    v_mfma_f32_32x32x16_bf16 v[124:139], v[28:31], v[20:23], v[124:139]
    v_exp_f32 v178, v178
    v_cvt_pk_bf16_f32 v210, v176, v177
    v_exp_f32 v179, v179
    v_exp_f32 v180, v180
    v_cvt_pk_bf16_f32 v211, v178, v179
    v_mfma_f32_32x32x16_bf16 v[140:155], v[32:35], v[16:19], v[108:123]
    v_exp_f32 v181, v181
    v_exp_f32 v182, v182
    v_cvt_pk_bf16_f32 v212, v180, v181
    v_exp_f32 v183, v183
    v_exp_f32 v184, v184
    v_mfma_f32_32x32x16_bf16 v[140:155], v[36:39], v[20:23], v[140:155]
    v_cvt_pk_bf16_f32 v213, v182, v183
    v_exp_f32 v185, v185
    v_exp_f32 v186, v186
    v_cvt_pk_bf16_f32 v214, v184, v185
    v_exp_f32 v187, v187
    s_nop 0
    v_cvt_pk_bf16_f32 v215, v186, v187
    ds_read_b128 v[24:27], v12 offset:4096
    ds_read_b128 v[28:31], v13 offset:4096
    ds_read_b128 v[32:35], v12 offset:6144
    ds_read_b128 v[36:39], v13 offset:6144
    s_cmp_eq_u32 s14, 0
    s_cbranch_scc0 attn_fix11
attn_fixb11:
    s_waitcnt lgkmcnt(4)
    v_mfma_f32_32x32x16_bf16 v[76:91], v[40:43], v[200:203], v[76:91]
    v_max3_f32 v188, v124, v125, v126
    v_max3_f32 v189, v127, v128, v129
    v_max3_f32 v188, v188, v130, v131
    v_max3_f32 v189, v189, v132, v133
    v_max3_f32 v188, v188, v134, v135
    v_max3_f32 v189, v189, v136, v137
    v_mfma_f32_32x32x16_bf16 v[92:107], v[56:59], v[200:203], v[92:107]
    v_max3_f32 v188, v188, v138, v139
    v_max3_f32 v189, v189, v140, v141
    v_max3_f32 v188, v188, v142, v143
    v_max3_f32 v189, v189, v144, v145
    v_max3_f32 v188, v188, v146, v147
    v_max3_f32 v189, v189, v148, v149
    v_mfma_f32_32x32x16_bf16 v[76:91], v[44:47], v[204:207], v[76:91]
    v_max3_f32 v188, v188, v150, v151
    v_max3_f32 v189, v189, v152, v153
    v_max3_f32 v188, v188, v154, v155
    v_max_f32 v188, v188, v189
    v_cmp_lt_f32 vcc, s11, v188
    s_cbranch_vccnz attn_rare12
attn_back12:
    s_waitcnt lgkmcnt(0)
    v_mfma_f32_32x32x16_bf16 v[92:107], v[56:59], v[204:207], v[92:107]
    v_exp_f32 v124, v124
    v_exp_f32 v125, v125
    v_exp_f32 v126, v126
    v_cvt_pk_bf16_f32 v60, v124, v125
    v_exp_f32 v127, v127
    v_mfma_f32_32x32x16_bf16 v[76:91], v[48:51], v[208:211], v[76:91]
    v_exp_f32 v128, v128
    v_cvt_pk_bf16_f32 v61, v126, v127
    v_exp_f32 v129, v129
    v_exp_f32 v130, v130
    v_cvt_pk_bf16_f32 v62, v128, v129
    v_mfma_f32_32x32x16_bf16 v[92:107], v[56:59], v[208:211], v[92:107]
    v_exp_f32 v131, v131
    v_exp_f32 v132, v132
    v_cvt_pk_bf16_f32 v63, v130, v131
    v_exp_f32 v133, v133
    v_exp_f32 v134, v134
    v_cvt_pk_bf16_f32 v64, v132, v133
    v_mfma_f32_32x32x16_bf16 v[76:91], v[52:55], v[212:215], v[76:91]
    v_exp_f32 v135, v135
    v_exp_f32 v136, v136
    v_cvt_pk_bf16_f32 v65, v134, v135
    v_exp_f32 v137, v137
    v_exp_f32 v138, v138
    v_mfma_f32_32x32x16_bf16 v[92:107], v[56:59], v[212:215], v[92:107]
    ds_read_b128 v[40:43], v14
    ds_read_b128 v[44:47], v14 offset:1024
    ds_read_b128 v[48:51], v14 offset:2048
    ds_read_b128 v[52:55], v14 offset:3072
    v_cvt_pk_bf16_f32 v66, v136, v137
    v_exp_f32 v139, v139
    v_exp_f32 v140, v140
    v_cvt_pk_bf16_f32 v67, v138, v139
    v_exp_f32 v141, v141
    v_mfma_f32_32x32x16_bf16 v[156:171], v[24:27], v[16:19], v[108:123]
    v_exp_f32 v142, v142
    v_cvt_pk_bf16_f32 v68, v140, v141
    v_exp_f32 v143, v143
    v_exp_f32 v144, v144
    v_cvt_pk_bf16_f32 v69, v142, v143
    v_exp_f32 v145, v145
    v_mfma_f32_32x32x16_bf16 v[156:171], v[28:31], v[20:23], v[156:171]
    v_exp_f32 v146, v146
    v_cvt_pk_bf16_f32 v70, v144, v145
    v_exp_f32 v147, v147
    v_exp_f32 v148, v148
    v_cvt_pk_bf16_f32 v71, v146, v147
    v_mfma_f32_32x32x16_bf16 v[172:187], v[32:35], v[16:19], v[108:123]
    v_exp_f32 v149, v149
    v_exp_f32 v150, v150
    v_cvt_pk_bf16_f32 v72, v148, v149
    v_exp_f32 v151, v151
    v_exp_f32 v152, v152
    v_mfma_f32_32x32x16_bf16 v[172:187], v[36:39], v[20:23], v[172:187]
    v_cvt_pk_bf16_f32 v73, v150, v151
    v_exp_f32 v153, v153
    v_exp_f32 v154, v154
    v_cvt_pk_bf16_f32 v74, v152, v153
    v_exp_f32 v155, v155
    s_nop 0
    v_cvt_pk_bf16_f32 v75, v154, v155
    ds_read_b128 v[24:27], v12 offset:8192
    ds_read_b128 v[28:31], v13 offset:8192
    ds_read_b128 v[32:35], v12 offset:10240
    ds_read_b128 v[36:39], v13 offset:10240
    s_cmp_eq_u32 s14, 0
    s_cbranch_scc0 attn_fix12
attn_fixb12:
    s_sub_u32 s13, s13, 1
    s_cmp_lg_u32 s13, 0
    s_cbranch_scc1 attn_loop
    s_nop 15
    s_waitcnt lgkmcnt(4)
    v_mfma_f32_32x32x16_bf16 v[76:91], v[40:43], v[60:63], v[76:91]
    v_max3_f32 v188, v156, v157, v158
    v_max3_f32 v189, v159, v160, v161
    v_max3_f32 v188, v188, v162, v163
    v_max3_f32 v189, v189, v164, v165
    v_max3_f32 v188, v188, v166, v167
    v_max3_f32 v189, v189, v168, v169
    v_mfma_f32_32x32x16_bf16 v[92:107], v[56:59], v[60:63], v[92:107]
    v_max3_f32 v188, v188, v170, v171
    v_max3_f32 v189, v189, v172, v173
    v_max3_f32 v188, v188, v174, v175
    v_max3_f32 v189, v189, v176, v177
    v_max3_f32 v188, v188, v178, v179
    v_max3_f32 v189, v189, v180, v181
    v_mfma_f32_32x32x16_bf16 v[76:91], v[44:47], v[64:67], v[76:91]
    v_max3_f32 v188, v188, v182, v183
    v_max3_f32 v189, v189, v184, v185
    v_max3_f32 v188, v188, v186, v187
    v_max_f32 v188, v188, v189
    v_cmp_lt_f32 vcc, s11, v188
    s_cbranch_vccnz attn_rare13
attn_back13:
    s_waitcnt lgkmcnt(0)
    v_mfma_f32_32x32x16_bf16 v[92:107], v[56:59], v[64:67], v[92:107]
    v_exp_f32 v156, v156
    v_exp_f32 v157, v157
    v_exp_f32 v158, v158
    v_cvt_pk_bf16_f32 v200, v156, v157
    v_exp_f32 v159, v159
    v_mfma_f32_32x32x16_bf16 v[76:91], v[48:51], v[68:71], v[76:91]
    v_exp_f32 v160, v160
    v_cvt_pk_bf16_f32 v201, v158, v159
    v_exp_f32 v161, v161
    v_exp_f32 v162, v162
    v_cvt_pk_bf16_f32 v202, v160, v161
    v_mfma_f32_32x32x16_bf16 v[92:107], v[56:59], v[68:71], v[92:107]
    v_exp_f32 v163, v163
    v_exp_f32 v164, v164
    v_cvt_pk_bf16_f32 v203, v162, v163
    v_exp_f32 v165, v165
    v_exp_f32 v166, v166
    v_cvt_pk_bf16_f32 v204, v164, v165
    v_mfma_f32_32x32x16_bf16 v[76:91], v[52:55], v[72:75], v[76:91]
    v_exp_f32 v167, v167
    v_exp_f32 v168, v168
    v_cvt_pk_bf16_f32 v205, v166, v167
    v_exp_f32 v169, v169
    v_exp_f32 v170, v170
    v_mfma_f32_32x32x16_bf16 v[92:107], v[56:59], v[72:75], v[92:107]
    ds_read_b128 v[40:43], v14 offset:4096
    ds_read_b128 v[44:47], v14 offset:5120
    ds_read_b128 v[48:51], v14 offset:6144
    ds_read_b128 v[52:55], v14 offset:7168
    v_cvt_pk_bf16_f32 v206, v168, v169
    v_exp_f32 v171, v171
    v_exp_f32 v172, v172
    v_cvt_pk_bf16_f32 v207, v170, v171
    v_exp_f32 v173, v173
    v_mfma_f32_32x32x16_bf16 v[124:139], v[24:27], v[16:19], v[108:123]
    v_exp_f32 v174, v174
    v_cvt_pk_bf16_f32 v208, v172, v173
    v_exp_f32 v175, v175
    v_exp_f32 v176, v176
    v_cvt_pk_bf16_f32 v209, v174, v175
    v_exp_f32 v177, v177
    v_mfma_f32_32x32x16_bf16 v[124:139], v[28:31], v[20:23], v[124:139]
    v_exp_f32 v178, v178
    v_cvt_pk_bf16_f32 v210, v176, v177
    v_exp_f32 v179, v179
    v_exp_f32 v180, v180
    v_cvt_pk_bf16_f32 v211, v178, v179
    v_mfma_f32_32x32x16_bf16 v[140:155], v[32:35], v[16:19], v[108:123]
    v_exp_f32 v181, v181
    v_exp_f32 v182, v182
    v_cvt_pk_bf16_f32 v212, v180, v181
    v_exp_f32 v183, v183
    v_exp_f32 v184, v184
    v_mfma_f32_32x32x16_bf16 v[140:155], v[36:39], v[20:23], v[140:155]
    v_cvt_pk_bf16_f32 v213, v182, v183
    v_exp_f32 v185, v185
    v_exp_f32 v186, v186
    v_cvt_pk_bf16_f32 v214, v184, v185
    v_exp_f32 v187, v187
    s_nop 0
    v_cvt_pk_bf16_f32 v215, v186, v187
    ds_read_b128 v[24:27], v12 offset:12288
    ds_read_b128 v[28:31], v13 offset:12288
    ds_read_b128 v[32:35], v12 offset:14336
    ds_read_b128 v[36:39], v13 offset:14336
    s_cmp_eq_u32 s14, 0
    s_cbranch_scc0 attn_fix13
attn_fixb13:
    s_waitcnt vmcnt(0)
    s_barrier
    s_waitcnt lgkmcnt(4)
    v_mfma_f32_32x32x16_bf16 v[76:91], v[40:43], v[200:203], v[76:91]
    v_max3_f32 v188, v124, v125, v126
    v_max3_f32 v189, v127, v128, v129
    v_max3_f32 v188, v188, v130, v131
    v_max3_f32 v189, v189, v132, v133
    v_max3_f32 v188, v188, v134, v135
    v_max3_f32 v189, v189, v136, v137
    v_mfma_f32_32x32x16_bf16 v[92:107], v[56:59], v[200:203], v[92:107]
    v_max3_f32 v188, v188, v138, v139
    v_max3_f32 v189, v189, v140, v141
    v_max3_f32 v188, v188, v142, v143
    v_max3_f32 v189, v189, v144, v145
    v_max3_f32 v188, v188, v146, v147
    v_max3_f32 v189, v189, v148, v149
    v_mfma_f32_32x32x16_bf16 v[76:91], v[44:47], v[204:207], v[76:91]
    v_max3_f32 v188, v188, v150, v151
    v_max3_f32 v189, v189, v152, v153
    v_max3_f32 v188, v188, v154, v155
    v_max_f32 v188, v188, v189
    v_cmp_lt_f32 vcc, s11, v188
    s_cbranch_vccnz attn_rare14
attn_back14:
    s_waitcnt lgkmcnt(0)
    v_mfma_f32_32x32x16_bf16 v[92:107], v[56:59], v[204:207], v[92:107]
    v_exp_f32 v124, v124
    v_exp_f32 v125, v125
    v_exp_f32 v126, v126
    v_cvt_pk_bf16_f32 v60, v124, v125
    v_exp_f32 v127, v127
    v_mfma_f32_32x32x16_bf16 v[76:91], v[48:51], v[208:211], v[76:91]
    v_exp_f32 v128, v128
    v_cvt_pk_bf16_f32 v61, v126, v127
    v_exp_f32 v129, v129
    v_exp_f32 v130, v130
    v_cvt_pk_bf16_f32 v62, v128, v129
    v_mfma_f32_32x32x16_bf16 v[92:107], v[56:59], v[208:211], v[92:107]
    v_exp_f32 v131, v131
    v_exp_f32 v132, v132
    v_cvt_pk_bf16_f32 v63, v130, v131
    v_exp_f32 v133, v133
    v_exp_f32 v134, v134
    v_cvt_pk_bf16_f32 v64, v132, v133
    v_mfma_f32_32x32x16_bf16 v[76:91], v[52:55], v[212:215], v[76:91]
    v_exp_f32 v135, v135
    v_exp_f32 v136, v136
    v_cvt_pk_bf16_f32 v65, v134, v135
    v_exp_f32 v137, v137
    v_exp_f32 v138, v138
    v_mfma_f32_32x32x16_bf16 v[92:107], v[56:59], v[212:215], v[92:107]
    ds_read_b128 v[40:43], v14 offset:8192
    ds_read_b128 v[44:47], v14 offset:9216
    ds_read_b128 v[48:51], v14 offset:10240
    ds_read_b128 v[52:55], v14 offset:11264
    v_cvt_pk_bf16_f32 v66, v136, v137
    v_exp_f32 v139, v139
    v_exp_f32 v140, v140
    v_cvt_pk_bf16_f32 v67, v138, v139
    v_exp_f32 v141, v141
    v_mfma_f32_32x32x16_bf16 v[156:171], v[24:27], v[16:19], v[108:123]
    v_exp_f32 v142, v142
    v_cvt_pk_bf16_f32 v68, v140, v141
    v_exp_f32 v143, v143
    v_exp_f32 v144, v144
    v_cvt_pk_bf16_f32 v69, v142, v143
    v_exp_f32 v145, v145
    v_mfma_f32_32x32x16_bf16 v[156:171], v[28:31], v[20:23], v[156:171]
    v_exp_f32 v146, v146
    v_cvt_pk_bf16_f32 v70, v144, v145
    v_exp_f32 v147, v147
    v_exp_f32 v148, v148
    v_cvt_pk_bf16_f32 v71, v146, v147
    v_mfma_f32_32x32x16_bf16 v[172:187], v[32:35], v[16:19], v[108:123]
    v_exp_f32 v149, v149
    v_exp_f32 v150, v150
    v_cvt_pk_bf16_f32 v72, v148, v149
    v_exp_f32 v151, v151
    v_exp_f32 v152, v152
    v_mfma_f32_32x32x16_bf16 v[172:187], v[36:39], v[20:23], v[172:187]
    v_cvt_pk_bf16_f32 v73, v150, v151
    v_exp_f32 v153, v153
    v_exp_f32 v154, v154
    v_cvt_pk_bf16_f32 v74, v152, v153
    v_exp_f32 v155, v155
    s_nop 0
    v_cvt_pk_bf16_f32 v75, v154, v155
    ds_read_b128 v[24:27], v12 offset:32768
    ds_read_b128 v[28:31], v13 offset:32768
    ds_read_b128 v[32:35], v12 offset:34816
    ds_read_b128 v[36:39], v13 offset:34816
    s_cmp_eq_u32 s14, 0
    s_cbranch_scc0 attn_fix14
attn_fixb14:
    s_waitcnt lgkmcnt(4)
    v_mfma_f32_32x32x16_bf16 v[76:91], v[40:43], v[60:63], v[76:91]
    v_max3_f32 v188, v156, v157, v158
    v_max3_f32 v189, v159, v160, v161
    v_max3_f32 v188, v188, v162, v163
    v_max3_f32 v189, v189, v164, v165
    v_max3_f32 v188, v188, v166, v167
    v_max3_f32 v189, v189, v168, v169
    v_mfma_f32_32x32x16_bf16 v[92:107], v[56:59], v[60:63], v[92:107]
    v_max3_f32 v188, v188, v170, v171
    v_max3_f32 v189, v189, v172, v173
    v_max3_f32 v188, v188, v174, v175
    v_max3_f32 v189, v189, v176, v177
    v_max3_f32 v188, v188, v178, v179
    v_max3_f32 v189, v189, v180, v181
    v_mfma_f32_32x32x16_bf16 v[76:91], v[44:47], v[64:67], v[76:91]
    v_max3_f32 v188, v188, v182, v183
    v_max3_f32 v189, v189, v184, v185
    v_max3_f32 v188, v188, v186, v187
    v_max_f32 v188, v188, v189
    v_cmp_lt_f32 vcc, s11, v188
    s_cbranch_vccnz attn_rare15
attn_back15:
    s_waitcnt lgkmcnt(0)
    v_mfma_f32_32x32x16_bf16 v[92:107], v[56:59], v[64:67], v[92:107]
    v_exp_f32 v156, v156
    v_exp_f32 v157, v157
    v_exp_f32 v158, v158
    v_cvt_pk_bf16_f32 v200, v156, v157
    v_exp_f32 v159, v159
    v_mfma_f32_32x32x16_bf16 v[76:91], v[48:51], v[68:71], v[76:91]
    v_exp_f32 v160, v160
    v_cvt_pk_bf16_f32 v201, v158, v159
    v_exp_f32 v161, v161
    v_exp_f32 v162, v162
    v_cvt_pk_bf16_f32 v202, v160, v161
    v_mfma_f32_32x32x16_bf16 v[92:107], v[56:59], v[68:71], v[92:107]
    v_exp_f32 v163, v163
    v_exp_f32 v164, v164
    v_cvt_pk_bf16_f32 v203, v162, v163
    v_exp_f32 v165, v165
    v_exp_f32 v166, v166
    v_cvt_pk_bf16_f32 v204, v164, v165
    v_mfma_f32_32x32x16_bf16 v[76:91], v[52:55], v[72:75], v[76:91]
    v_exp_f32 v167, v167
    v_exp_f32 v168, v168
    v_cvt_pk_bf16_f32 v205, v166, v167
    v_exp_f32 v169, v169
    v_exp_f32 v170, v170
    v_mfma_f32_32x32x16_bf16 v[92:107], v[56:59], v[72:75], v[92:107]
    ds_read_b128 v[40:43], v14 offset:12288
    ds_read_b128 v[44:47], v14 offset:13312
    ds_read_b128 v[48:51], v14 offset:14336
    ds_read_b128 v[52:55], v14 offset:15360
    v_cvt_pk_bf16_f32 v206, v168, v169
    v_exp_f32 v171, v171
    v_exp_f32 v172, v172
    v_cvt_pk_bf16_f32 v207, v170, v171
    v_exp_f32 v173, v173
    v_mfma_f32_32x32x16_bf16 v[124:139], v[24:27], v[16:19], v[108:123]
    v_exp_f32 v174, v174
    v_cvt_pk_bf16_f32 v208, v172, v173
    v_exp_f32 v175, v175
    v_exp_f32 v176, v176
    v_cvt_pk_bf16_f32 v209, v174, v175
    v_exp_f32 v177, v177
    v_mfma_f32_32x32x16_bf16 v[124:139], v[28:31], v[20:23], v[124:139]
    v_exp_f32 v178, v178
    v_cvt_pk_bf16_f32 v210, v176, v177
    v_exp_f32 v179, v179
    v_exp_f32 v180, v180
    v_cvt_pk_bf16_f32 v211, v178, v179
    v_mfma_f32_32x32x16_bf16 v[140:155], v[32:35], v[16:19], v[108:123]
    v_exp_f32 v181, v181
    v_exp_f32 v182, v182
    v_cvt_pk_bf16_f32 v212, v180, v181
    v_exp_f32 v183, v183
    v_exp_f32 v184, v184
    v_mfma_f32_32x32x16_bf16 v[140:155], v[36:39], v[20:23], v[140:155]
    v_cvt_pk_bf16_f32 v213, v182, v183
    v_exp_f32 v185, v185
    v_exp_f32 v186, v186
    v_cvt_pk_bf16_f32 v214, v184, v185
    v_exp_f32 v187, v187
    s_nop 0
    v_cvt_pk_bf16_f32 v215, v186, v187
    ds_read_b128 v[24:27], v12 offset:36864
    ds_read_b128 v[28:31], v13 offset:36864
    ds_read_b128 v[32:35], v12 offset:38912
    ds_read_b128 v[36:39], v13 offset:38912
    s_cmp_eq_u32 s14, 0
    s_cbranch_scc0 attn_fix15
attn_fixb15:
    s_waitcnt lgkmcnt(4)
    v_mfma_f32_32x32x16_bf16 v[76:91], v[40:43], v[200:203], v[76:91]
    v_max3_f32 v188, v124, v125, v126
    v_max3_f32 v189, v127, v128, v129
    v_max3_f32 v188, v188, v130, v131
    v_max3_f32 v189, v189, v132, v133
    v_max3_f32 v188, v188, v134, v135
    v_max3_f32 v189, v189, v136, v137
    v_mfma_f32_32x32x16_bf16 v[92:107], v[56:59], v[200:203], v[92:107]
    v_max3_f32 v188, v188, v138, v139
    v_max3_f32 v189, v189, v140, v141
    v_max3_f32 v188, v188, v142, v143
    v_max3_f32 v189, v189, v144, v145
    v_max3_f32 v188, v188, v146, v147
    v_max3_f32 v189, v189, v148, v149
    v_mfma_f32_32x32x16_bf16 v[76:91], v[44:47], v[204:207], v[76:91]
    v_max3_f32 v188, v188, v150, v151
    v_max3_f32 v189, v189, v152, v153
    v_max3_f32 v188, v188, v154, v155
    v_max_f32 v188, v188, v189
    v_cmp_lt_f32 vcc, s11, v188
    s_cbranch_vccnz attn_rare16
attn_back16:
    s_waitcnt lgkmcnt(0)
    v_mfma_f32_32x32x16_bf16 v[92:107], v[56:59], v[204:207], v[92:107]
    v_exp_f32 v124, v124
    v_exp_f32 v125, v125
    v_exp_f32 v126, v126
    v_cvt_pk_bf16_f32 v60, v124, v125
    v_exp_f32 v127, v127
    v_mfma_f32_32x32x16_bf16 v[76:91], v[48:51], v[208:211], v[76:91]
    v_exp_f32 v128, v128
    v_cvt_pk_bf16_f32 v61, v126, v127
    v_exp_f32 v129, v129
    v_exp_f32 v130, v130
    v_cvt_pk_bf16_f32 v62, v128, v129
    v_mfma_f32_32x32x16_bf16 v[92:107], v[56:59], v[208:211], v[92:107]
    v_exp_f32 v131, v131
    v_exp_f32 v132, v132
    v_cvt_pk_bf16_f32 v63, v130, v131
    v_exp_f32 v133, v133
    v_exp_f32 v134, v134
    v_cvt_pk_bf16_f32 v64, v132, v133
    v_mfma_f32_32x32x16_bf16 v[76:91], v[52:55], v[212:215], v[76:91]
    v_exp_f32 v135, v135
    v_exp_f32 v136, v136
    v_cvt_pk_bf16_f32 v65, v134, v135
    v_exp_f32 v137, v137
    v_exp_f32 v138, v138
    v_mfma_f32_32x32x16_bf16 v[92:107], v[56:59], v[212:215], v[92:107]
    ds_read_b128 v[40:43], v14 offset:32768
    ds_read_b128 v[44:47], v14 offset:33792
    ds_read_b128 v[48:51], v14 offset:34816
    ds_read_b128 v[52:55], v14 offset:35840
    v_cvt_pk_bf16_f32 v66, v136, v137
    v_exp_f32 v139, v139
    v_exp_f32 v140, v140
    v_cvt_pk_bf16_f32 v67, v138, v139
    v_exp_f32 v141, v141
    v_mfma_f32_32x32x16_bf16 v[156:171], v[24:27], v[16:19], v[108:123]
    v_exp_f32 v142, v142
    v_cvt_pk_bf16_f32 v68, v140, v141
    v_exp_f32 v143, v143
    v_exp_f32 v144, v144
    v_cvt_pk_bf16_f32 v69, v142, v143
    v_exp_f32 v145, v145
    v_mfma_f32_32x32x16_bf16 v[156:171], v[28:31], v[20:23], v[156:171]
    v_exp_f32 v146, v146
    v_cvt_pk_bf16_f32 v70, v144, v145
    v_exp_f32 v147, v147
    v_exp_f32 v148, v148
    v_cvt_pk_bf16_f32 v71, v146, v147
    v_mfma_f32_32x32x16_bf16 v[172:187], v[32:35], v[16:19], v[108:123]
    v_exp_f32 v149, v149
    v_exp_f32 v150, v150
    v_cvt_pk_bf16_f32 v72, v148, v149
    v_exp_f32 v151, v151
    v_exp_f32 v152, v152
    v_mfma_f32_32x32x16_bf16 v[172:187], v[36:39], v[20:23], v[172:187]
    v_cvt_pk_bf16_f32 v73, v150, v151
    v_exp_f32 v153, v153
    v_exp_f32 v154, v154
    v_cvt_pk_bf16_f32 v74, v152, v153
    v_exp_f32 v155, v155
    s_nop 0
    v_cvt_pk_bf16_f32 v75, v154, v155
    ds_read_b128 v[24:27], v12 offset:40960
    ds_read_b128 v[28:31], v13 offset:40960
    ds_read_b128 v[32:35], v12 offset:43008
    ds_read_b128 v[36:39], v13 offset:43008
    s_cmp_eq_u32 s14, 0
    s_cbranch_scc0 attn_fix16
attn_fixb16:
    s_waitcnt lgkmcnt(4)
    v_mfma_f32_32x32x16_bf16 v[76:91], v[40:43], v[60:63], v[76:91]
    v_max3_f32 v188, v156, v157, v158
    v_max3_f32 v189, v159, v160, v161
    v_max3_f32 v188, v188, v162, v163
    v_max3_f32 v189, v189, v164, v165
    v_max3_f32 v188, v188, v166, v167
    v_max3_f32 v189, v189, v168, v169
    v_mfma_f32_32x32x16_bf16 v[92:107], v[56:59], v[60:63], v[92:107]
    v_max3_f32 v188, v188, v170, v171
    v_max3_f32 v189, v189, v172, v173
    v_max3_f32 v188, v188, v174, v175
    v_max3_f32 v189, v189, v176, v177
    v_max3_f32 v188, v188, v178, v179
    v_max3_f32 v189, v189, v180, v181
    v_mfma_f32_32x32x16_bf16 v[76:91], v[44:47], v[64:67], v[76:91]
    v_max3_f32 v188, v188, v182, v183
    v_max3_f32 v189, v189, v184, v185
    v_max3_f32 v188, v188, v186, v187
    v_max_f32 v188, v188, v189
    v_cmp_lt_f32 vcc, s11, v188
    s_cbranch_vccnz attn_rare17
attn_back17:
    s_waitcnt lgkmcnt(0)
    v_mfma_f32_32x32x16_bf16 v[92:107], v[56:59], v[64:67], v[92:107]
    v_exp_f32 v156, v156
    v_exp_f32 v157, v157
    v_exp_f32 v158, v158
    v_cvt_pk_bf16_f32 v200, v156, v157
    v_exp_f32 v159, v159
    v_mfma_f32_32x32x16_bf16 v[76:91], v[48:51], v[68:71], v[76:91]
    v_exp_f32 v160, v160
    v_cvt_pk_bf16_f32 v201, v158, v159
    v_exp_f32 v161, v161
    v_exp_f32 v162, v162
    v_cvt_pk_bf16_f32 v202, v160, v161
    v_mfma_f32_32x32x16_bf16 v[92:107], v[56:59], v[68:71], v[92:107]
    v_exp_f32 v163, v163
    v_exp_f32 v164, v164
    v_cvt_pk_bf16_f32 v203, v162, v163
    v_exp_f32 v165, v165
    v_exp_f32 v166, v166
    v_cvt_pk_bf16_f32 v204, v164, v165
    v_mfma_f32_32x32x16_bf16 v[76:91], v[52:55], v[72:75], v[76:91]
    v_exp_f32 v167, v167
    v_exp_f32 v168, v168
    v_cvt_pk_bf16_f32 v205, v166, v167
    v_exp_f32 v169, v169
    v_exp_f32 v170, v170
    v_mfma_f32_32x32x16_bf16 v[92:107], v[56:59], v[72:75], v[92:107]
    ds_read_b128 v[40:43], v14 offset:36864
    ds_read_b128 v[44:47], v14 offset:37888
    ds_read_b128 v[48:51], v14 offset:38912
    ds_read_b128 v[52:55], v14 offset:39936
    v_cvt_pk_bf16_f32 v206, v168, v169
    v_exp_f32 v171, v171
    v_exp_f32 v172, v172
    v_cvt_pk_bf16_f32 v207, v170, v171
    v_exp_f32 v173, v173
    v_mfma_f32_32x32x16_bf16 v[124:139], v[24:27], v[16:19], v[108:123]
    v_exp_f32 v174, v174
    v_cvt_pk_bf16_f32 v208, v172, v173
    v_exp_f32 v175, v175
    v_exp_f32 v176, v176
    v_cvt_pk_bf16_f32 v209, v174, v175
    v_exp_f32 v177, v177
    v_mfma_f32_32x32x16_bf16 v[124:139], v[28:31], v[20:23], v[124:139]
    v_exp_f32 v178, v178
    v_cvt_pk_bf16_f32 v210, v176, v177
    v_exp_f32 v179, v179
    v_exp_f32 v180, v180
    v_cvt_pk_bf16_f32 v211, v178, v179
    v_mfma_f32_32x32x16_bf16 v[140:155], v[32:35], v[16:19], v[108:123]
    v_exp_f32 v181, v181
    v_exp_f32 v182, v182
    v_cvt_pk_bf16_f32 v212, v180, v181
    v_exp_f32 v183, v183
    v_exp_f32 v184, v184
    v_mfma_f32_32x32x16_bf16 v[140:155], v[36:39], v[20:23], v[140:155]
    v_cvt_pk_bf16_f32 v213, v182, v183
    v_exp_f32 v185, v185
    v_exp_f32 v186, v186
    v_cvt_pk_bf16_f32 v214, v184, v185
    v_exp_f32 v187, v187
    s_nop 0
    v_cvt_pk_bf16_f32 v215, v186, v187
    ds_read_b128 v[24:27], v12 offset:45056
    ds_read_b128 v[28:31], v13 offset:45056
    ds_read_b128 v[32:35], v12 offset:47104
    ds_read_b128 v[36:39], v13 offset:47104
    s_cmp_eq_u32 s14, 0
    s_cbranch_scc0 attn_fix17
attn_fixb17:
    s_waitcnt lgkmcnt(4)
    v_mfma_f32_32x32x16_bf16 v[76:91], v[40:43], v[200:203], v[76:91]
    v_max3_f32 v188, v124, v125, v126
    v_max3_f32 v189, v127, v128, v129
    v_max3_f32 v188, v188, v130, v131
    v_max3_f32 v189, v189, v132, v133
    v_max3_f32 v188, v188, v134, v135
    v_max3_f32 v189, v189, v136, v137
    v_mfma_f32_32x32x16_bf16 v[92:107], v[56:59], v[200:203], v[92:107]
    v_max3_f32 v188, v188, v138, v139
    v_max3_f32 v189, v189, v140, v141
    v_max3_f32 v188, v188, v142, v143
    v_max3_f32 v189, v189, v144, v145
    v_max3_f32 v188, v188, v146, v147
    v_max3_f32 v189, v189, v148, v149
    v_mfma_f32_32x32x16_bf16 v[76:91], v[44:47], v[204:207], v[76:91]
    v_max3_f32 v188, v188, v150, v151
    v_max3_f32 v189, v189, v152, v153
    v_max3_f32 v188, v188, v154, v155
    v_max_f32 v188, v188, v189
    v_cmp_lt_f32 vcc, s11, v188
    s_cbranch_vccnz attn_rare18
attn_back18:
    s_waitcnt lgkmcnt(0)
    v_mfma_f32_32x32x16_bf16 v[92:107], v[56:59], v[204:207], v[92:107]
    v_exp_f32 v124, v124
    v_exp_f32 v125, v125
    v_exp_f32 v126, v126
    v_cvt_pk_bf16_f32 v60, v124, v125
    v_exp_f32 v127, v127
    v_mfma_f32_32x32x16_bf16 v[76:91], v[48:51], v[208:211], v[76:91]
    v_exp_f32 v128, v128
    v_cvt_pk_bf16_f32 v61, v126, v127
    v_exp_f32 v129, v129
    v_exp_f32 v130, v130
    v_cvt_pk_bf16_f32 v62, v128, v129
    v_mfma_f32_32x32x16_bf16 v[92:107], v[56:59], v[208:211], v[92:107]
    v_exp_f32 v131, v131
    v_exp_f32 v132, v132
    v_cvt_pk_bf16_f32 v63, v130, v131
    v_exp_f32 v133, v133
    v_exp_f32 v134, v134
    v_cvt_pk_bf16_f32 v64, v132, v133
    v_mfma_f32_32x32x16_bf16 v[76:91], v[52:55], v[212:215], v[76:91]
    v_exp_f32 v135, v135
    v_exp_f32 v136, v136
    v_cvt_pk_bf16_f32 v65, v134, v135
    v_exp_f32 v137, v137
    v_exp_f32 v138, v138
    v_mfma_f32_32x32x16_bf16 v[92:107], v[56:59], v[212:215], v[92:107]
    ds_read_b128 v[40:43], v14 offset:40960
    ds_read_b128 v[44:47], v14 offset:41984
    ds_read_b128 v[48:51], v14 offset:43008
    ds_read_b128 v[52:55], v14 offset:44032
    v_cvt_pk_bf16_f32 v66, v136, v137
    v_exp_f32 v139, v139
    v_exp_f32 v140, v140
    v_cvt_pk_bf16_f32 v67, v138, v139
    v_exp_f32 v141, v141
    v_mfma_f32_32x32x16_bf16 v[156:171], v[24:27], v[16:19], v[108:123]
    v_exp_f32 v142, v142
    v_cvt_pk_bf16_f32 v68, v140, v141
    v_exp_f32 v143, v143
    v_exp_f32 v144, v144
    v_cvt_pk_bf16_f32 v69, v142, v143
    v_exp_f32 v145, v145
    v_mfma_f32_32x32x16_bf16 v[156:171], v[28:31], v[20:23], v[156:171]
    v_exp_f32 v146, v146
    v_cvt_pk_bf16_f32 v70, v144, v145
    v_exp_f32 v147, v147
    v_exp_f32 v148, v148
    v_cvt_pk_bf16_f32 v71, v146, v147
    v_mfma_f32_32x32x16_bf16 v[172:187], v[32:35], v[16:19], v[108:123]
    v_exp_f32 v149, v149
    v_exp_f32 v150, v150
    v_cvt_pk_bf16_f32 v72, v148, v149
    v_exp_f32 v151, v151
    v_exp_f32 v152, v152
    v_mfma_f32_32x32x16_bf16 v[172:187], v[36:39], v[20:23], v[172:187]
    v_cvt_pk_bf16_f32 v73, v150, v151
    v_exp_f32 v153, v153
    v_exp_f32 v154, v154
    v_cvt_pk_bf16_f32 v74, v152, v153
    v_exp_f32 v155, v155
    s_nop 0
    v_cvt_pk_bf16_f32 v75, v154, v155
    s_cmp_eq_u32 s14, 0
    s_cbranch_scc0 attn_fix18
attn_fixb18:
    s_waitcnt lgkmcnt(4)
    v_mfma_f32_32x32x16_bf16 v[76:91], v[40:43], v[60:63], v[76:91]
    v_max3_f32 v188, v156, v157, v158
    v_max3_f32 v189, v159, v160, v161
    v_max3_f32 v188, v188, v162, v163
    v_max3_f32 v189, v189, v164, v165
    v_max3_f32 v188, v188, v166, v167
    v_max3_f32 v189, v189, v168, v169
    v_mfma_f32_32x32x16_bf16 v[92:107], v[56:59], v[60:63], v[92:107]
    v_max3_f32 v188, v188, v170, v171
    v_max3_f32 v189, v189, v172, v173
    v_max3_f32 v188, v188, v174, v175
    v_max3_f32 v189, v189, v176, v177
    v_max3_f32 v188, v188, v178, v179
    v_max3_f32 v189, v189, v180, v181
    v_mfma_f32_32x32x16_bf16 v[76:91], v[44:47], v[64:67], v[76:91]
    v_max3_f32 v188, v188, v182, v183
    v_max3_f32 v189, v189, v184, v185
    v_max3_f32 v188, v188, v186, v187
    v_max_f32 v188, v188, v189
    v_cmp_lt_f32 vcc, s11, v188
    s_cbranch_vccnz attn_rare19
attn_back19:
    v_mfma_f32_32x32x16_bf16 v[92:107], v[56:59], v[64:67], v[92:107]
    v_exp_f32 v156, v156
    v_exp_f32 v157, v157
    v_exp_f32 v158, v158
    v_cvt_pk_bf16_f32 v200, v156, v157
    v_exp_f32 v159, v159
    v_exp_f32 v160, v160
    v_cvt_pk_bf16_f32 v201, v158, v159
    v_exp_f32 v161, v161
    v_exp_f32 v162, v162
    v_mfma_f32_32x32x16_bf16 v[76:91], v[48:51], v[68:71], v[76:91]
    v_cvt_pk_bf16_f32 v202, v160, v161
    v_exp_f32 v163, v163
    v_exp_f32 v164, v164
    v_cvt_pk_bf16_f32 v203, v162, v163
    v_exp_f32 v165, v165
    v_exp_f32 v166, v166
    v_cvt_pk_bf16_f32 v204, v164, v165
    v_exp_f32 v167, v167
    v_exp_f32 v168, v168
    v_cvt_pk_bf16_f32 v205, v166, v167
    v_mfma_f32_32x32x16_bf16 v[92:107], v[56:59], v[68:71], v[92:107]
    v_exp_f32 v169, v169
    v_exp_f32 v170, v170
    v_cvt_pk_bf16_f32 v206, v168, v169
    v_exp_f32 v171, v171
    v_exp_f32 v172, v172
    v_cvt_pk_bf16_f32 v207, v170, v171
    v_exp_f32 v173, v173
    v_exp_f32 v174, v174
    v_cvt_pk_bf16_f32 v208, v172, v173
    v_mfma_f32_32x32x16_bf16 v[76:91], v[52:55], v[72:75], v[76:91]
    v_exp_f32 v175, v175
    v_exp_f32 v176, v176
    v_cvt_pk_bf16_f32 v209, v174, v175
    v_exp_f32 v177, v177
    v_exp_f32 v178, v178
    v_cvt_pk_bf16_f32 v210, v176, v177
    v_exp_f32 v179, v179
    v_exp_f32 v180, v180
    v_cvt_pk_bf16_f32 v211, v178, v179
    v_exp_f32 v181, v181
    v_mfma_f32_32x32x16_bf16 v[92:107], v[56:59], v[72:75], v[92:107]
    ds_read_b128 v[40:43], v14 offset:45056
    ds_read_b128 v[44:47], v14 offset:46080
    ds_read_b128 v[48:51], v14 offset:47104
    ds_read_b128 v[52:55], v14 offset:48128
    v_exp_f32 v182, v182
    v_cvt_pk_bf16_f32 v212, v180, v181
    v_exp_f32 v183, v183
    v_exp_f32 v184, v184
    v_cvt_pk_bf16_f32 v213, v182, v183
    v_exp_f32 v185, v185
    v_exp_f32 v186, v186
    v_cvt_pk_bf16_f32 v214, v184, v185
    v_exp_f32 v187, v187
    s_nop 0
    v_cvt_pk_bf16_f32 v215, v186, v187
    s_cmp_eq_u32 s14, 0
    s_cbranch_scc0 attn_fix19
attn_fixb19:
    s_waitcnt lgkmcnt(0)
    v_mfma_f32_32x32x16_bf16 v[76:91], v[40:43], v[200:203], v[76:91]
    v_mfma_f32_32x32x16_bf16 v[92:107], v[56:59], v[200:203], v[92:107]
    v_mfma_f32_32x32x16_bf16 v[76:91], v[44:47], v[204:207], v[76:91]
    v_mfma_f32_32x32x16_bf16 v[92:107], v[56:59], v[204:207], v[92:107]
    v_mfma_f32_32x32x16_bf16 v[76:91], v[48:51], v[208:211], v[76:91]
    v_mfma_f32_32x32x16_bf16 v[92:107], v[56:59], v[208:211], v[92:107]
    v_mfma_f32_32x32x16_bf16 v[76:91], v[52:55], v[212:215], v[76:91]
    v_mfma_f32_32x32x16_bf16 v[92:107], v[56:59], v[212:215], v[92:107]
    s_nop 15
    v_rcp_f32 v188, v92
    s_nop 0
    v_mul_f32 v76, v76, v188
    v_mul_f32 v77, v77, v188
    v_mul_f32 v78, v78, v188
    v_mul_f32 v79, v79, v188
    v_mul_f32 v80, v80, v188
    v_mul_f32 v81, v81, v188
    v_mul_f32 v82, v82, v188
    v_mul_f32 v83, v83, v188
    v_mul_f32 v84, v84, v188
    v_mul_f32 v85, v85, v188
    v_mul_f32 v86, v86, v188
    v_mul_f32 v87, v87, v188
    v_mul_f32 v88, v88, v188
    v_mul_f32 v89, v89, v188
    v_mul_f32 v90, v90, v188
    v_mul_f32 v91, v91, v188
    v_cvt_pk_bf16_f32 v60, v76, v77
    v_cvt_pk_bf16_f32 v61, v78, v79
    v_cvt_pk_bf16_f32 v62, v80, v81
    v_cvt_pk_bf16_f32 v63, v82, v83
    v_cvt_pk_bf16_f32 v64, v84, v85
    v_cvt_pk_bf16_f32 v65, v86, v87
    v_cvt_pk_bf16_f32 v66, v88, v89
    v_cvt_pk_bf16_f32 v67, v90, v91
    v_lshlrev_b32 v6, 11, v5
    s_lshl_b32 s8, s3, 6
    v_add_u32 v6, s8, v6
    v_lshl_add_u32 v6, v4, 4, v6
    v_permlane32_swap_b32 v60, v62
    v_permlane32_swap_b32 v61, v63
    buffer_store_dwordx4 v[60:63], v6, s[52:55], 0 offen
    v_permlane32_swap_b32 v64, v66
    v_permlane32_swap_b32 v65, v67
    buffer_store_dwordx4 v[64:67], v6, s[52:55], 0 offen offset:32
    s_waitcnt vmcnt(0)
    s_endpgm
attn_rare0:
    s_nop 15
    v_mov_b32 v189, v188
    v_mov_b32 v190, v188
    s_nop 1
    v_permlane32_swap_b32 v189, v190
    v_max_f32 v188, v189, v190
    v_max_f32 v188, s12, v188
    v_sub_f32 v189, 0, v188
    v_exp_f32 v216, v189
    v_sub_f32 v108, v108, v188
    v_sub_f32 v109, v109, v188
    v_sub_f32 v110, v110, v188
    v_sub_f32 v111, v111, v188
    v_sub_f32 v112, v112, v188
    v_sub_f32 v113, v113, v188
    v_sub_f32 v114, v114, v188
    v_sub_f32 v115, v115, v188
    v_sub_f32 v116, v116, v188
    v_sub_f32 v117, v117, v188
    v_sub_f32 v118, v118, v188
    v_sub_f32 v119, v119, v188
    v_sub_f32 v120, v120, v188
    v_sub_f32 v121, v121, v188
    v_sub_f32 v122, v122, v188
    v_sub_f32 v123, v123, v188
    v_sub_f32 v124, v124, v188
    v_sub_f32 v125, v125, v188
    v_sub_f32 v126, v126, v188
    v_sub_f32 v127, v127, v188
    v_sub_f32 v128, v128, v188
    v_sub_f32 v129, v129, v188
    v_sub_f32 v130, v130, v188
    v_sub_f32 v131, v131, v188
    v_sub_f32 v132, v132, v188
    v_sub_f32 v133, v133, v188
    v_sub_f32 v134, v134, v188
    v_sub_f32 v135, v135, v188
    v_sub_f32 v136, v136, v188
    v_sub_f32 v137, v137, v188
    v_sub_f32 v138, v138, v188
    v_sub_f32 v139, v139, v188
    v_sub_f32 v140, v140, v188
    v_sub_f32 v141, v141, v188
    v_sub_f32 v142, v142, v188
    v_sub_f32 v143, v143, v188
    v_sub_f32 v144, v144, v188
    v_sub_f32 v145, v145, v188
    v_sub_f32 v146, v146, v188
    v_sub_f32 v147, v147, v188
    v_sub_f32 v148, v148, v188
    v_sub_f32 v149, v149, v188
    v_sub_f32 v150, v150, v188
    v_sub_f32 v151, v151, v188
    v_sub_f32 v152, v152, v188
    v_sub_f32 v153, v153, v188
    v_sub_f32 v154, v154, v188
    v_sub_f32 v155, v155, v188
    s_mov_b32 s14, 1
    s_mov_b32 s11, 0x42400000
    s_mov_b32 s12, 0
    s_nop 3
    s_branch attn_back0
attn_rare1:
    s_nop 15
    v_mov_b32 v189, v188
    v_mov_b32 v190, v188
    s_nop 1
    v_permlane32_swap_b32 v189, v190
    v_max_f32 v188, v189, v190
    v_max_f32 v188, s12, v188
    v_sub_f32 v189, 0, v188
    v_exp_f32 v216, v189
    v_sub_f32 v108, v108, v188
    v_sub_f32 v109, v109, v188
    v_sub_f32 v110, v110, v188
    v_sub_f32 v111, v111, v188
    v_sub_f32 v112, v112, v188
    v_sub_f32 v113, v113, v188
    v_sub_f32 v114, v114, v188
    v_sub_f32 v115, v115, v188
    v_sub_f32 v116, v116, v188
    v_sub_f32 v117, v117, v188
    v_sub_f32 v118, v118, v188
    v_sub_f32 v119, v119, v188
    v_sub_f32 v120, v120, v188
    v_sub_f32 v121, v121, v188
    v_sub_f32 v122, v122, v188
    v_sub_f32 v123, v123, v188
    v_sub_f32 v156, v156, v188
    v_sub_f32 v157, v157, v188
    v_sub_f32 v158, v158, v188
    v_sub_f32 v159, v159, v188
    v_sub_f32 v160, v160, v188
    v_sub_f32 v161, v161, v188
    v_sub_f32 v162, v162, v188
    v_sub_f32 v163, v163, v188
    v_sub_f32 v164, v164, v188
    v_sub_f32 v165, v165, v188
    v_sub_f32 v166, v166, v188
    v_sub_f32 v167, v167, v188
    v_sub_f32 v168, v168, v188
    v_sub_f32 v169, v169, v188
    v_sub_f32 v170, v170, v188
    v_sub_f32 v171, v171, v188
    v_sub_f32 v172, v172, v188
    v_sub_f32 v173, v173, v188
    v_sub_f32 v174, v174, v188
    v_sub_f32 v175, v175, v188
    v_sub_f32 v176, v176, v188
    v_sub_f32 v177, v177, v188
    v_sub_f32 v178, v178, v188
    v_sub_f32 v179, v179, v188
    v_sub_f32 v180, v180, v188
    v_sub_f32 v181, v181, v188
    v_sub_f32 v182, v182, v188
    v_sub_f32 v183, v183, v188
    v_sub_f32 v184, v184, v188
    v_sub_f32 v185, v185, v188
    v_sub_f32 v186, v186, v188
    v_sub_f32 v187, v187, v188
    s_mov_b32 s14, 1
    s_mov_b32 s11, 0x42400000
    s_mov_b32 s12, 0
    s_nop 3
    s_branch attn_back1
attn_rare2:
    s_nop 15
    v_mov_b32 v189, v188
    v_mov_b32 v190, v188
    s_nop 1
    v_permlane32_swap_b32 v189, v190
    v_max_f32 v188, v189, v190
    v_max_f32 v188, s12, v188
    v_sub_f32 v189, 0, v188
    v_exp_f32 v216, v189
    v_sub_f32 v108, v108, v188
    v_sub_f32 v109, v109, v188
    v_sub_f32 v110, v110, v188
    v_sub_f32 v111, v111, v188
    v_sub_f32 v112, v112, v188
    v_sub_f32 v113, v113, v188
    v_sub_f32 v114, v114, v188
    v_sub_f32 v115, v115, v188
    v_sub_f32 v116, v116, v188
    v_sub_f32 v117, v117, v188
    v_sub_f32 v118, v118, v188
    v_sub_f32 v119, v119, v188
    v_sub_f32 v120, v120, v188
    v_sub_f32 v121, v121, v188
    v_sub_f32 v122, v122, v188
    v_sub_f32 v123, v123, v188
    v_sub_f32 v124, v124, v188
    v_sub_f32 v125, v125, v188
    v_sub_f32 v126, v126, v188
    v_sub_f32 v127, v127, v188
    v_sub_f32 v128, v128, v188
    v_sub_f32 v129, v129, v188
    v_sub_f32 v130, v130, v188
    v_sub_f32 v131, v131, v188
    v_sub_f32 v132, v132, v188
    v_sub_f32 v133, v133, v188
    v_sub_f32 v134, v134, v188
    v_sub_f32 v135, v135, v188
    v_sub_f32 v136, v136, v188
    v_sub_f32 v137, v137, v188
    v_sub_f32 v138, v138, v188
    v_sub_f32 v139, v139, v188
    v_sub_f32 v140, v140, v188
    v_sub_f32 v141, v141, v188
    v_sub_f32 v142, v142, v188
    v_sub_f32 v143, v143, v188
    v_sub_f32 v144, v144, v188
    v_sub_f32 v145, v145, v188
    v_sub_f32 v146, v146, v188
    v_sub_f32 v147, v147, v188
    v_sub_f32 v148, v148, v188
    v_sub_f32 v149, v149, v188
    v_sub_f32 v150, v150, v188
    v_sub_f32 v151, v151, v188
    v_sub_f32 v152, v152, v188
    v_sub_f32 v153, v153, v188
    v_sub_f32 v154, v154, v188
    v_sub_f32 v155, v155, v188
    s_mov_b32 s14, 1
    s_mov_b32 s11, 0x42400000
    s_mov_b32 s12, 0
    s_nop 3
    s_branch attn_back2
attn_rare3:
    s_nop 15
    v_mov_b32 v189, v188
    v_mov_b32 v190, v188
    s_nop 1
    v_permlane32_swap_b32 v189, v190
    v_max_f32 v188, v189, v190
    v_max_f32 v188, s12, v188
    v_sub_f32 v189, 0, v188
    v_exp_f32 v216, v189
    v_sub_f32 v108, v108, v188
    v_sub_f32 v109, v109, v188
    v_sub_f32 v110, v110, v188
    v_sub_f32 v111, v111, v188
    v_sub_f32 v112, v112, v188
    v_sub_f32 v113, v113, v188
    v_sub_f32 v114, v114, v188
    v_sub_f32 v115, v115, v188
    v_sub_f32 v116, v116, v188
    v_sub_f32 v117, v117, v188
    v_sub_f32 v118, v118, v188
    v_sub_f32 v119, v119, v188
    v_sub_f32 v120, v120, v188
    v_sub_f32 v121, v121, v188
    v_sub_f32 v122, v122, v188
    v_sub_f32 v123, v123, v188
    v_sub_f32 v156, v156, v188
    v_sub_f32 v157, v157, v188
    v_sub_f32 v158, v158, v188
    v_sub_f32 v159, v159, v188
    v_sub_f32 v160, v160, v188
    v_sub_f32 v161, v161, v188
    v_sub_f32 v162, v162, v188
    v_sub_f32 v163, v163, v188
    v_sub_f32 v164, v164, v188
    v_sub_f32 v165, v165, v188
    v_sub_f32 v166, v166, v188
    v_sub_f32 v167, v167, v188
    v_sub_f32 v168, v168, v188
    v_sub_f32 v169, v169, v188
    v_sub_f32 v170, v170, v188
    v_sub_f32 v171, v171, v188
    v_sub_f32 v172, v172, v188
    v_sub_f32 v173, v173, v188
    v_sub_f32 v174, v174, v188
    v_sub_f32 v175, v175, v188
    v_sub_f32 v176, v176, v188
    v_sub_f32 v177, v177, v188
    v_sub_f32 v178, v178, v188
    v_sub_f32 v179, v179, v188
    v_sub_f32 v180, v180, v188
    v_sub_f32 v181, v181, v188
    v_sub_f32 v182, v182, v188
    v_sub_f32 v183, v183, v188
    v_sub_f32 v184, v184, v188
    v_sub_f32 v185, v185, v188
    v_sub_f32 v186, v186, v188
    v_sub_f32 v187, v187, v188
    s_mov_b32 s14, 1
    s_mov_b32 s11, 0x42400000
    s_mov_b32 s12, 0
    s_nop 3
    s_branch attn_back3
attn_rare4:
    s_nop 15
    v_mov_b32 v189, v188
    v_mov_b32 v190, v188
    s_nop 1
    v_permlane32_swap_b32 v189, v190
    v_max_f32 v188, v189, v190
    v_max_f32 v188, s12, v188
    v_sub_f32 v189, 0, v188
    v_exp_f32 v216, v189
    v_sub_f32 v108, v108, v188
    v_sub_f32 v109, v109, v188
    v_sub_f32 v110, v110, v188
    v_sub_f32 v111, v111, v188
    v_sub_f32 v112, v112, v188
    v_sub_f32 v113, v113, v188
    v_sub_f32 v114, v114, v188
    v_sub_f32 v115, v115, v188
    v_sub_f32 v116, v116, v188
    v_sub_f32 v117, v117, v188
    v_sub_f32 v118, v118, v188
    v_sub_f32 v119, v119, v188
    v_sub_f32 v120, v120, v188
    v_sub_f32 v121, v121, v188
    v_sub_f32 v122, v122, v188
    v_sub_f32 v123, v123, v188
    v_sub_f32 v124, v124, v188
    v_sub_f32 v125, v125, v188
    v_sub_f32 v126, v126, v188
    v_sub_f32 v127, v127, v188
    v_sub_f32 v128, v128, v188
    v_sub_f32 v129, v129, v188
    v_sub_f32 v130, v130, v188
    v_sub_f32 v131, v131, v188
    v_sub_f32 v132, v132, v188
    v_sub_f32 v133, v133, v188
    v_sub_f32 v134, v134, v188
    v_sub_f32 v135, v135, v188
    v_sub_f32 v136, v136, v188
    v_sub_f32 v137, v137, v188
    v_sub_f32 v138, v138, v188
    v_sub_f32 v139, v139, v188
    v_sub_f32 v140, v140, v188
    v_sub_f32 v141, v141, v188
    v_sub_f32 v142, v142, v188
    v_sub_f32 v143, v143, v188
    v_sub_f32 v144, v144, v188
    v_sub_f32 v145, v145, v188
    v_sub_f32 v146, v146, v188
    v_sub_f32 v147, v147, v188
    v_sub_f32 v148, v148, v188
    v_sub_f32 v149, v149, v188
    v_sub_f32 v150, v150, v188
    v_sub_f32 v151, v151, v188
    v_sub_f32 v152, v152, v188
    v_sub_f32 v153, v153, v188
    v_sub_f32 v154, v154, v188
    v_sub_f32 v155, v155, v188
    s_mov_b32 s14, 1
    s_mov_b32 s11, 0x42400000
    s_mov_b32 s12, 0
    s_nop 3
    s_branch attn_back4
attn_rare5:
    s_nop 15
    v_mov_b32 v189, v188
    v_mov_b32 v190, v188
    s_nop 1
    v_permlane32_swap_b32 v189, v190
    v_max_f32 v188, v189, v190
    v_max_f32 v188, s12, v188
    v_sub_f32 v189, 0, v188
    v_exp_f32 v216, v189
    v_sub_f32 v108, v108, v188
    v_sub_f32 v109, v109, v188
    v_sub_f32 v110, v110, v188
    v_sub_f32 v111, v111, v188
    v_sub_f32 v112, v112, v188
    v_sub_f32 v113, v113, v188
    v_sub_f32 v114, v114, v188
    v_sub_f32 v115, v115, v188
    v_sub_f32 v116, v116, v188
    v_sub_f32 v117, v117, v188
    v_sub_f32 v118, v118, v188
    v_sub_f32 v119, v119, v188
    v_sub_f32 v120, v120, v188
    v_sub_f32 v121, v121, v188
    v_sub_f32 v122, v122, v188
    v_sub_f32 v123, v123, v188
    v_sub_f32 v156, v156, v188
    v_sub_f32 v157, v157, v188
    v_sub_f32 v158, v158, v188
    v_sub_f32 v159, v159, v188
    v_sub_f32 v160, v160, v188
    v_sub_f32 v161, v161, v188
    v_sub_f32 v162, v162, v188
    v_sub_f32 v163, v163, v188
    v_sub_f32 v164, v164, v188
    v_sub_f32 v165, v165, v188
    v_sub_f32 v166, v166, v188
    v_sub_f32 v167, v167, v188
    v_sub_f32 v168, v168, v188
    v_sub_f32 v169, v169, v188
    v_sub_f32 v170, v170, v188
    v_sub_f32 v171, v171, v188
    v_sub_f32 v172, v172, v188
    v_sub_f32 v173, v173, v188
    v_sub_f32 v174, v174, v188
    v_sub_f32 v175, v175, v188
    v_sub_f32 v176, v176, v188
    v_sub_f32 v177, v177, v188
    v_sub_f32 v178, v178, v188
    v_sub_f32 v179, v179, v188
    v_sub_f32 v180, v180, v188
    v_sub_f32 v181, v181, v188
    v_sub_f32 v182, v182, v188
    v_sub_f32 v183, v183, v188
    v_sub_f32 v184, v184, v188
    v_sub_f32 v185, v185, v188
    v_sub_f32 v186, v186, v188
    v_sub_f32 v187, v187, v188
    s_mov_b32 s14, 1
    s_mov_b32 s11, 0x42400000
    s_mov_b32 s12, 0
    s_nop 3
    s_branch attn_back5
attn_rare6:
    s_nop 15
    v_mov_b32 v189, v188
    v_mov_b32 v190, v188
    s_nop 1
    v_permlane32_swap_b32 v189, v190
    v_max_f32 v188, v189, v190
    v_max_f32 v188, s12, v188
    v_sub_f32 v189, 0, v188
    v_exp_f32 v216, v189
    v_sub_f32 v108, v108, v188
    v_sub_f32 v109, v109, v188
    v_sub_f32 v110, v110, v188
    v_sub_f32 v111, v111, v188
    v_sub_f32 v112, v112, v188
    v_sub_f32 v113, v113, v188
    v_sub_f32 v114, v114, v188
    v_sub_f32 v115, v115, v188
    v_sub_f32 v116, v116, v188
    v_sub_f32 v117, v117, v188
    v_sub_f32 v118, v118, v188
    v_sub_f32 v119, v119, v188
    v_sub_f32 v120, v120, v188
    v_sub_f32 v121, v121, v188
    v_sub_f32 v122, v122, v188
    v_sub_f32 v123, v123, v188
    v_sub_f32 v124, v124, v188
    v_sub_f32 v125, v125, v188
    v_sub_f32 v126, v126, v188
    v_sub_f32 v127, v127, v188
    v_sub_f32 v128, v128, v188
    v_sub_f32 v129, v129, v188
    v_sub_f32 v130, v130, v188
    v_sub_f32 v131, v131, v188
    v_sub_f32 v132, v132, v188
    v_sub_f32 v133, v133, v188
    v_sub_f32 v134, v134, v188
    v_sub_f32 v135, v135, v188
    v_sub_f32 v136, v136, v188
    v_sub_f32 v137, v137, v188
    v_sub_f32 v138, v138, v188
    v_sub_f32 v139, v139, v188
    v_sub_f32 v140, v140, v188
    v_sub_f32 v141, v141, v188
    v_sub_f32 v142, v142, v188
    v_sub_f32 v143, v143, v188
    v_sub_f32 v144, v144, v188
    v_sub_f32 v145, v145, v188
    v_sub_f32 v146, v146, v188
    v_sub_f32 v147, v147, v188
    v_sub_f32 v148, v148, v188
    v_sub_f32 v149, v149, v188
    v_sub_f32 v150, v150, v188
    v_sub_f32 v151, v151, v188
    v_sub_f32 v152, v152, v188
    v_sub_f32 v153, v153, v188
    v_sub_f32 v154, v154, v188
    v_sub_f32 v155, v155, v188
    s_mov_b32 s14, 1
    s_mov_b32 s11, 0x42400000
    s_mov_b32 s12, 0
    s_nop 3
    s_branch attn_back6
attn_rare7:
    s_nop 15
    v_mov_b32 v189, v188
    v_mov_b32 v190, v188
    s_nop 1
    v_permlane32_swap_b32 v189, v190
    v_max_f32 v188, v189, v190
    v_max_f32 v188, s12, v188
    v_sub_f32 v189, 0, v188
    v_exp_f32 v216, v189
    v_sub_f32 v108, v108, v188
    v_sub_f32 v109, v109, v188
    v_sub_f32 v110, v110, v188
    v_sub_f32 v111, v111, v188
    v_sub_f32 v112, v112, v188
    v_sub_f32 v113, v113, v188
    v_sub_f32 v114, v114, v188
    v_sub_f32 v115, v115, v188
    v_sub_f32 v116, v116, v188
    v_sub_f32 v117, v117, v188
    v_sub_f32 v118, v118, v188
    v_sub_f32 v119, v119, v188
    v_sub_f32 v120, v120, v188
    v_sub_f32 v121, v121, v188
    v_sub_f32 v122, v122, v188
    v_sub_f32 v123, v123, v188
    v_sub_f32 v156, v156, v188
    v_sub_f32 v157, v157, v188
    v_sub_f32 v158, v158, v188
    v_sub_f32 v159, v159, v188
    v_sub_f32 v160, v160, v188
    v_sub_f32 v161, v161, v188
    v_sub_f32 v162, v162, v188
    v_sub_f32 v163, v163, v188
    v_sub_f32 v164, v164, v188
    v_sub_f32 v165, v165, v188
    v_sub_f32 v166, v166, v188
    v_sub_f32 v167, v167, v188
    v_sub_f32 v168, v168, v188
    v_sub_f32 v169, v169, v188
    v_sub_f32 v170, v170, v188
    v_sub_f32 v171, v171, v188
    v_sub_f32 v172, v172, v188
    v_sub_f32 v173, v173, v188
    v_sub_f32 v174, v174, v188
    v_sub_f32 v175, v175, v188
    v_sub_f32 v176, v176, v188
    v_sub_f32 v177, v177, v188
    v_sub_f32 v178, v178, v188
    v_sub_f32 v179, v179, v188
    v_sub_f32 v180, v180, v188
    v_sub_f32 v181, v181, v188
    v_sub_f32 v182, v182, v188
    v_sub_f32 v183, v183, v188
    v_sub_f32 v184, v184, v188
    v_sub_f32 v185, v185, v188
    v_sub_f32 v186, v186, v188
    v_sub_f32 v187, v187, v188
    s_mov_b32 s14, 1
    s_mov_b32 s11, 0x42400000
    s_mov_b32 s12, 0
    s_nop 3
    s_branch attn_back7
attn_rare8:
    s_nop 15
    v_mov_b32 v189, v188
    v_mov_b32 v190, v188
    s_nop 1
    v_permlane32_swap_b32 v189, v190
    v_max_f32 v188, v189, v190
    v_max_f32 v188, s12, v188
    v_sub_f32 v189, 0, v188
    v_exp_f32 v216, v189
    v_sub_f32 v108, v108, v188
    v_sub_f32 v109, v109, v188
    v_sub_f32 v110, v110, v188
    v_sub_f32 v111, v111, v188
    v_sub_f32 v112, v112, v188
    v_sub_f32 v113, v113, v188
    v_sub_f32 v114, v114, v188
    v_sub_f32 v115, v115, v188
    v_sub_f32 v116, v116, v188
    v_sub_f32 v117, v117, v188
    v_sub_f32 v118, v118, v188
    v_sub_f32 v119, v119, v188
    v_sub_f32 v120, v120, v188
    v_sub_f32 v121, v121, v188
    v_sub_f32 v122, v122, v188
    v_sub_f32 v123, v123, v188
    v_sub_f32 v124, v124, v188
    v_sub_f32 v125, v125, v188
    v_sub_f32 v126, v126, v188
    v_sub_f32 v127, v127, v188
    v_sub_f32 v128, v128, v188
    v_sub_f32 v129, v129, v188
    v_sub_f32 v130, v130, v188
    v_sub_f32 v131, v131, v188
    v_sub_f32 v132, v132, v188
    v_sub_f32 v133, v133, v188
    v_sub_f32 v134, v134, v188
    v_sub_f32 v135, v135, v188
    v_sub_f32 v136, v136, v188
    v_sub_f32 v137, v137, v188
    v_sub_f32 v138, v138, v188
    v_sub_f32 v139, v139, v188
    v_sub_f32 v140, v140, v188
    v_sub_f32 v141, v141, v188
    v_sub_f32 v142, v142, v188
    v_sub_f32 v143, v143, v188
    v_sub_f32 v144, v144, v188
    v_sub_f32 v145, v145, v188
    v_sub_f32 v146, v146, v188
    v_sub_f32 v147, v147, v188
    v_sub_f32 v148, v148, v188
    v_sub_f32 v149, v149, v188
    v_sub_f32 v150, v150, v188
    v_sub_f32 v151, v151, v188
    v_sub_f32 v152, v152, v188
    v_sub_f32 v153, v153, v188
    v_sub_f32 v154, v154, v188
    v_sub_f32 v155, v155, v188
    s_mov_b32 s14, 1
    s_mov_b32 s11, 0x42400000
    s_mov_b32 s12, 0
    s_nop 3
    s_branch attn_back8
attn_rare9:
    s_nop 15
    v_mov_b32 v189, v188
    v_mov_b32 v190, v188
    s_nop 1
    v_permlane32_swap_b32 v189, v190
    v_max_f32 v188, v189, v190
    v_max_f32 v188, s12, v188
    v_sub_f32 v189, 0, v188
    v_exp_f32 v216, v189
    v_sub_f32 v108, v108, v188
    v_sub_f32 v109, v109, v188
    v_sub_f32 v110, v110, v188
    v_sub_f32 v111, v111, v188
    v_sub_f32 v112, v112, v188
    v_sub_f32 v113, v113, v188
    v_sub_f32 v114, v114, v188
    v_sub_f32 v115, v115, v188
    v_sub_f32 v116, v116, v188
    v_sub_f32 v117, v117, v188
    v_sub_f32 v118, v118, v188
    v_sub_f32 v119, v119, v188
    v_sub_f32 v120, v120, v188
    v_sub_f32 v121, v121, v188
    v_sub_f32 v122, v122, v188
    v_sub_f32 v123, v123, v188
    v_sub_f32 v156, v156, v188
    v_sub_f32 v157, v157, v188
    v_sub_f32 v158, v158, v188
    v_sub_f32 v159, v159, v188
    v_sub_f32 v160, v160, v188
    v_sub_f32 v161, v161, v188
    v_sub_f32 v162, v162, v188
    v_sub_f32 v163, v163, v188
    v_sub_f32 v164, v164, v188
    v_sub_f32 v165, v165, v188
    v_sub_f32 v166, v166, v188
    v_sub_f32 v167, v167, v188
    v_sub_f32 v168, v168, v188
    v_sub_f32 v169, v169, v188
    v_sub_f32 v170, v170, v188
    v_sub_f32 v171, v171, v188
    v_sub_f32 v172, v172, v188
    v_sub_f32 v173, v173, v188
    v_sub_f32 v174, v174, v188
    v_sub_f32 v175, v175, v188
    v_sub_f32 v176, v176, v188
    v_sub_f32 v177, v177, v188
    v_sub_f32 v178, v178, v188
    v_sub_f32 v179, v179, v188
    v_sub_f32 v180, v180, v188
    v_sub_f32 v181, v181, v188
    v_sub_f32 v182, v182, v188
    v_sub_f32 v183, v183, v188
    v_sub_f32 v184, v184, v188
    v_sub_f32 v185, v185, v188
    v_sub_f32 v186, v186, v188
    v_sub_f32 v187, v187, v188
    s_mov_b32 s14, 1
    s_mov_b32 s11, 0x42400000
    s_mov_b32 s12, 0
    s_nop 3
    s_branch attn_back9
attn_rare10:
    s_nop 15
    v_mov_b32 v189, v188
    v_mov_b32 v190, v188
    s_nop 1
    v_permlane32_swap_b32 v189, v190
    v_max_f32 v188, v189, v190
    v_max_f32 v188, s12, v188
    v_sub_f32 v189, 0, v188
    v_exp_f32 v216, v189
    v_sub_f32 v108, v108, v188
    v_sub_f32 v109, v109, v188
    v_sub_f32 v110, v110, v188
    v_sub_f32 v111, v111, v188
    v_sub_f32 v112, v112, v188
    v_sub_f32 v113, v113, v188
    v_sub_f32 v114, v114, v188
    v_sub_f32 v115, v115, v188
    v_sub_f32 v116, v116, v188
    v_sub_f32 v117, v117, v188
    v_sub_f32 v118, v118, v188
    v_sub_f32 v119, v119, v188
    v_sub_f32 v120, v120, v188
    v_sub_f32 v121, v121, v188
    v_sub_f32 v122, v122, v188
    v_sub_f32 v123, v123, v188
    v_sub_f32 v124, v124, v188
    v_sub_f32 v125, v125, v188
    v_sub_f32 v126, v126, v188
    v_sub_f32 v127, v127, v188
    v_sub_f32 v128, v128, v188
    v_sub_f32 v129, v129, v188
    v_sub_f32 v130, v130, v188
    v_sub_f32 v131, v131, v188
    v_sub_f32 v132, v132, v188
    v_sub_f32 v133, v133, v188
    v_sub_f32 v134, v134, v188
    v_sub_f32 v135, v135, v188
    v_sub_f32 v136, v136, v188
    v_sub_f32 v137, v137, v188
    v_sub_f32 v138, v138, v188
    v_sub_f32 v139, v139, v188
    v_sub_f32 v140, v140, v188
    v_sub_f32 v141, v141, v188
    v_sub_f32 v142, v142, v188
    v_sub_f32 v143, v143, v188
    v_sub_f32 v144, v144, v188
    v_sub_f32 v145, v145, v188
    v_sub_f32 v146, v146, v188
    v_sub_f32 v147, v147, v188
    v_sub_f32 v148, v148, v188
    v_sub_f32 v149, v149, v188
    v_sub_f32 v150, v150, v188
    v_sub_f32 v151, v151, v188
    v_sub_f32 v152, v152, v188
    v_sub_f32 v153, v153, v188
    v_sub_f32 v154, v154, v188
    v_sub_f32 v155, v155, v188
    s_mov_b32 s14, 1
    s_mov_b32 s11, 0x42400000
    s_mov_b32 s12, 0
    s_nop 3
    s_branch attn_back10
attn_rare11:
    s_nop 15
    v_mov_b32 v189, v188
    v_mov_b32 v190, v188
    s_nop 1
    v_permlane32_swap_b32 v189, v190
    v_max_f32 v188, v189, v190
    v_max_f32 v188, s12, v188
    v_sub_f32 v189, 0, v188
    v_exp_f32 v216, v189
    v_sub_f32 v108, v108, v188
    v_sub_f32 v109, v109, v188
    v_sub_f32 v110, v110, v188
    v_sub_f32 v111, v111, v188
    v_sub_f32 v112, v112, v188
    v_sub_f32 v113, v113, v188
    v_sub_f32 v114, v114, v188
    v_sub_f32 v115, v115, v188
    v_sub_f32 v116, v116, v188
    v_sub_f32 v117, v117, v188
    v_sub_f32 v118, v118, v188
    v_sub_f32 v119, v119, v188
    v_sub_f32 v120, v120, v188
    v_sub_f32 v121, v121, v188
    v_sub_f32 v122, v122, v188
    v_sub_f32 v123, v123, v188
    v_sub_f32 v156, v156, v188
    v_sub_f32 v157, v157, v188
    v_sub_f32 v158, v158, v188
    v_sub_f32 v159, v159, v188
    v_sub_f32 v160, v160, v188
    v_sub_f32 v161, v161, v188
    v_sub_f32 v162, v162, v188
    v_sub_f32 v163, v163, v188
    v_sub_f32 v164, v164, v188
    v_sub_f32 v165, v165, v188
    v_sub_f32 v166, v166, v188
    v_sub_f32 v167, v167, v188
    v_sub_f32 v168, v168, v188
    v_sub_f32 v169, v169, v188
    v_sub_f32 v170, v170, v188
    v_sub_f32 v171, v171, v188
    v_sub_f32 v172, v172, v188
    v_sub_f32 v173, v173, v188
    v_sub_f32 v174, v174, v188
    v_sub_f32 v175, v175, v188
    v_sub_f32 v176, v176, v188
    v_sub_f32 v177, v177, v188
    v_sub_f32 v178, v178, v188
    v_sub_f32 v179, v179, v188
    v_sub_f32 v180, v180, v188
    v_sub_f32 v181, v181, v188
    v_sub_f32 v182, v182, v188
    v_sub_f32 v183, v183, v188
    v_sub_f32 v184, v184, v188
    v_sub_f32 v185, v185, v188
    v_sub_f32 v186, v186, v188
    v_sub_f32 v187, v187, v188
    s_mov_b32 s14, 1
    s_mov_b32 s11, 0x42400000
    s_mov_b32 s12, 0
    s_nop 3
    s_branch attn_back11
attn_rare12:
    s_nop 15
    v_mov_b32 v189, v188
    v_mov_b32 v190, v188
    s_nop 1
    v_permlane32_swap_b32 v189, v190
    v_max_f32 v188, v189, v190
    v_max_f32 v188, s12, v188
    v_sub_f32 v189, 0, v188
    v_exp_f32 v216, v189
    v_sub_f32 v108, v108, v188
    v_sub_f32 v109, v109, v188
    v_sub_f32 v110, v110, v188
    v_sub_f32 v111, v111, v188
    v_sub_f32 v112, v112, v188
    v_sub_f32 v113, v113, v188
    v_sub_f32 v114, v114, v188
    v_sub_f32 v115, v115, v188
    v_sub_f32 v116, v116, v188
    v_sub_f32 v117, v117, v188
    v_sub_f32 v118, v118, v188
    v_sub_f32 v119, v119, v188
    v_sub_f32 v120, v120, v188
    v_sub_f32 v121, v121, v188
    v_sub_f32 v122, v122, v188
    v_sub_f32 v123, v123, v188
    v_sub_f32 v124, v124, v188
    v_sub_f32 v125, v125, v188
    v_sub_f32 v126, v126, v188
    v_sub_f32 v127, v127, v188
    v_sub_f32 v128, v128, v188
    v_sub_f32 v129, v129, v188
    v_sub_f32 v130, v130, v188
    v_sub_f32 v131, v131, v188
    v_sub_f32 v132, v132, v188
    v_sub_f32 v133, v133, v188
    v_sub_f32 v134, v134, v188
    v_sub_f32 v135, v135, v188
    v_sub_f32 v136, v136, v188
    v_sub_f32 v137, v137, v188
    v_sub_f32 v138, v138, v188
    v_sub_f32 v139, v139, v188
    v_sub_f32 v140, v140, v188
    v_sub_f32 v141, v141, v188
    v_sub_f32 v142, v142, v188
    v_sub_f32 v143, v143, v188
    v_sub_f32 v144, v144, v188
    v_sub_f32 v145, v145, v188
    v_sub_f32 v146, v146, v188
    v_sub_f32 v147, v147, v188
    v_sub_f32 v148, v148, v188
    v_sub_f32 v149, v149, v188
    v_sub_f32 v150, v150, v188
    v_sub_f32 v151, v151, v188
    v_sub_f32 v152, v152, v188
    v_sub_f32 v153, v153, v188
    v_sub_f32 v154, v154, v188
    v_sub_f32 v155, v155, v188
    s_mov_b32 s14, 1
    s_mov_b32 s11, 0x42400000
    s_mov_b32 s12, 0
    s_nop 3
    s_branch attn_back12
attn_rare13:
    s_nop 15
    v_mov_b32 v189, v188
    v_mov_b32 v190, v188
    s_nop 1
    v_permlane32_swap_b32 v189, v190
    v_max_f32 v188, v189, v190
    v_max_f32 v188, s12, v188
    v_sub_f32 v189, 0, v188
    v_exp_f32 v216, v189
    v_sub_f32 v108, v108, v188
    v_sub_f32 v109, v109, v188
    v_sub_f32 v110, v110, v188
    v_sub_f32 v111, v111, v188
    v_sub_f32 v112, v112, v188
    v_sub_f32 v113, v113, v188
    v_sub_f32 v114, v114, v188
    v_sub_f32 v115, v115, v188
    v_sub_f32 v116, v116, v188
    v_sub_f32 v117, v117, v188
    v_sub_f32 v118, v118, v188
    v_sub_f32 v119, v119, v188
    v_sub_f32 v120, v120, v188
    v_sub_f32 v121, v121, v188
    v_sub_f32 v122, v122, v188
    v_sub_f32 v123, v123, v188
    v_sub_f32 v156, v156, v188
    v_sub_f32 v157, v157, v188
    v_sub_f32 v158, v158, v188
    v_sub_f32 v159, v159, v188
    v_sub_f32 v160, v160, v188
    v_sub_f32 v161, v161, v188
    v_sub_f32 v162, v162, v188
    v_sub_f32 v163, v163, v188
    v_sub_f32 v164, v164, v188
    v_sub_f32 v165, v165, v188
    v_sub_f32 v166, v166, v188
    v_sub_f32 v167, v167, v188
    v_sub_f32 v168, v168, v188
    v_sub_f32 v169, v169, v188
    v_sub_f32 v170, v170, v188
    v_sub_f32 v171, v171, v188
    v_sub_f32 v172, v172, v188
    v_sub_f32 v173, v173, v188
    v_sub_f32 v174, v174, v188
    v_sub_f32 v175, v175, v188
    v_sub_f32 v176, v176, v188
    v_sub_f32 v177, v177, v188
    v_sub_f32 v178, v178, v188
    v_sub_f32 v179, v179, v188
    v_sub_f32 v180, v180, v188
    v_sub_f32 v181, v181, v188
    v_sub_f32 v182, v182, v188
    v_sub_f32 v183, v183, v188
    v_sub_f32 v184, v184, v188
    v_sub_f32 v185, v185, v188
    v_sub_f32 v186, v186, v188
    v_sub_f32 v187, v187, v188
    s_mov_b32 s14, 1
    s_mov_b32 s11, 0x42400000
    s_mov_b32 s12, 0
    s_nop 3
    s_branch attn_back13
attn_rare14:
    s_nop 15
    v_mov_b32 v189, v188
    v_mov_b32 v190, v188
    s_nop 1
    v_permlane32_swap_b32 v189, v190
    v_max_f32 v188, v189, v190
    v_max_f32 v188, s12, v188
    v_sub_f32 v189, 0, v188
    v_exp_f32 v216, v189
    v_sub_f32 v108, v108, v188
    v_sub_f32 v109, v109, v188
    v_sub_f32 v110, v110, v188
    v_sub_f32 v111, v111, v188
    v_sub_f32 v112, v112, v188
    v_sub_f32 v113, v113, v188
    v_sub_f32 v114, v114, v188
    v_sub_f32 v115, v115, v188
    v_sub_f32 v116, v116, v188
    v_sub_f32 v117, v117, v188
    v_sub_f32 v118, v118, v188
    v_sub_f32 v119, v119, v188
    v_sub_f32 v120, v120, v188
    v_sub_f32 v121, v121, v188
    v_sub_f32 v122, v122, v188
    v_sub_f32 v123, v123, v188
    v_sub_f32 v124, v124, v188
    v_sub_f32 v125, v125, v188
    v_sub_f32 v126, v126, v188
    v_sub_f32 v127, v127, v188
    v_sub_f32 v128, v128, v188
    v_sub_f32 v129, v129, v188
    v_sub_f32 v130, v130, v188
    v_sub_f32 v131, v131, v188
    v_sub_f32 v132, v132, v188
    v_sub_f32 v133, v133, v188
    v_sub_f32 v134, v134, v188
    v_sub_f32 v135, v135, v188
    v_sub_f32 v136, v136, v188
    v_sub_f32 v137, v137, v188
    v_sub_f32 v138, v138, v188
    v_sub_f32 v139, v139, v188
    v_sub_f32 v140, v140, v188
    v_sub_f32 v141, v141, v188
    v_sub_f32 v142, v142, v188
    v_sub_f32 v143, v143, v188
    v_sub_f32 v144, v144, v188
    v_sub_f32 v145, v145, v188
    v_sub_f32 v146, v146, v188
    v_sub_f32 v147, v147, v188
    v_sub_f32 v148, v148, v188
    v_sub_f32 v149, v149, v188
    v_sub_f32 v150, v150, v188
    v_sub_f32 v151, v151, v188
    v_sub_f32 v152, v152, v188
    v_sub_f32 v153, v153, v188
    v_sub_f32 v154, v154, v188
    v_sub_f32 v155, v155, v188
    s_mov_b32 s14, 1
    s_mov_b32 s11, 0x42400000
    s_mov_b32 s12, 0
    s_nop 3
    s_branch attn_back14
attn_rare15:
    s_nop 15
    v_mov_b32 v189, v188
    v_mov_b32 v190, v188
    s_nop 1
    v_permlane32_swap_b32 v189, v190
    v_max_f32 v188, v189, v190
    v_max_f32 v188, s12, v188
    v_sub_f32 v189, 0, v188
    v_exp_f32 v216, v189
    v_sub_f32 v108, v108, v188
    v_sub_f32 v109, v109, v188
    v_sub_f32 v110, v110, v188
    v_sub_f32 v111, v111, v188
    v_sub_f32 v112, v112, v188
    v_sub_f32 v113, v113, v188
    v_sub_f32 v114, v114, v188
    v_sub_f32 v115, v115, v188
    v_sub_f32 v116, v116, v188
    v_sub_f32 v117, v117, v188
    v_sub_f32 v118, v118, v188
    v_sub_f32 v119, v119, v188
    v_sub_f32 v120, v120, v188
    v_sub_f32 v121, v121, v188
    v_sub_f32 v122, v122, v188
    v_sub_f32 v123, v123, v188
    v_sub_f32 v156, v156, v188
    v_sub_f32 v157, v157, v188
    v_sub_f32 v158, v158, v188
    v_sub_f32 v159, v159, v188
    v_sub_f32 v160, v160, v188
    v_sub_f32 v161, v161, v188
    v_sub_f32 v162, v162, v188
    v_sub_f32 v163, v163, v188
    v_sub_f32 v164, v164, v188
    v_sub_f32 v165, v165, v188
    v_sub_f32 v166, v166, v188
    v_sub_f32 v167, v167, v188
    v_sub_f32 v168, v168, v188
    v_sub_f32 v169, v169, v188
    v_sub_f32 v170, v170, v188
    v_sub_f32 v171, v171, v188
    v_sub_f32 v172, v172, v188
    v_sub_f32 v173, v173, v188
    v_sub_f32 v174, v174, v188
    v_sub_f32 v175, v175, v188
    v_sub_f32 v176, v176, v188
    v_sub_f32 v177, v177, v188
    v_sub_f32 v178, v178, v188
    v_sub_f32 v179, v179, v188
    v_sub_f32 v180, v180, v188
    v_sub_f32 v181, v181, v188
    v_sub_f32 v182, v182, v188
    v_sub_f32 v183, v183, v188
    v_sub_f32 v184, v184, v188
    v_sub_f32 v185, v185, v188
    v_sub_f32 v186, v186, v188
    v_sub_f32 v187, v187, v188
    s_mov_b32 s14, 1
    s_mov_b32 s11, 0x42400000
    s_mov_b32 s12, 0
    s_nop 3
    s_branch attn_back15
attn_rare16:
    s_nop 15
    v_mov_b32 v189, v188
    v_mov_b32 v190, v188
    s_nop 1
    v_permlane32_swap_b32 v189, v190
    v_max_f32 v188, v189, v190
    v_max_f32 v188, s12, v188
    v_sub_f32 v189, 0, v188
    v_exp_f32 v216, v189
    v_sub_f32 v108, v108, v188
    v_sub_f32 v109, v109, v188
    v_sub_f32 v110, v110, v188
    v_sub_f32 v111, v111, v188
    v_sub_f32 v112, v112, v188
    v_sub_f32 v113, v113, v188
    v_sub_f32 v114, v114, v188
    v_sub_f32 v115, v115, v188
    v_sub_f32 v116, v116, v188
    v_sub_f32 v117, v117, v188
    v_sub_f32 v118, v118, v188
    v_sub_f32 v119, v119, v188
    v_sub_f32 v120, v120, v188
    v_sub_f32 v121, v121, v188
    v_sub_f32 v122, v122, v188
    v_sub_f32 v123, v123, v188
    v_sub_f32 v124, v124, v188
    v_sub_f32 v125, v125, v188
    v_sub_f32 v126, v126, v188
    v_sub_f32 v127, v127, v188
    v_sub_f32 v128, v128, v188
    v_sub_f32 v129, v129, v188
    v_sub_f32 v130, v130, v188
    v_sub_f32 v131, v131, v188
    v_sub_f32 v132, v132, v188
    v_sub_f32 v133, v133, v188
    v_sub_f32 v134, v134, v188
    v_sub_f32 v135, v135, v188
    v_sub_f32 v136, v136, v188
    v_sub_f32 v137, v137, v188
    v_sub_f32 v138, v138, v188
    v_sub_f32 v139, v139, v188
    v_sub_f32 v140, v140, v188
    v_sub_f32 v141, v141, v188
    v_sub_f32 v142, v142, v188
    v_sub_f32 v143, v143, v188
    v_sub_f32 v144, v144, v188
    v_sub_f32 v145, v145, v188
    v_sub_f32 v146, v146, v188
    v_sub_f32 v147, v147, v188
    v_sub_f32 v148, v148, v188
    v_sub_f32 v149, v149, v188
    v_sub_f32 v150, v150, v188
    v_sub_f32 v151, v151, v188
    v_sub_f32 v152, v152, v188
    v_sub_f32 v153, v153, v188
    v_sub_f32 v154, v154, v188
    v_sub_f32 v155, v155, v188
    s_mov_b32 s14, 1
    s_mov_b32 s11, 0x42400000
    s_mov_b32 s12, 0
    s_nop 3
    s_branch attn_back16
attn_rare17:
    s_nop 15
    v_mov_b32 v189, v188
    v_mov_b32 v190, v188
    s_nop 1
    v_permlane32_swap_b32 v189, v190
    v_max_f32 v188, v189, v190
    v_max_f32 v188, s12, v188
    v_sub_f32 v189, 0, v188
    v_exp_f32 v216, v189
    v_sub_f32 v108, v108, v188
    v_sub_f32 v109, v109, v188
    v_sub_f32 v110, v110, v188
    v_sub_f32 v111, v111, v188
    v_sub_f32 v112, v112, v188
    v_sub_f32 v113, v113, v188
    v_sub_f32 v114, v114, v188
    v_sub_f32 v115, v115, v188
    v_sub_f32 v116, v116, v188
    v_sub_f32 v117, v117, v188
    v_sub_f32 v118, v118, v188
    v_sub_f32 v119, v119, v188
    v_sub_f32 v120, v120, v188
    v_sub_f32 v121, v121, v188
    v_sub_f32 v122, v122, v188
    v_sub_f32 v123, v123, v188
    v_sub_f32 v156, v156, v188
    v_sub_f32 v157, v157, v188
    v_sub_f32 v158, v158, v188
    v_sub_f32 v159, v159, v188
    v_sub_f32 v160, v160, v188
    v_sub_f32 v161, v161, v188
    v_sub_f32 v162, v162, v188
    v_sub_f32 v163, v163, v188
    v_sub_f32 v164, v164, v188
    v_sub_f32 v165, v165, v188
    v_sub_f32 v166, v166, v188
    v_sub_f32 v167, v167, v188
    v_sub_f32 v168, v168, v188
    v_sub_f32 v169, v169, v188
    v_sub_f32 v170, v170, v188
    v_sub_f32 v171, v171, v188
    v_sub_f32 v172, v172, v188
    v_sub_f32 v173, v173, v188
    v_sub_f32 v174, v174, v188
    v_sub_f32 v175, v175, v188
    v_sub_f32 v176, v176, v188
    v_sub_f32 v177, v177, v188
    v_sub_f32 v178, v178, v188
    v_sub_f32 v179, v179, v188
    v_sub_f32 v180, v180, v188
    v_sub_f32 v181, v181, v188
    v_sub_f32 v182, v182, v188
    v_sub_f32 v183, v183, v188
    v_sub_f32 v184, v184, v188
    v_sub_f32 v185, v185, v188
    v_sub_f32 v186, v186, v188
    v_sub_f32 v187, v187, v188
    s_mov_b32 s14, 1
    s_mov_b32 s11, 0x42400000
    s_mov_b32 s12, 0
    s_nop 3
    s_branch attn_back17
attn_rare18:
    s_nop 15
    v_mov_b32 v189, v188
    v_mov_b32 v190, v188
    s_nop 1
    v_permlane32_swap_b32 v189, v190
    v_max_f32 v188, v189, v190
    v_max_f32 v188, s12, v188
    v_sub_f32 v189, 0, v188
    v_exp_f32 v216, v189
    v_sub_f32 v108, v108, v188
    v_sub_f32 v109, v109, v188
    v_sub_f32 v110, v110, v188
    v_sub_f32 v111, v111, v188
    v_sub_f32 v112, v112, v188
    v_sub_f32 v113, v113, v188
    v_sub_f32 v114, v114, v188
    v_sub_f32 v115, v115, v188
    v_sub_f32 v116, v116, v188
    v_sub_f32 v117, v117, v188
    v_sub_f32 v118, v118, v188
    v_sub_f32 v119, v119, v188
    v_sub_f32 v120, v120, v188
    v_sub_f32 v121, v121, v188
    v_sub_f32 v122, v122, v188
    v_sub_f32 v123, v123, v188
    v_sub_f32 v124, v124, v188
    v_sub_f32 v125, v125, v188
    v_sub_f32 v126, v126, v188
    v_sub_f32 v127, v127, v188
    v_sub_f32 v128, v128, v188
    v_sub_f32 v129, v129, v188
    v_sub_f32 v130, v130, v188
    v_sub_f32 v131, v131, v188
    v_sub_f32 v132, v132, v188
    v_sub_f32 v133, v133, v188
    v_sub_f32 v134, v134, v188
    v_sub_f32 v135, v135, v188
    v_sub_f32 v136, v136, v188
    v_sub_f32 v137, v137, v188
    v_sub_f32 v138, v138, v188
    v_sub_f32 v139, v139, v188
    v_sub_f32 v140, v140, v188
    v_sub_f32 v141, v141, v188
    v_sub_f32 v142, v142, v188
    v_sub_f32 v143, v143, v188
    v_sub_f32 v144, v144, v188
    v_sub_f32 v145, v145, v188
    v_sub_f32 v146, v146, v188
    v_sub_f32 v147, v147, v188
    v_sub_f32 v148, v148, v188
    v_sub_f32 v149, v149, v188
    v_sub_f32 v150, v150, v188
    v_sub_f32 v151, v151, v188
    v_sub_f32 v152, v152, v188
    v_sub_f32 v153, v153, v188
    v_sub_f32 v154, v154, v188
    v_sub_f32 v155, v155, v188
    s_mov_b32 s14, 1
    s_mov_b32 s11, 0x42400000
    s_mov_b32 s12, 0
    s_nop 3
    s_branch attn_back18
attn_rare19:
    s_nop 15
    v_mov_b32 v189, v188
    v_mov_b32 v190, v188
    s_nop 1
    v_permlane32_swap_b32 v189, v190
    v_max_f32 v188, v189, v190
    v_max_f32 v188, s12, v188
    v_sub_f32 v189, 0, v188
    v_exp_f32 v216, v189
    v_sub_f32 v108, v108, v188
    v_sub_f32 v109, v109, v188
    v_sub_f32 v110, v110, v188
    v_sub_f32 v111, v111, v188
    v_sub_f32 v112, v112, v188
    v_sub_f32 v113, v113, v188
    v_sub_f32 v114, v114, v188
    v_sub_f32 v115, v115, v188
    v_sub_f32 v116, v116, v188
    v_sub_f32 v117, v117, v188
    v_sub_f32 v118, v118, v188
    v_sub_f32 v119, v119, v188
    v_sub_f32 v120, v120, v188
    v_sub_f32 v121, v121, v188
    v_sub_f32 v122, v122, v188
    v_sub_f32 v123, v123, v188
    v_sub_f32 v156, v156, v188
    v_sub_f32 v157, v157, v188
    v_sub_f32 v158, v158, v188
    v_sub_f32 v159, v159, v188
    v_sub_f32 v160, v160, v188
    v_sub_f32 v161, v161, v188
    v_sub_f32 v162, v162, v188
    v_sub_f32 v163, v163, v188
    v_sub_f32 v164, v164, v188
    v_sub_f32 v165, v165, v188
    v_sub_f32 v166, v166, v188
    v_sub_f32 v167, v167, v188
    v_sub_f32 v168, v168, v188
    v_sub_f32 v169, v169, v188
    v_sub_f32 v170, v170, v188
    v_sub_f32 v171, v171, v188
    v_sub_f32 v172, v172, v188
    v_sub_f32 v173, v173, v188
    v_sub_f32 v174, v174, v188
    v_sub_f32 v175, v175, v188
    v_sub_f32 v176, v176, v188
    v_sub_f32 v177, v177, v188
    v_sub_f32 v178, v178, v188
    v_sub_f32 v179, v179, v188
    v_sub_f32 v180, v180, v188
    v_sub_f32 v181, v181, v188
    v_sub_f32 v182, v182, v188
    v_sub_f32 v183, v183, v188
    v_sub_f32 v184, v184, v188
    v_sub_f32 v185, v185, v188
    v_sub_f32 v186, v186, v188
    v_sub_f32 v187, v187, v188
    s_mov_b32 s14, 1
    s_mov_b32 s11, 0x42400000
    s_mov_b32 s12, 0
    s_nop 3
    s_branch attn_back19
attn_fix1:
    s_nop 15
    v_mul_f32 v76, v76, v216
    v_mul_f32 v92, v92, v216
    v_mul_f32 v77, v77, v216
    v_mul_f32 v93, v93, v216
    v_mul_f32 v78, v78, v216
    v_mul_f32 v94, v94, v216
    v_mul_f32 v79, v79, v216
    v_mul_f32 v95, v95, v216
    v_mul_f32 v80, v80, v216
    v_mul_f32 v96, v96, v216
    v_mul_f32 v81, v81, v216
    v_mul_f32 v97, v97, v216
    v_mul_f32 v82, v82, v216
    v_mul_f32 v98, v98, v216
    v_mul_f32 v83, v83, v216
    v_mul_f32 v99, v99, v216
    v_mul_f32 v84, v84, v216
    v_mul_f32 v100, v100, v216
    v_mul_f32 v85, v85, v216
    v_mul_f32 v101, v101, v216
    v_mul_f32 v86, v86, v216
    v_mul_f32 v102, v102, v216
    v_mul_f32 v87, v87, v216
    v_mul_f32 v103, v103, v216
    v_mul_f32 v88, v88, v216
    v_mul_f32 v104, v104, v216
    v_mul_f32 v89, v89, v216
    v_mul_f32 v105, v105, v216
    v_mul_f32 v90, v90, v216
    v_mul_f32 v106, v106, v216
    v_mul_f32 v91, v91, v216
    v_mul_f32 v107, v107, v216
    s_mov_b32 s14, 0
    s_nop 3
    s_branch attn_fixb1
attn_fix2:
    s_nop 15
    v_mul_f32 v76, v76, v216
    v_mul_f32 v92, v92, v216
    v_mul_f32 v77, v77, v216
    v_mul_f32 v93, v93, v216
    v_mul_f32 v78, v78, v216
    v_mul_f32 v94, v94, v216
    v_mul_f32 v79, v79, v216
    v_mul_f32 v95, v95, v216
    v_mul_f32 v80, v80, v216
    v_mul_f32 v96, v96, v216
    v_mul_f32 v81, v81, v216
    v_mul_f32 v97, v97, v216
    v_mul_f32 v82, v82, v216
    v_mul_f32 v98, v98, v216
    v_mul_f32 v83, v83, v216
    v_mul_f32 v99, v99, v216
    v_mul_f32 v84, v84, v216
    v_mul_f32 v100, v100, v216
    v_mul_f32 v85, v85, v216
    v_mul_f32 v101, v101, v216
    v_mul_f32 v86, v86, v216
    v_mul_f32 v102, v102, v216
    v_mul_f32 v87, v87, v216
    v_mul_f32 v103, v103, v216
    v_mul_f32 v88, v88, v216
    v_mul_f32 v104, v104, v216
    v_mul_f32 v89, v89, v216
    v_mul_f32 v105, v105, v216
    v_mul_f32 v90, v90, v216
    v_mul_f32 v106, v106, v216
    v_mul_f32 v91, v91, v216
    v_mul_f32 v107, v107, v216
    s_mov_b32 s14, 0
    s_nop 3
    s_branch attn_fixb2
attn_fix3:
    s_nop 15
    v_mul_f32 v76, v76, v216
    v_mul_f32 v92, v92, v216
    v_mul_f32 v77, v77, v216
    v_mul_f32 v93, v93, v216
    v_mul_f32 v78, v78, v216
    v_mul_f32 v94, v94, v216
    v_mul_f32 v79, v79, v216
    v_mul_f32 v95, v95, v216
    v_mul_f32 v80, v80, v216
    v_mul_f32 v96, v96, v216
    v_mul_f32 v81, v81, v216
    v_mul_f32 v97, v97, v216
    v_mul_f32 v82, v82, v216
    v_mul_f32 v98, v98, v216
    v_mul_f32 v83, v83, v216
    v_mul_f32 v99, v99, v216
    v_mul_f32 v84, v84, v216
    v_mul_f32 v100, v100, v216
    v_mul_f32 v85, v85, v216
    v_mul_f32 v101, v101, v216
    v_mul_f32 v86, v86, v216
    v_mul_f32 v102, v102, v216
    v_mul_f32 v87, v87, v216
    v_mul_f32 v103, v103, v216
    v_mul_f32 v88, v88, v216
    v_mul_f32 v104, v104, v216
    v_mul_f32 v89, v89, v216
    v_mul_f32 v105, v105, v216
    v_mul_f32 v90, v90, v216
    v_mul_f32 v106, v106, v216
    v_mul_f32 v91, v91, v216
    v_mul_f32 v107, v107, v216
    s_mov_b32 s14, 0
    s_nop 3
    s_branch attn_fixb3
attn_fix4:
    s_nop 15
    v_mul_f32 v76, v76, v216
    v_mul_f32 v92, v92, v216
    v_mul_f32 v77, v77, v216
    v_mul_f32 v93, v93, v216
    v_mul_f32 v78, v78, v216
    v_mul_f32 v94, v94, v216
    v_mul_f32 v79, v79, v216
    v_mul_f32 v95, v95, v216
    v_mul_f32 v80, v80, v216
    v_mul_f32 v96, v96, v216
    v_mul_f32 v81, v81, v216
    v_mul_f32 v97, v97, v216
    v_mul_f32 v82, v82, v216
    v_mul_f32 v98, v98, v216
    v_mul_f32 v83, v83, v216
    v_mul_f32 v99, v99, v216
    v_mul_f32 v84, v84, v216
    v_mul_f32 v100, v100, v216
    v_mul_f32 v85, v85, v216
    v_mul_f32 v101, v101, v216
    v_mul_f32 v86, v86, v216
    v_mul_f32 v102, v102, v216
    v_mul_f32 v87, v87, v216
    v_mul_f32 v103, v103, v216
    v_mul_f32 v88, v88, v216
    v_mul_f32 v104, v104, v216
    v_mul_f32 v89, v89, v216
    v_mul_f32 v105, v105, v216
    v_mul_f32 v90, v90, v216
    v_mul_f32 v106, v106, v216
    v_mul_f32 v91, v91, v216
    v_mul_f32 v107, v107, v216
    s_mov_b32 s14, 0
    s_nop 3
    s_branch attn_fixb4
attn_fix5:
    s_nop 15
    v_mul_f32 v76, v76, v216
    v_mul_f32 v92, v92, v216
    v_mul_f32 v77, v77, v216
    v_mul_f32 v93, v93, v216
    v_mul_f32 v78, v78, v216
    v_mul_f32 v94, v94, v216
    v_mul_f32 v79, v79, v216
    v_mul_f32 v95, v95, v216
    v_mul_f32 v80, v80, v216
    v_mul_f32 v96, v96, v216
    v_mul_f32 v81, v81, v216
    v_mul_f32 v97, v97, v216
    v_mul_f32 v82, v82, v216
    v_mul_f32 v98, v98, v216
    v_mul_f32 v83, v83, v216
    v_mul_f32 v99, v99, v216
    v_mul_f32 v84, v84, v216
    v_mul_f32 v100, v100, v216
    v_mul_f32 v85, v85, v216
    v_mul_f32 v101, v101, v216
    v_mul_f32 v86, v86, v216
    v_mul_f32 v102, v102, v216
    v_mul_f32 v87, v87, v216
    v_mul_f32 v103, v103, v216
    v_mul_f32 v88, v88, v216
    v_mul_f32 v104, v104, v216
    v_mul_f32 v89, v89, v216
    v_mul_f32 v105, v105, v216
    v_mul_f32 v90, v90, v216
    v_mul_f32 v106, v106, v216
    v_mul_f32 v91, v91, v216
    v_mul_f32 v107, v107, v216
    s_mov_b32 s14, 0
    s_nop 3
    s_branch attn_fixb5
attn_fix6:
    s_nop 15
    v_mul_f32 v76, v76, v216
    v_mul_f32 v92, v92, v216
    v_mul_f32 v77, v77, v216
    v_mul_f32 v93, v93, v216
    v_mul_f32 v78, v78, v216
    v_mul_f32 v94, v94, v216
    v_mul_f32 v79, v79, v216
    v_mul_f32 v95, v95, v216
    v_mul_f32 v80, v80, v216
    v_mul_f32 v96, v96, v216
    v_mul_f32 v81, v81, v216
    v_mul_f32 v97, v97, v216
    v_mul_f32 v82, v82, v216
    v_mul_f32 v98, v98, v216
    v_mul_f32 v83, v83, v216
    v_mul_f32 v99, v99, v216
    v_mul_f32 v84, v84, v216
    v_mul_f32 v100, v100, v216
    v_mul_f32 v85, v85, v216
    v_mul_f32 v101, v101, v216
    v_mul_f32 v86, v86, v216
    v_mul_f32 v102, v102, v216
    v_mul_f32 v87, v87, v216
    v_mul_f32 v103, v103, v216
    v_mul_f32 v88, v88, v216
    v_mul_f32 v104, v104, v216
    v_mul_f32 v89, v89, v216
    v_mul_f32 v105, v105, v216
    v_mul_f32 v90, v90, v216
    v_mul_f32 v106, v106, v216
    v_mul_f32 v91, v91, v216
    v_mul_f32 v107, v107, v216
    s_mov_b32 s14, 0
    s_nop 3
    s_branch attn_fixb6
attn_fix7:
    s_nop 15
    v_mul_f32 v76, v76, v216
    v_mul_f32 v92, v92, v216
    v_mul_f32 v77, v77, v216
    v_mul_f32 v93, v93, v216
    v_mul_f32 v78, v78, v216
    v_mul_f32 v94, v94, v216
    v_mul_f32 v79, v79, v216
    v_mul_f32 v95, v95, v216
    v_mul_f32 v80, v80, v216
    v_mul_f32 v96, v96, v216
    v_mul_f32 v81, v81, v216
    v_mul_f32 v97, v97, v216
    v_mul_f32 v82, v82, v216
    v_mul_f32 v98, v98, v216
    v_mul_f32 v83, v83, v216
    v_mul_f32 v99, v99, v216
    v_mul_f32 v84, v84, v216
    v_mul_f32 v100, v100, v216
    v_mul_f32 v85, v85, v216
    v_mul_f32 v101, v101, v216
    v_mul_f32 v86, v86, v216
    v_mul_f32 v102, v102, v216
    v_mul_f32 v87, v87, v216
    v_mul_f32 v103, v103, v216
    v_mul_f32 v88, v88, v216
    v_mul_f32 v104, v104, v216
    v_mul_f32 v89, v89, v216
    v_mul_f32 v105, v105, v216
    v_mul_f32 v90, v90, v216
    v_mul_f32 v106, v106, v216
    v_mul_f32 v91, v91, v216
    v_mul_f32 v107, v107, v216
    s_mov_b32 s14, 0
    s_nop 3
    s_branch attn_fixb7
attn_fix8:
    s_nop 15
    v_mul_f32 v76, v76, v216
    v_mul_f32 v92, v92, v216
    v_mul_f32 v77, v77, v216
    v_mul_f32 v93, v93, v216
    v_mul_f32 v78, v78, v216
    v_mul_f32 v94, v94, v216
    v_mul_f32 v79, v79, v216
    v_mul_f32 v95, v95, v216
    v_mul_f32 v80, v80, v216
    v_mul_f32 v96, v96, v216
    v_mul_f32 v81, v81, v216
    v_mul_f32 v97, v97, v216
    v_mul_f32 v82, v82, v216
    v_mul_f32 v98, v98, v216
    v_mul_f32 v83, v83, v216
    v_mul_f32 v99, v99, v216
    v_mul_f32 v84, v84, v216
    v_mul_f32 v100, v100, v216
    v_mul_f32 v85, v85, v216
    v_mul_f32 v101, v101, v216
    v_mul_f32 v86, v86, v216
    v_mul_f32 v102, v102, v216
    v_mul_f32 v87, v87, v216
    v_mul_f32 v103, v103, v216
    v_mul_f32 v88, v88, v216
    v_mul_f32 v104, v104, v216
    v_mul_f32 v89, v89, v216
    v_mul_f32 v105, v105, v216
    v_mul_f32 v90, v90, v216
    v_mul_f32 v106, v106, v216
    v_mul_f32 v91, v91, v216
    v_mul_f32 v107, v107, v216
    s_mov_b32 s14, 0
    s_nop 3
    s_branch attn_fixb8
attn_fix9:
    s_nop 15
    v_mul_f32 v76, v76, v216
    v_mul_f32 v92, v92, v216
    v_mul_f32 v77, v77, v216
    v_mul_f32 v93, v93, v216
    v_mul_f32 v78, v78, v216
    v_mul_f32 v94, v94, v216
    v_mul_f32 v79, v79, v216
    v_mul_f32 v95, v95, v216
    v_mul_f32 v80, v80, v216
    v_mul_f32 v96, v96, v216
    v_mul_f32 v81, v81, v216
    v_mul_f32 v97, v97, v216
    v_mul_f32 v82, v82, v216
    v_mul_f32 v98, v98, v216
    v_mul_f32 v83, v83, v216
    v_mul_f32 v99, v99, v216
    v_mul_f32 v84, v84, v216
    v_mul_f32 v100, v100, v216
    v_mul_f32 v85, v85, v216
    v_mul_f32 v101, v101, v216
    v_mul_f32 v86, v86, v216
    v_mul_f32 v102, v102, v216
    v_mul_f32 v87, v87, v216
    v_mul_f32 v103, v103, v216
    v_mul_f32 v88, v88, v216
    v_mul_f32 v104, v104, v216
    v_mul_f32 v89, v89, v216
    v_mul_f32 v105, v105, v216
    v_mul_f32 v90, v90, v216
    v_mul_f32 v106, v106, v216
    v_mul_f32 v91, v91, v216
    v_mul_f32 v107, v107, v216
    s_mov_b32 s14, 0
    s_nop 3
    s_branch attn_fixb9
attn_fix10:
    s_nop 15
    v_mul_f32 v76, v76, v216
    v_mul_f32 v92, v92, v216
    v_mul_f32 v77, v77, v216
    v_mul_f32 v93, v93, v216
    v_mul_f32 v78, v78, v216
    v_mul_f32 v94, v94, v216
    v_mul_f32 v79, v79, v216
    v_mul_f32 v95, v95, v216
    v_mul_f32 v80, v80, v216
    v_mul_f32 v96, v96, v216
    v_mul_f32 v81, v81, v216
    v_mul_f32 v97, v97, v216
    v_mul_f32 v82, v82, v216
    v_mul_f32 v98, v98, v216
    v_mul_f32 v83, v83, v216
    v_mul_f32 v99, v99, v216
    v_mul_f32 v84, v84, v216
    v_mul_f32 v100, v100, v216
    v_mul_f32 v85, v85, v216
    v_mul_f32 v101, v101, v216
    v_mul_f32 v86, v86, v216
    v_mul_f32 v102, v102, v216
    v_mul_f32 v87, v87, v216
    v_mul_f32 v103, v103, v216
    v_mul_f32 v88, v88, v216
    v_mul_f32 v104, v104, v216
    v_mul_f32 v89, v89, v216
    v_mul_f32 v105, v105, v216
    v_mul_f32 v90, v90, v216
    v_mul_f32 v106, v106, v216
    v_mul_f32 v91, v91, v216
    v_mul_f32 v107, v107, v216
    s_mov_b32 s14, 0
    s_nop 3
    s_branch attn_fixb10
attn_fix11:
    s_nop 15
    v_mul_f32 v76, v76, v216
    v_mul_f32 v92, v92, v216
    v_mul_f32 v77, v77, v216
    v_mul_f32 v93, v93, v216
    v_mul_f32 v78, v78, v216
    v_mul_f32 v94, v94, v216
    v_mul_f32 v79, v79, v216
    v_mul_f32 v95, v95, v216
    v_mul_f32 v80, v80, v216
    v_mul_f32 v96, v96, v216
    v_mul_f32 v81, v81, v216
    v_mul_f32 v97, v97, v216
    v_mul_f32 v82, v82, v216
    v_mul_f32 v98, v98, v216
    v_mul_f32 v83, v83, v216
    v_mul_f32 v99, v99, v216
    v_mul_f32 v84, v84, v216
    v_mul_f32 v100, v100, v216
    v_mul_f32 v85, v85, v216
    v_mul_f32 v101, v101, v216
    v_mul_f32 v86, v86, v216
    v_mul_f32 v102, v102, v216
    v_mul_f32 v87, v87, v216
    v_mul_f32 v103, v103, v216
    v_mul_f32 v88, v88, v216
    v_mul_f32 v104, v104, v216
    v_mul_f32 v89, v89, v216
    v_mul_f32 v105, v105, v216
    v_mul_f32 v90, v90, v216
    v_mul_f32 v106, v106, v216
    v_mul_f32 v91, v91, v216
    v_mul_f32 v107, v107, v216
    s_mov_b32 s14, 0
    s_nop 3
    s_branch attn_fixb11
attn_fix12:
    s_nop 15
    v_mul_f32 v76, v76, v216
    v_mul_f32 v92, v92, v216
    v_mul_f32 v77, v77, v216
    v_mul_f32 v93, v93, v216
    v_mul_f32 v78, v78, v216
    v_mul_f32 v94, v94, v216
    v_mul_f32 v79, v79, v216
    v_mul_f32 v95, v95, v216
    v_mul_f32 v80, v80, v216
    v_mul_f32 v96, v96, v216
    v_mul_f32 v81, v81, v216
    v_mul_f32 v97, v97, v216
    v_mul_f32 v82, v82, v216
    v_mul_f32 v98, v98, v216
    v_mul_f32 v83, v83, v216
    v_mul_f32 v99, v99, v216
    v_mul_f32 v84, v84, v216
    v_mul_f32 v100, v100, v216
    v_mul_f32 v85, v85, v216
    v_mul_f32 v101, v101, v216
    v_mul_f32 v86, v86, v216
    v_mul_f32 v102, v102, v216
    v_mul_f32 v87, v87, v216
    v_mul_f32 v103, v103, v216
    v_mul_f32 v88, v88, v216
    v_mul_f32 v104, v104, v216
    v_mul_f32 v89, v89, v216
    v_mul_f32 v105, v105, v216
    v_mul_f32 v90, v90, v216
    v_mul_f32 v106, v106, v216
    v_mul_f32 v91, v91, v216
    v_mul_f32 v107, v107, v216
    s_mov_b32 s14, 0
    s_nop 3
    s_branch attn_fixb12
attn_fix13:
    s_nop 15
    v_mul_f32 v76, v76, v216
    v_mul_f32 v92, v92, v216
    v_mul_f32 v77, v77, v216
    v_mul_f32 v93, v93, v216
    v_mul_f32 v78, v78, v216
    v_mul_f32 v94, v94, v216
    v_mul_f32 v79, v79, v216
    v_mul_f32 v95, v95, v216
    v_mul_f32 v80, v80, v216
    v_mul_f32 v96, v96, v216
    v_mul_f32 v81, v81, v216
    v_mul_f32 v97, v97, v216
    v_mul_f32 v82, v82, v216
    v_mul_f32 v98, v98, v216
    v_mul_f32 v83, v83, v216
    v_mul_f32 v99, v99, v216
    v_mul_f32 v84, v84, v216
    v_mul_f32 v100, v100, v216
    v_mul_f32 v85, v85, v216
    v_mul_f32 v101, v101, v216
    v_mul_f32 v86, v86, v216
    v_mul_f32 v102, v102, v216
    v_mul_f32 v87, v87, v216
    v_mul_f32 v103, v103, v216
    v_mul_f32 v88, v88, v216
    v_mul_f32 v104, v104, v216
    v_mul_f32 v89, v89, v216
    v_mul_f32 v105, v105, v216
    v_mul_f32 v90, v90, v216
    v_mul_f32 v106, v106, v216
    v_mul_f32 v91, v91, v216
    v_mul_f32 v107, v107, v216
    s_mov_b32 s14, 0
    s_nop 3
    s_branch attn_fixb13
attn_fix14:
    s_nop 15
    v_mul_f32 v76, v76, v216
    v_mul_f32 v92, v92, v216
    v_mul_f32 v77, v77, v216
    v_mul_f32 v93, v93, v216
    v_mul_f32 v78, v78, v216
    v_mul_f32 v94, v94, v216
    v_mul_f32 v79, v79, v216
    v_mul_f32 v95, v95, v216
    v_mul_f32 v80, v80, v216
    v_mul_f32 v96, v96, v216
    v_mul_f32 v81, v81, v216
    v_mul_f32 v97, v97, v216
    v_mul_f32 v82, v82, v216
    v_mul_f32 v98, v98, v216
    v_mul_f32 v83, v83, v216
    v_mul_f32 v99, v99, v216
    v_mul_f32 v84, v84, v216
    v_mul_f32 v100, v100, v216
    v_mul_f32 v85, v85, v216
    v_mul_f32 v101, v101, v216
    v_mul_f32 v86, v86, v216
    v_mul_f32 v102, v102, v216
    v_mul_f32 v87, v87, v216
    v_mul_f32 v103, v103, v216
    v_mul_f32 v88, v88, v216
    v_mul_f32 v104, v104, v216
    v_mul_f32 v89, v89, v216
    v_mul_f32 v105, v105, v216
    v_mul_f32 v90, v90, v216
    v_mul_f32 v106, v106, v216
    v_mul_f32 v91, v91, v216
    v_mul_f32 v107, v107, v216
    s_mov_b32 s14, 0
    s_nop 3
    s_branch attn_fixb14
attn_fix15:
    s_nop 15
    v_mul_f32 v76, v76, v216
    v_mul_f32 v92, v92, v216
    v_mul_f32 v77, v77, v216
    v_mul_f32 v93, v93, v216
    v_mul_f32 v78, v78, v216
    v_mul_f32 v94, v94, v216
    v_mul_f32 v79, v79, v216
    v_mul_f32 v95, v95, v216
    v_mul_f32 v80, v80, v216
    v_mul_f32 v96, v96, v216
    v_mul_f32 v81, v81, v216
    v_mul_f32 v97, v97, v216
    v_mul_f32 v82, v82, v216
    v_mul_f32 v98, v98, v216
    v_mul_f32 v83, v83, v216
    v_mul_f32 v99, v99, v216
    v_mul_f32 v84, v84, v216
    v_mul_f32 v100, v100, v216
    v_mul_f32 v85, v85, v216
    v_mul_f32 v101, v101, v216
    v_mul_f32 v86, v86, v216
    v_mul_f32 v102, v102, v216
    v_mul_f32 v87, v87, v216
    v_mul_f32 v103, v103, v216
    v_mul_f32 v88, v88, v216
    v_mul_f32 v104, v104, v216
    v_mul_f32 v89, v89, v216
    v_mul_f32 v105, v105, v216
    v_mul_f32 v90, v90, v216
    v_mul_f32 v106, v106, v216
    v_mul_f32 v91, v91, v216
    v_mul_f32 v107, v107, v216
    s_mov_b32 s14, 0
    s_nop 3
    s_branch attn_fixb15
attn_fix16:
    s_nop 15
    v_mul_f32 v76, v76, v216
    v_mul_f32 v92, v92, v216
    v_mul_f32 v77, v77, v216
    v_mul_f32 v93, v93, v216
    v_mul_f32 v78, v78, v216
    v_mul_f32 v94, v94, v216
    v_mul_f32 v79, v79, v216
    v_mul_f32 v95, v95, v216
    v_mul_f32 v80, v80, v216
    v_mul_f32 v96, v96, v216
    v_mul_f32 v81, v81, v216
    v_mul_f32 v97, v97, v216
    v_mul_f32 v82, v82, v216
    v_mul_f32 v98, v98, v216
    v_mul_f32 v83, v83, v216
    v_mul_f32 v99, v99, v216
    v_mul_f32 v84, v84, v216
    v_mul_f32 v100, v100, v216
    v_mul_f32 v85, v85, v216
    v_mul_f32 v101, v101, v216
    v_mul_f32 v86, v86, v216
    v_mul_f32 v102, v102, v216
    v_mul_f32 v87, v87, v216
    v_mul_f32 v103, v103, v216
    v_mul_f32 v88, v88, v216
    v_mul_f32 v104, v104, v216
    v_mul_f32 v89, v89, v216
    v_mul_f32 v105, v105, v216
    v_mul_f32 v90, v90, v216
    v_mul_f32 v106, v106, v216
    v_mul_f32 v91, v91, v216
    v_mul_f32 v107, v107, v216
    s_mov_b32 s14, 0
    s_nop 3
    s_branch attn_fixb16
attn_fix17:
    s_nop 15
    v_mul_f32 v76, v76, v216
    v_mul_f32 v92, v92, v216
    v_mul_f32 v77, v77, v216
    v_mul_f32 v93, v93, v216
    v_mul_f32 v78, v78, v216
    v_mul_f32 v94, v94, v216
    v_mul_f32 v79, v79, v216
    v_mul_f32 v95, v95, v216
    v_mul_f32 v80, v80, v216
    v_mul_f32 v96, v96, v216
    v_mul_f32 v81, v81, v216
    v_mul_f32 v97, v97, v216
    v_mul_f32 v82, v82, v216
    v_mul_f32 v98, v98, v216
    v_mul_f32 v83, v83, v216
    v_mul_f32 v99, v99, v216
    v_mul_f32 v84, v84, v216
    v_mul_f32 v100, v100, v216
    v_mul_f32 v85, v85, v216
    v_mul_f32 v101, v101, v216
    v_mul_f32 v86, v86, v216
    v_mul_f32 v102, v102, v216
    v_mul_f32 v87, v87, v216
    v_mul_f32 v103, v103, v216
    v_mul_f32 v88, v88, v216
    v_mul_f32 v104, v104, v216
    v_mul_f32 v89, v89, v216
    v_mul_f32 v105, v105, v216
    v_mul_f32 v90, v90, v216
    v_mul_f32 v106, v106, v216
    v_mul_f32 v91, v91, v216
    v_mul_f32 v107, v107, v216
    s_mov_b32 s14, 0
    s_nop 3
    s_branch attn_fixb17
attn_fix18:
    s_nop 15
    v_mul_f32 v76, v76, v216
    v_mul_f32 v92, v92, v216
    v_mul_f32 v77, v77, v216
    v_mul_f32 v93, v93, v216
    v_mul_f32 v78, v78, v216
    v_mul_f32 v94, v94, v216
    v_mul_f32 v79, v79, v216
    v_mul_f32 v95, v95, v216
    v_mul_f32 v80, v80, v216
    v_mul_f32 v96, v96, v216
    v_mul_f32 v81, v81, v216
    v_mul_f32 v97, v97, v216
    v_mul_f32 v82, v82, v216
    v_mul_f32 v98, v98, v216
    v_mul_f32 v83, v83, v216
    v_mul_f32 v99, v99, v216
    v_mul_f32 v84, v84, v216
    v_mul_f32 v100, v100, v216
    v_mul_f32 v85, v85, v216
    v_mul_f32 v101, v101, v216
    v_mul_f32 v86, v86, v216
    v_mul_f32 v102, v102, v216
    v_mul_f32 v87, v87, v216
    v_mul_f32 v103, v103, v216
    v_mul_f32 v88, v88, v216
    v_mul_f32 v104, v104, v216
    v_mul_f32 v89, v89, v216
    v_mul_f32 v105, v105, v216
    v_mul_f32 v90, v90, v216
    v_mul_f32 v106, v106, v216
    v_mul_f32 v91, v91, v216
    v_mul_f32 v107, v107, v216
    s_mov_b32 s14, 0
    s_nop 3
    s_branch attn_fixb18
attn_fix19:
    s_nop 15
    v_mul_f32 v76, v76, v216
    v_mul_f32 v92, v92, v216
    v_mul_f32 v77, v77, v216
    v_mul_f32 v93, v93, v216
    v_mul_f32 v78, v78, v216
    v_mul_f32 v94, v94, v216
    v_mul_f32 v79, v79, v216
    v_mul_f32 v95, v95, v216
    v_mul_f32 v80, v80, v216
    v_mul_f32 v96, v96, v216
    v_mul_f32 v81, v81, v216
    v_mul_f32 v97, v97, v216
    v_mul_f32 v82, v82, v216
    v_mul_f32 v98, v98, v216
    v_mul_f32 v83, v83, v216
    v_mul_f32 v99, v99, v216
    v_mul_f32 v84, v84, v216
    v_mul_f32 v100, v100, v216
    v_mul_f32 v85, v85, v216
    v_mul_f32 v101, v101, v216
    v_mul_f32 v86, v86, v216
    v_mul_f32 v102, v102, v216
    v_mul_f32 v87, v87, v216
    v_mul_f32 v103, v103, v216
    v_mul_f32 v88, v88, v216
    v_mul_f32 v104, v104, v216
    v_mul_f32 v89, v89, v216
    v_mul_f32 v105, v105, v216
    v_mul_f32 v90, v90, v216
    v_mul_f32 v106, v106, v216
    v_mul_f32 v91, v91, v216
    v_mul_f32 v107, v107, v216
    s_mov_b32 s14, 0
    s_nop 3
    s_branch attn_fixb19
attn_kernel_end:
    s_endpgm
.p2align 8
.globl wo_kernel
.type wo_kernel,@function
wo_kernel:
    s_cmp_ge_u32 s2, 256
    s_cbranch_scc1 wo_kernel_end
    s_load_dwordx16 s[16:31], s[0:1], 0
    s_load_dwordx8 s[32:39], s[0:1], 64
    s_and_b32 s3, s2, 3
    s_lshl_b32 s3, s3, 2
    s_bfe_u32 s4, s2, 0x20003
    s_add_u32 s3, s3, s4
    s_bfe_u32 s4, s2, 0x10002
    s_lshl_b32 s4, s4, 3
    s_lshr_b32 s5, s2, 5
    s_add_u32 s4, s4, s5
    v_lshrrev_b32 v1, 6, v0
    s_nop 0
    v_readfirstlane_b32 s6, v1
    v_and_b32 v2, 63, v0
    s_and_b32 s7, s6, 3
    s_lshr_b32 s8, s6, 2
    s_waitcnt lgkmcnt(0)
    s_mul_i32 s9, s3, 262144
    s_add_u32 s10, s9, 20971520
    s_sub_u32 s11, 4194304, s9
    s_add_u32 s40, s38, s10
    s_addc_u32 s41, s39, 0
    s_and_b32 s41, s41, 0xffff
    s_mov_b32 s42, s11
    s_mov_b32 s43, 0x00020000
    s_mul_i32 s9, s4, 128
    s_add_u32 s9, s9, 0
    s_sub_u32 s11, 2097152, s9
    s_add_u32 s44, s20, s9
    s_addc_u32 s45, s21, 0
    s_and_b32 s45, s45, 0xffff
    s_mov_b32 s46, s11
    s_mov_b32 s47, 0x00020000
    v_lshrrev_b32 v10, 3, v2
    v_lshrrev_b32 v11, 4, v2
    v_bfe_u32 v12, v2, 2, 2
    v_and_b32 v15, 3, v2
    s_and_b32 s9, s6, 1
    s_lshl_b32 s9, s9, 2
    v_add_u32 v13, s9, v11
    v_and_b32 v14, 7, v2
    v_xor_b32 v13, v13, v14
    s_lshl_b32 s9, s6, 3
    v_add_u32 v14, s9, v10
    s_mov_b32 s9, 2048
    v_mul_lo_u32 v14, v14, s9
    v_lshl_add_u32 v4, v13, 4, v14
    v_add_u32 v5, 131072, v4
    v_and_b32 v13, 1, v11
    s_and_b32 s9, s6, 1
    s_lshl_b32 s9, s9, 1
    v_add_u32 v13, s9, v13
    v_bfe_u32 v14, v2, 1, 2
    v_xor_b32 v13, v13, v14
    v_lshlrev_b32 v13, 5, v13
    v_and_b32 v14, 1, v2
    v_lshl_add_u32 v13, v14, 4, v13
    s_lshl_b32 s9, s6, 3
    v_add_u32 v14, s9, v10
    s_mov_b32 s9, 2048
    v_mul_lo_u32 v14, v14, s9
    v_add_u32 v32, v13, v14
    s_lshl_b32 s75, s6, 10
    v_and_b32 v13, 15, v2
    v_lshrrev_b32 v14, 1, v13
    v_xor_b32 v14, v14, v11
    v_lshlrev_b32 v13, 7, v13
    v_lshl_add_u32 v13, v14, 4, v13
    s_lshl_b32 s9, s7, 12
    v_add_u32 v13, s9, v13
    v_add_u32 v16, 0, v13
    v_xor_b32 v17, 64, v16
    v_add_u32 v18, 24576, v13
    v_xor_b32 v19, 64, v18
    v_add_u32 v20, 49152, v13
    v_xor_b32 v21, 64, v20
    v_add_u32 v22, 73728, v13
    v_xor_b32 v23, 64, v22
    v_lshrrev_b32 v13, 1, v12
    v_and_b32 v14, 1, v11
    v_lshl_add_u32 v13, v14, 1, v13
    s_lshl_b32 s9, s8, 1
    v_xor_b32 v13, s9, v13
    v_lshl_add_u32 v14, v11, 3, v12
    v_lshlrev_b32 v14, 7, v14
    v_lshl_add_u32 v14, v15, 3, v14
    v_lshl_add_u32 v24, v13, 5, v14
    v_xor_b32 v25, 32, v24
    v_add_u32 v40, 16384, v24
    v_add_u32 v41, 16384, v25
    v_add_u32 v42, 40960, v24
    v_add_u32 v43, 40960, v25
    v_add_u32 v44, 65536, v24
    v_add_u32 v45, 65536, v25
    v_add_u32 v46, 90112, v24
    v_add_u32 v47, 90112, v25
    s_lshl_b32 s12, s6, 10
    s_mov_b32 s13, 0
    s_mov_b32 s14, 0
    s_add_u32 m0, s12, 0
    s_nop 0
    buffer_load_dwordx4 v4, s[40:43], s13 offen lds
    s_add_u32 m0, s12, 8192
    s_nop 0
    buffer_load_dwordx4 v5, s[40:43], s13 offen lds
    s_add_u32 m0, s75, 16384
    s_nop 0
    buffer_load_dwordx4 v32, s[44:47], s14 offen lds
    s_add_u32 s13, s13, 128
    s_add_u32 s14, s14, 131072
    s_add_u32 m0, s12, 24576
    s_nop 0
    buffer_load_dwordx4 v4, s[40:43], s13 offen lds
    s_add_u32 m0, s12, 32768
    s_nop 0
    buffer_load_dwordx4 v5, s[40:43], s13 offen lds
    s_add_u32 m0, s75, 40960
    s_nop 0
    buffer_load_dwordx4 v32, s[44:47], s14 offen lds
    s_add_u32 s13, s13, 128
    s_add_u32 s14, s14, 131072
    s_add_u32 m0, s12, 49152
    s_nop 0
    buffer_load_dwordx4 v4, s[40:43], s13 offen lds
    s_add_u32 m0, s12, 57344
    s_nop 0
    buffer_load_dwordx4 v5, s[40:43], s13 offen lds
    s_add_u32 m0, s75, 65536
    s_nop 0
    buffer_load_dwordx4 v32, s[44:47], s14 offen lds
    s_add_u32 s13, s13, 128
    s_add_u32 s14, s14, 131072
    s_add_u32 m0, s12, 73728
    s_nop 0
    buffer_load_dwordx4 v4, s[40:43], s13 offen lds
    s_add_u32 m0, s12, 81920
    s_nop 0
    buffer_load_dwordx4 v5, s[40:43], s13 offen lds
    s_add_u32 m0, s75, 90112
    s_nop 0
    buffer_load_dwordx4 v32, s[44:47], s14 offen lds
    s_add_u32 s13, s13, 128
    s_add_u32 s14, s14, 131072
    v_accvgpr_write_b32 a0, 0
    v_accvgpr_write_b32 a1, 0
    v_accvgpr_write_b32 a2, 0
    v_accvgpr_write_b32 a3, 0
    v_accvgpr_write_b32 a4, 0
    v_accvgpr_write_b32 a5, 0
    v_accvgpr_write_b32 a6, 0
    v_accvgpr_write_b32 a7, 0
    v_accvgpr_write_b32 a8, 0
    v_accvgpr_write_b32 a9, 0
    v_accvgpr_write_b32 a10, 0
    v_accvgpr_write_b32 a11, 0
    v_accvgpr_write_b32 a12, 0
    v_accvgpr_write_b32 a13, 0
    v_accvgpr_write_b32 a14, 0
    v_accvgpr_write_b32 a15, 0
    s_waitcnt vmcnt(9)
    s_barrier
    ds_read_b128 v[64:67], v16
    ds_read_b128 v[68:71], v16 offset:2048
    ds_read_b64_tr_b16 v[72:73], v40
    ds_read_b64_tr_b16 v[74:75], v40 offset:512
    ds_read_b64_tr_b16 v[76:77], v41
    ds_read_b64_tr_b16 v[78:79], v41 offset:512
    ds_read_b128 v[80:83], v17
    ds_read_b128 v[84:87], v17 offset:2048
    ds_read_b64_tr_b16 v[88:89], v40 offset:4096
    ds_read_b64_tr_b16 v[90:91], v40 offset:4608
    ds_read_b64_tr_b16 v[92:93], v41 offset:4096
    ds_read_b64_tr_b16 v[94:95], v41 offset:4608
    s_mov_b32 s15, 3
wo_kernel_loop:
    s_waitcnt vmcnt(6) lgkmcnt(0)
    s_barrier
    v_mfma_f32_16x16x32_bf16 a[0:3], v[72:75], v[64:67], a[0:3]
    ds_read_b128 v[96:99], v18
    ds_read_b128 v[100:103], v18 offset:2048
    v_mfma_f32_16x16x32_bf16 a[4:7], v[72:75], v[68:71], a[4:7]
    ds_read_b64_tr_b16 v[104:105], v42
    s_add_u32 m0, s12, 0
    s_nop 0
    buffer_load_dwordx4 v4, s[40:43], s13 offen lds
    v_mfma_f32_16x16x32_bf16 a[8:11], v[76:79], v[64:67], a[8:11]
    ds_read_b64_tr_b16 v[106:107], v42 offset:512
    ds_read_b64_tr_b16 v[108:109], v43
    v_mfma_f32_16x16x32_bf16 a[12:15], v[76:79], v[68:71], a[12:15]
    ds_read_b64_tr_b16 v[110:111], v43 offset:512
    s_add_u32 m0, s12, 8192
    s_nop 0
    buffer_load_dwordx4 v5, s[40:43], s13 offen lds
    v_mfma_f32_16x16x32_bf16 a[0:3], v[88:91], v[80:83], a[0:3]
    ds_read_b128 v[112:115], v19
    ds_read_b128 v[116:119], v19 offset:2048
    v_mfma_f32_16x16x32_bf16 a[4:7], v[88:91], v[84:87], a[4:7]
    ds_read_b64_tr_b16 v[120:121], v42 offset:4096
    s_add_u32 m0, s75, 16384
    s_nop 0
    buffer_load_dwordx4 v32, s[44:47], s14 offen lds
    v_mfma_f32_16x16x32_bf16 a[8:11], v[92:95], v[80:83], a[8:11]
    ds_read_b64_tr_b16 v[122:123], v42 offset:4608
    ds_read_b64_tr_b16 v[124:125], v43 offset:4096
    v_mfma_f32_16x16x32_bf16 a[12:15], v[92:95], v[84:87], a[12:15]
    ds_read_b64_tr_b16 v[126:127], v43 offset:4608
    s_add_u32 s13, s13, 128
    s_add_u32 s14, s14, 131072
    s_waitcnt vmcnt(6) lgkmcnt(0)
    s_barrier
    v_mfma_f32_16x16x32_bf16 a[0:3], v[104:107], v[96:99], a[0:3]
    ds_read_b128 v[64:67], v20
    ds_read_b128 v[68:71], v20 offset:2048
    v_mfma_f32_16x16x32_bf16 a[4:7], v[104:107], v[100:103], a[4:7]
    ds_read_b64_tr_b16 v[72:73], v44
    s_add_u32 m0, s12, 24576
    s_nop 0
    buffer_load_dwordx4 v4, s[40:43], s13 offen lds
    v_mfma_f32_16x16x32_bf16 a[8:11], v[108:111], v[96:99], a[8:11]
    ds_read_b64_tr_b16 v[74:75], v44 offset:512
    ds_read_b64_tr_b16 v[76:77], v45
    v_mfma_f32_16x16x32_bf16 a[12:15], v[108:111], v[100:103], a[12:15]
    ds_read_b64_tr_b16 v[78:79], v45 offset:512
    s_add_u32 m0, s12, 32768
    s_nop 0
    buffer_load_dwordx4 v5, s[40:43], s13 offen lds
    v_mfma_f32_16x16x32_bf16 a[0:3], v[120:123], v[112:115], a[0:3]
    ds_read_b128 v[80:83], v21
    ds_read_b128 v[84:87], v21 offset:2048
    v_mfma_f32_16x16x32_bf16 a[4:7], v[120:123], v[116:119], a[4:7]
    ds_read_b64_tr_b16 v[88:89], v44 offset:4096
    s_add_u32 m0, s75, 40960
    s_nop 0
    buffer_load_dwordx4 v32, s[44:47], s14 offen lds
    v_mfma_f32_16x16x32_bf16 a[8:11], v[124:127], v[112:115], a[8:11]
    ds_read_b64_tr_b16 v[90:91], v44 offset:4608
    ds_read_b64_tr_b16 v[92:93], v45 offset:4096
    v_mfma_f32_16x16x32_bf16 a[12:15], v[124:127], v[116:119], a[12:15]
    ds_read_b64_tr_b16 v[94:95], v45 offset:4608
    s_add_u32 s13, s13, 128
    s_add_u32 s14, s14, 131072
    s_waitcnt vmcnt(6) lgkmcnt(0)
    s_barrier
    v_mfma_f32_16x16x32_bf16 a[0:3], v[72:75], v[64:67], a[0:3]
    ds_read_b128 v[96:99], v22
    ds_read_b128 v[100:103], v22 offset:2048
    v_mfma_f32_16x16x32_bf16 a[4:7], v[72:75], v[68:71], a[4:7]
    ds_read_b64_tr_b16 v[104:105], v46
    s_add_u32 m0, s12, 49152
    s_nop 0
    buffer_load_dwordx4 v4, s[40:43], s13 offen lds
    v_mfma_f32_16x16x32_bf16 a[8:11], v[76:79], v[64:67], a[8:11]
    ds_read_b64_tr_b16 v[106:107], v46 offset:512
    ds_read_b64_tr_b16 v[108:109], v47
    v_mfma_f32_16x16x32_bf16 a[12:15], v[76:79], v[68:71], a[12:15]
    ds_read_b64_tr_b16 v[110:111], v47 offset:512
    s_add_u32 m0, s12, 57344
    s_nop 0
    buffer_load_dwordx4 v5, s[40:43], s13 offen lds
    v_mfma_f32_16x16x32_bf16 a[0:3], v[88:91], v[80:83], a[0:3]
    ds_read_b128 v[112:115], v23
    ds_read_b128 v[116:119], v23 offset:2048
    v_mfma_f32_16x16x32_bf16 a[4:7], v[88:91], v[84:87], a[4:7]
    ds_read_b64_tr_b16 v[120:121], v46 offset:4096
    s_add_u32 m0, s75, 65536
    s_nop 0
    buffer_load_dwordx4 v32, s[44:47], s14 offen lds
    v_mfma_f32_16x16x32_bf16 a[8:11], v[92:95], v[80:83], a[8:11]
    ds_read_b64_tr_b16 v[122:123], v46 offset:4608
    ds_read_b64_tr_b16 v[124:125], v47 offset:4096
    v_mfma_f32_16x16x32_bf16 a[12:15], v[92:95], v[84:87], a[12:15]
    ds_read_b64_tr_b16 v[126:127], v47 offset:4608
    s_add_u32 s13, s13, 128
    s_add_u32 s14, s14, 131072
    s_waitcnt vmcnt(6) lgkmcnt(0)
    s_barrier
    v_mfma_f32_16x16x32_bf16 a[0:3], v[104:107], v[96:99], a[0:3]
    ds_read_b128 v[64:67], v16
    ds_read_b128 v[68:71], v16 offset:2048
    v_mfma_f32_16x16x32_bf16 a[4:7], v[104:107], v[100:103], a[4:7]
    ds_read_b64_tr_b16 v[72:73], v40
    s_add_u32 m0, s12, 73728
    s_nop 0
    buffer_load_dwordx4 v4, s[40:43], s13 offen lds
    v_mfma_f32_16x16x32_bf16 a[8:11], v[108:111], v[96:99], a[8:11]
    ds_read_b64_tr_b16 v[74:75], v40 offset:512
    ds_read_b64_tr_b16 v[76:77], v41
    v_mfma_f32_16x16x32_bf16 a[12:15], v[108:111], v[100:103], a[12:15]
    ds_read_b64_tr_b16 v[78:79], v41 offset:512
    s_add_u32 m0, s12, 81920
    s_nop 0
    buffer_load_dwordx4 v5, s[40:43], s13 offen lds
    v_mfma_f32_16x16x32_bf16 a[0:3], v[120:123], v[112:115], a[0:3]
    ds_read_b128 v[80:83], v17
    ds_read_b128 v[84:87], v17 offset:2048
    v_mfma_f32_16x16x32_bf16 a[4:7], v[120:123], v[116:119], a[4:7]
    ds_read_b64_tr_b16 v[88:89], v40 offset:4096
    s_add_u32 m0, s75, 90112
    s_nop 0
    buffer_load_dwordx4 v32, s[44:47], s14 offen lds
    v_mfma_f32_16x16x32_bf16 a[8:11], v[124:127], v[112:115], a[8:11]
    ds_read_b64_tr_b16 v[90:91], v40 offset:4608
    ds_read_b64_tr_b16 v[92:93], v41 offset:4096
    v_mfma_f32_16x16x32_bf16 a[12:15], v[124:127], v[116:119], a[12:15]
    ds_read_b64_tr_b16 v[94:95], v41 offset:4608
    s_add_u32 s13, s13, 128
    s_add_u32 s14, s14, 131072
    s_sub_u32 s15, s15, 1
    s_cmp_lg_u32 s15, 0
    s_cbranch_scc1 wo_kernel_loop
    s_nop 3
    v_and_b32 v10, 15, v2
    v_lshrrev_b32 v11, 4, v2
    v_and_b32 v12, 1, v11
    v_lshlrev_b32 v12, 5, v12
    v_lshrrev_b32 v13, 1, v11
    v_lshl_add_u32 v12, v13, 4, v12
    s_lshl_b32 s9, s4, 6
    s_lshl_b32 s10, s8, 5
    s_add_u32 s9, s9, s10
    s_lshl_b32 s10, s3, 7
    s_lshl_b32 s11, s7, 5
    s_add_u32 s10, s10, s11
    s_add_u32 s60, s16, 0
    s_addc_u32 s61, s17, 0
    s_and_b32 s61, s61, 0xffff
    s_mov_b32 s62, 4194304
    s_mov_b32 s63, 0x00020000
    s_add_u32 s64, s38, 25165824
    s_addc_u32 s65, s39, 0
    s_and_b32 s65, s65, 0xffff
    s_mov_b32 s66, 4194304
    s_mov_b32 s67, 0x00020000
    s_add_u32 s68, s38, 0
    s_addc_u32 s69, s39, 0
    s_and_b32 s69, s69, 0xffff
    s_mov_b32 s70, 24576
    s_mov_b32 s71, 0x00020000
    v_add_u32 v14, s10, v10
    v_lshlrev_b32 v14, 11, v14
    s_lshl_b32 s11, s9, 1
    v_add_u32 v14, s11, v14
    v_lshl_add_u32 v15, v11, 3, v14
    v_add_u32 v144, v14, v12
    s_lshl_b32 s11, s9, 2
    s_add_u32 s11, s11, 8192
    v_lshlrev_b32 v13, 4, v11
    buffer_load_dwordx4 v[128:131], v13, s[68:71], s11 offen
    buffer_load_dwordx4 v[132:135], v13, s[68:71], s11 offen offset:64
    s_mov_b32 s9, 0
    buffer_load_dwordx2 v[136:137], v15, s[60:63], s9 offen
    buffer_load_dwordx2 v[138:139], v15, s[60:63], s9 offen offset:32
    s_mov_b32 s9, 32768
    buffer_load_dwordx2 v[140:141], v15, s[60:63], s9 offen
    buffer_load_dwordx2 v[142:143], v15, s[60:63], s9 offen offset:32
    s_waitcnt vmcnt(12) lgkmcnt(0)
    s_barrier
    v_mfma_f32_16x16x32_bf16 a[0:3], v[72:75], v[64:67], a[0:3]
    ds_read_b128 v[96:99], v18
    ds_read_b128 v[100:103], v18 offset:2048
    v_mfma_f32_16x16x32_bf16 a[4:7], v[72:75], v[68:71], a[4:7]
    ds_read_b64_tr_b16 v[104:105], v42
    ds_read_b64_tr_b16 v[106:107], v42 offset:512
    v_mfma_f32_16x16x32_bf16 a[8:11], v[76:79], v[64:67], a[8:11]
    ds_read_b64_tr_b16 v[108:109], v43
    ds_read_b64_tr_b16 v[110:111], v43 offset:512
    v_mfma_f32_16x16x32_bf16 a[12:15], v[76:79], v[68:71], a[12:15]
    ds_read_b128 v[112:115], v19
    ds_read_b128 v[116:119], v19 offset:2048
    v_mfma_f32_16x16x32_bf16 a[0:3], v[88:91], v[80:83], a[0:3]
    ds_read_b64_tr_b16 v[120:121], v42 offset:4096
    v_mfma_f32_16x16x32_bf16 a[4:7], v[88:91], v[84:87], a[4:7]
    ds_read_b64_tr_b16 v[122:123], v42 offset:4608
    v_mfma_f32_16x16x32_bf16 a[8:11], v[92:95], v[80:83], a[8:11]
    ds_read_b64_tr_b16 v[124:125], v43 offset:4096
    v_mfma_f32_16x16x32_bf16 a[12:15], v[92:95], v[84:87], a[12:15]
    ds_read_b64_tr_b16 v[126:127], v43 offset:4608
    s_waitcnt vmcnt(9) lgkmcnt(0)
    s_barrier
    v_mfma_f32_16x16x32_bf16 a[0:3], v[104:107], v[96:99], a[0:3]
    ds_read_b128 v[64:67], v20
    ds_read_b128 v[68:71], v20 offset:2048
    v_mfma_f32_16x16x32_bf16 a[4:7], v[104:107], v[100:103], a[4:7]
    ds_read_b64_tr_b16 v[72:73], v44
    ds_read_b64_tr_b16 v[74:75], v44 offset:512
    v_mfma_f32_16x16x32_bf16 a[8:11], v[108:111], v[96:99], a[8:11]
    ds_read_b64_tr_b16 v[76:77], v45
    ds_read_b64_tr_b16 v[78:79], v45 offset:512
    v_mfma_f32_16x16x32_bf16 a[12:15], v[108:111], v[100:103], a[12:15]
    ds_read_b128 v[80:83], v21
    ds_read_b128 v[84:87], v21 offset:2048
    v_mfma_f32_16x16x32_bf16 a[0:3], v[120:123], v[112:115], a[0:3]
    ds_read_b64_tr_b16 v[88:89], v44 offset:4096
    v_mfma_f32_16x16x32_bf16 a[4:7], v[120:123], v[116:119], a[4:7]
    ds_read_b64_tr_b16 v[90:91], v44 offset:4608
    v_mfma_f32_16x16x32_bf16 a[8:11], v[124:127], v[112:115], a[8:11]
    ds_read_b64_tr_b16 v[92:93], v45 offset:4096
    v_mfma_f32_16x16x32_bf16 a[12:15], v[124:127], v[116:119], a[12:15]
    ds_read_b64_tr_b16 v[94:95], v45 offset:4608
    s_waitcnt vmcnt(6) lgkmcnt(0)
    s_barrier
    v_mfma_f32_16x16x32_bf16 a[0:3], v[72:75], v[64:67], a[0:3]
    ds_read_b128 v[96:99], v22
    ds_read_b128 v[100:103], v22 offset:2048
    v_mfma_f32_16x16x32_bf16 a[4:7], v[72:75], v[68:71], a[4:7]
    ds_read_b64_tr_b16 v[104:105], v46
    ds_read_b64_tr_b16 v[106:107], v46 offset:512
    v_mfma_f32_16x16x32_bf16 a[8:11], v[76:79], v[64:67], a[8:11]
    ds_read_b64_tr_b16 v[108:109], v47
    ds_read_b64_tr_b16 v[110:111], v47 offset:512
    v_mfma_f32_16x16x32_bf16 a[12:15], v[76:79], v[68:71], a[12:15]
    ds_read_b128 v[112:115], v23
    ds_read_b128 v[116:119], v23 offset:2048
    v_mfma_f32_16x16x32_bf16 a[0:3], v[88:91], v[80:83], a[0:3]
    ds_read_b64_tr_b16 v[120:121], v46 offset:4096
    v_mfma_f32_16x16x32_bf16 a[4:7], v[88:91], v[84:87], a[4:7]
    ds_read_b64_tr_b16 v[122:123], v46 offset:4608
    v_mfma_f32_16x16x32_bf16 a[8:11], v[92:95], v[80:83], a[8:11]
    ds_read_b64_tr_b16 v[124:125], v47 offset:4096
    v_mfma_f32_16x16x32_bf16 a[12:15], v[92:95], v[84:87], a[12:15]
    ds_read_b64_tr_b16 v[126:127], v47 offset:4608
    s_waitcnt lgkmcnt(0)
    v_mfma_f32_16x16x32_bf16 a[0:3], v[104:107], v[96:99], a[0:3]
    v_mfma_f32_16x16x32_bf16 a[4:7], v[104:107], v[100:103], a[4:7]
    v_mfma_f32_16x16x32_bf16 a[8:11], v[108:111], v[96:99], a[8:11]
    v_mfma_f32_16x16x32_bf16 a[12:15], v[108:111], v[100:103], a[12:15]
    v_mfma_f32_16x16x32_bf16 a[0:3], v[120:123], v[112:115], a[0:3]
    v_mfma_f32_16x16x32_bf16 a[4:7], v[120:123], v[116:119], a[4:7]
    v_mfma_f32_16x16x32_bf16 a[8:11], v[124:127], v[112:115], a[8:11]
    v_mfma_f32_16x16x32_bf16 a[12:15], v[124:127], v[116:119], a[12:15]
    s_nop 11
    s_waitcnt vmcnt(0)
    v_accvgpr_read_b32 v64, a0
    v_accvgpr_read_b32 v65, a1
    v_accvgpr_read_b32 v66, a2
    v_accvgpr_read_b32 v67, a3
    v_accvgpr_read_b32 v68, a8
    v_accvgpr_read_b32 v69, a9
    v_accvgpr_read_b32 v70, a10
    v_accvgpr_read_b32 v71, a11
    v_cvt_pk_bf16_f32 v64, v64, v64
    v_and_b32 v64, 0xffff0000, v64
    v_mul_f32 v64, v64, v128
    v_cvt_pk_bf16_f32 v64, v64, v64
    v_and_b32 v64, 0xffff0000, v64
    v_cvt_pk_bf16_f32 v65, v65, v65
    v_and_b32 v65, 0xffff0000, v65
    v_mul_f32 v65, v65, v129
    v_cvt_pk_bf16_f32 v65, v65, v65
    v_and_b32 v65, 0xffff0000, v65
    v_cvt_pk_bf16_f32 v66, v66, v66
    v_and_b32 v66, 0xffff0000, v66
    v_mul_f32 v66, v66, v130
    v_cvt_pk_bf16_f32 v66, v66, v66
    v_and_b32 v66, 0xffff0000, v66
    v_cvt_pk_bf16_f32 v67, v67, v67
    v_and_b32 v67, 0xffff0000, v67
    v_mul_f32 v67, v67, v131
    v_cvt_pk_bf16_f32 v67, v67, v67
    v_and_b32 v67, 0xffff0000, v67
    v_cvt_pk_bf16_f32 v68, v68, v68
    v_and_b32 v68, 0xffff0000, v68
    v_mul_f32 v68, v68, v132
    v_cvt_pk_bf16_f32 v68, v68, v68
    v_and_b32 v68, 0xffff0000, v68
    v_cvt_pk_bf16_f32 v69, v69, v69
    v_and_b32 v69, 0xffff0000, v69
    v_mul_f32 v69, v69, v133
    v_cvt_pk_bf16_f32 v69, v69, v69
    v_and_b32 v69, 0xffff0000, v69
    v_cvt_pk_bf16_f32 v70, v70, v70
    v_and_b32 v70, 0xffff0000, v70
    v_mul_f32 v70, v70, v134
    v_cvt_pk_bf16_f32 v70, v70, v70
    v_and_b32 v70, 0xffff0000, v70
    v_cvt_pk_bf16_f32 v71, v71, v71
    v_and_b32 v71, 0xffff0000, v71
    v_mul_f32 v71, v71, v135
    v_cvt_pk_bf16_f32 v71, v71, v71
    v_and_b32 v71, 0xffff0000, v71
    v_lshlrev_b32 v76, 16, v136
    v_and_b32 v77, 0xffff0000, v136
    v_lshlrev_b32 v78, 16, v137
    v_and_b32 v79, 0xffff0000, v137
    v_lshlrev_b32 v80, 16, v138
    v_and_b32 v81, 0xffff0000, v138
    v_lshlrev_b32 v82, 16, v139
    v_and_b32 v83, 0xffff0000, v139
    v_add_f32 v64, v64, v76
    v_add_f32 v65, v65, v77
    v_add_f32 v66, v66, v78
    v_add_f32 v67, v67, v79
    v_add_f32 v68, v68, v80
    v_add_f32 v69, v69, v81
    v_add_f32 v70, v70, v82
    v_add_f32 v71, v71, v83
    v_cvt_pk_bf16_f32 v72, v64, v65
    v_cvt_pk_bf16_f32 v73, v66, v67
    v_cvt_pk_bf16_f32 v74, v68, v69
    v_cvt_pk_bf16_f32 v75, v70, v71
    s_nop 0
    v_permlane16_swap_b32 v72, v74
    v_permlane16_swap_b32 v73, v75
    s_mov_b32 s12, 0
    buffer_store_dwordx4 v[72:75], v144, s[64:67], s12 offen
    v_accvgpr_read_b32 v88, a4
    v_accvgpr_read_b32 v89, a5
    v_accvgpr_read_b32 v90, a6
    v_accvgpr_read_b32 v91, a7
    v_accvgpr_read_b32 v92, a12
    v_accvgpr_read_b32 v93, a13
    v_accvgpr_read_b32 v94, a14
    v_accvgpr_read_b32 v95, a15
    v_cvt_pk_bf16_f32 v88, v88, v88
    v_and_b32 v88, 0xffff0000, v88
    v_mul_f32 v88, v88, v128
    v_cvt_pk_bf16_f32 v88, v88, v88
    v_and_b32 v88, 0xffff0000, v88
    v_cvt_pk_bf16_f32 v89, v89, v89
    v_and_b32 v89, 0xffff0000, v89
    v_mul_f32 v89, v89, v129
    v_cvt_pk_bf16_f32 v89, v89, v89
    v_and_b32 v89, 0xffff0000, v89
    v_cvt_pk_bf16_f32 v90, v90, v90
    v_and_b32 v90, 0xffff0000, v90
    v_mul_f32 v90, v90, v130
    v_cvt_pk_bf16_f32 v90, v90, v90
    v_and_b32 v90, 0xffff0000, v90
    v_cvt_pk_bf16_f32 v91, v91, v91
    v_and_b32 v91, 0xffff0000, v91
    v_mul_f32 v91, v91, v131
    v_cvt_pk_bf16_f32 v91, v91, v91
    v_and_b32 v91, 0xffff0000, v91
    v_cvt_pk_bf16_f32 v92, v92, v92
    v_and_b32 v92, 0xffff0000, v92
    v_mul_f32 v92, v92, v132
    v_cvt_pk_bf16_f32 v92, v92, v92
    v_and_b32 v92, 0xffff0000, v92
    v_cvt_pk_bf16_f32 v93, v93, v93
    v_and_b32 v93, 0xffff0000, v93
    v_mul_f32 v93, v93, v133
    v_cvt_pk_bf16_f32 v93, v93, v93
    v_and_b32 v93, 0xffff0000, v93
    v_cvt_pk_bf16_f32 v94, v94, v94
    v_and_b32 v94, 0xffff0000, v94
    v_mul_f32 v94, v94, v134
    v_cvt_pk_bf16_f32 v94, v94, v94
    v_and_b32 v94, 0xffff0000, v94
    v_cvt_pk_bf16_f32 v95, v95, v95
    v_and_b32 v95, 0xffff0000, v95
    v_mul_f32 v95, v95, v135
    v_cvt_pk_bf16_f32 v95, v95, v95
    v_and_b32 v95, 0xffff0000, v95
    v_lshlrev_b32 v100, 16, v140
    v_and_b32 v101, 0xffff0000, v140
    v_lshlrev_b32 v102, 16, v141
    v_and_b32 v103, 0xffff0000, v141
    v_lshlrev_b32 v104, 16, v142
    v_and_b32 v105, 0xffff0000, v142
    v_lshlrev_b32 v106, 16, v143
    v_and_b32 v107, 0xffff0000, v143
    v_add_f32 v88, v88, v100
    v_add_f32 v89, v89, v101
    v_add_f32 v90, v90, v102
    v_add_f32 v91, v91, v103
    v_add_f32 v92, v92, v104
    v_add_f32 v93, v93, v105
    v_add_f32 v94, v94, v106
    v_add_f32 v95, v95, v107
    v_cvt_pk_bf16_f32 v96, v88, v89
    v_cvt_pk_bf16_f32 v97, v90, v91
    v_cvt_pk_bf16_f32 v98, v92, v93
    v_cvt_pk_bf16_f32 v99, v94, v95
    s_nop 0
    v_permlane16_swap_b32 v96, v98
    v_permlane16_swap_b32 v97, v99
    s_mov_b32 s12, 32768
    buffer_store_dwordx4 v[96:99], v144, s[64:67], s12 offen
    s_waitcnt vmcnt(0)
wo_kernel_end:
    s_endpgm
.p2align 8
.globl ln2_kernel
.type ln2_kernel,@function
ln2_kernel:
    s_cmp_ge_u32 s2, 512
    s_cbranch_scc1 ln2_kernel_end
    s_load_dwordx16 s[16:31], s[0:1], 0
    s_load_dwordx8 s[32:39], s[0:1], 64
    v_lshrrev_b32 v1, 6, v0
    v_and_b32 v2, 63, v0
    s_lshl_b32 s3, s2, 2
    v_add_u32 v1, s3, v1
    v_lshlrev_b32 v3, 11, v1
    v_lshl_add_u32 v3, v2, 4, v3
    v_lshlrev_b32 v4, 5, v2
    s_waitcnt lgkmcnt(0)
    s_add_u32 s40, s38, 25165824
    s_addc_u32 s41, s39, 0
    s_and_b32 s41, s41, 0xffff
    s_mov_b32 s42, 4194304
    s_mov_b32 s43, 0x00020000
    s_add_u32 s44, s38, 29360128
    s_addc_u32 s45, s39, 0
    s_and_b32 s45, s45, 0xffff
    s_mov_b32 s46, 4194304
    s_mov_b32 s47, 0x00020000
    s_add_u32 s48, s38, 0
    s_addc_u32 s49, s39, 0
    s_and_b32 s49, s49, 0xffff
    s_mov_b32 s50, 24576
    s_mov_b32 s51, 0x00020000
    buffer_load_dwordx4 v[8:11], v3, s[40:43], 0 offen
    buffer_load_dwordx4 v[12:15], v3, s[40:43], 0 offen offset:1024
    s_mov_b32 s4, 16384
    s_mov_b32 s5, 12288
    buffer_load_dwordx4 v[64:67], v4, s[48:51], s4 offen
    buffer_load_dwordx4 v[68:71], v4, s[48:51], s4 offen offset:16
    buffer_load_dwordx4 v[72:75], v4, s[48:51], s4 offen offset:2048
    buffer_load_dwordx4 v[76:79], v4, s[48:51], s4 offen offset:2064
    buffer_load_dwordx4 v[80:83], v4, s[48:51], s5 offen
    buffer_load_dwordx4 v[84:87], v4, s[48:51], s5 offen offset:16
    buffer_load_dwordx4 v[88:91], v4, s[48:51], s5 offen offset:2048
    buffer_load_dwordx4 v[92:95], v4, s[48:51], s5 offen offset:2064
    s_waitcnt vmcnt(8)
    v_lshlrev_b32 v16, 16, v8
    v_and_b32 v17, 0xffff0000, v8
    v_lshlrev_b32 v18, 16, v9
    v_and_b32 v19, 0xffff0000, v9
    v_lshlrev_b32 v20, 16, v10
    v_and_b32 v21, 0xffff0000, v10
    v_lshlrev_b32 v22, 16, v11
    v_and_b32 v23, 0xffff0000, v11
    v_lshlrev_b32 v24, 16, v12
    v_and_b32 v25, 0xffff0000, v12
    v_lshlrev_b32 v26, 16, v13
    v_and_b32 v27, 0xffff0000, v13
    v_lshlrev_b32 v28, 16, v14
    v_and_b32 v29, 0xffff0000, v14
    v_lshlrev_b32 v30, 16, v15
    v_and_b32 v31, 0xffff0000, v15
    v_add_f32 v32, v16, v17
    v_add_f32 v32, v32, v18
    v_add_f32 v32, v32, v19
    v_add_f32 v32, v32, v20
    v_add_f32 v32, v32, v21
    v_add_f32 v32, v32, v22
    v_add_f32 v32, v32, v23
    v_add_f32 v32, v32, v24
    v_add_f32 v32, v32, v25
    v_add_f32 v32, v32, v26
    v_add_f32 v32, v32, v27
    v_add_f32 v32, v32, v28
    v_add_f32 v32, v32, v29
    v_add_f32 v32, v32, v30
    v_add_f32 v32, v32, v31
    s_nop 1
    v_add_f32 v33, v32, v32 quad_perm:[1,0,3,2] row_mask:0xf bank_mask:0xf
    s_nop 1
    v_add_f32 v32, v33, v33 quad_perm:[2,3,0,1] row_mask:0xf bank_mask:0xf
    s_nop 1
    v_add_f32 v33, v32, v32 row_half_mirror row_mask:0xf bank_mask:0xf
    s_nop 1
    v_add_f32 v32, v33, v33 row_mirror row_mask:0xf bank_mask:0xf
    s_nop 0
    v_readlane_b32 s8, v32, 0
    v_readlane_b32 s9, v32, 16
    v_readlane_b32 s10, v32, 32
    v_readlane_b32 s11, v32, 48
    v_mov_b32 v32, s8
    v_add_f32 v32, s9, v32
    v_add_f32 v32, s10, v32
    v_add_f32 v32, s11, v32
    v_mul_f32 v32, 0x3a800000, v32
    v_sub_f32 v34, v16, v32
    v_mul_f32 v35, v34, v34
    v_sub_f32 v34, v17, v32
    v_fmac_f32 v35, v34, v34
    v_sub_f32 v34, v18, v32
    v_fmac_f32 v35, v34, v34
    v_sub_f32 v34, v19, v32
    v_fmac_f32 v35, v34, v34
    v_sub_f32 v34, v20, v32
    v_fmac_f32 v35, v34, v34
    v_sub_f32 v34, v21, v32
    v_fmac_f32 v35, v34, v34
    v_sub_f32 v34, v22, v32
    v_fmac_f32 v35, v34, v34
    v_sub_f32 v34, v23, v32
    v_fmac_f32 v35, v34, v34
    v_sub_f32 v34, v24, v32
    v_fmac_f32 v35, v34, v34
    v_sub_f32 v34, v25, v32
    v_fmac_f32 v35, v34, v34
    v_sub_f32 v34, v26, v32
    v_fmac_f32 v35, v34, v34
    v_sub_f32 v34, v27, v32
    v_fmac_f32 v35, v34, v34
    v_sub_f32 v34, v28, v32
    v_fmac_f32 v35, v34, v34
    v_sub_f32 v34, v29, v32
    v_fmac_f32 v35, v34, v34
    v_sub_f32 v34, v30, v32
    v_fmac_f32 v35, v34, v34
    v_sub_f32 v34, v31, v32
    v_fmac_f32 v35, v34, v34
    s_nop 1
    v_add_f32 v33, v35, v35 quad_perm:[1,0,3,2] row_mask:0xf bank_mask:0xf
    s_nop 1
    v_add_f32 v35, v33, v33 quad_perm:[2,3,0,1] row_mask:0xf bank_mask:0xf
    s_nop 1
    v_add_f32 v33, v35, v35 row_half_mirror row_mask:0xf bank_mask:0xf
    s_nop 1
    v_add_f32 v35, v33, v33 row_mirror row_mask:0xf bank_mask:0xf
    s_nop 0
    v_readlane_b32 s8, v35, 0
    v_readlane_b32 s9, v35, 16
    v_readlane_b32 s10, v35, 32
    v_readlane_b32 s11, v35, 48
    v_mov_b32 v35, s8
    v_add_f32 v35, s9, v35
    v_add_f32 v35, s10, v35
    v_add_f32 v35, s11, v35
    v_mul_f32 v35, 0x3a800000, v35
    v_cvt_pk_bf16_f32 v32, v32, v32
    v_and_b32 v32, 0xffff0000, v32
    v_cvt_pk_bf16_f32 v35, v35, v35
    v_and_b32 v35, 0xffff0000, v35
    v_add_f32 v35, 0x3727c5ac, v35
    v_cvt_pk_bf16_f32 v35, v35, v35
    v_and_b32 v35, 0xffff0000, v35
    v_sqrt_f32 v35, v35
    s_nop 0
    v_cvt_pk_bf16_f32 v35, v35, v35
    v_and_b32 v35, 0xffff0000, v35
    v_rcp_f32 v36, v35
    s_waitcnt vmcnt(0)
    v_sub_f32 v16, v16, v32
    v_cvt_pk_bf16_f32 v16, v16, v16
    v_and_b32 v16, 0xffff0000, v16
    v_mul_f32 v16, v16, v36
    v_cvt_pk_bf16_f32 v16, v16, v16
    v_and_b32 v16, 0xffff0000, v16
    v_mul_f32 v16, v16, v64
    v_cvt_pk_bf16_f32 v16, v16, v16
    v_and_b32 v16, 0xffff0000, v16
    v_add_f32 v16, v16, v80
    v_sub_f32 v17, v17, v32
    v_cvt_pk_bf16_f32 v17, v17, v17
    v_and_b32 v17, 0xffff0000, v17
    v_mul_f32 v17, v17, v36
    v_cvt_pk_bf16_f32 v17, v17, v17
    v_and_b32 v17, 0xffff0000, v17
    v_mul_f32 v17, v17, v65
    v_cvt_pk_bf16_f32 v17, v17, v17
    v_and_b32 v17, 0xffff0000, v17
    v_add_f32 v17, v17, v81
    v_sub_f32 v18, v18, v32
    v_cvt_pk_bf16_f32 v18, v18, v18
    v_and_b32 v18, 0xffff0000, v18
    v_mul_f32 v18, v18, v36
    v_cvt_pk_bf16_f32 v18, v18, v18
    v_and_b32 v18, 0xffff0000, v18
    v_mul_f32 v18, v18, v66
    v_cvt_pk_bf16_f32 v18, v18, v18
    v_and_b32 v18, 0xffff0000, v18
    v_add_f32 v18, v18, v82
    v_sub_f32 v19, v19, v32
    v_cvt_pk_bf16_f32 v19, v19, v19
    v_and_b32 v19, 0xffff0000, v19
    v_mul_f32 v19, v19, v36
    v_cvt_pk_bf16_f32 v19, v19, v19
    v_and_b32 v19, 0xffff0000, v19
    v_mul_f32 v19, v19, v67
    v_cvt_pk_bf16_f32 v19, v19, v19
    v_and_b32 v19, 0xffff0000, v19
    v_add_f32 v19, v19, v83
    v_sub_f32 v20, v20, v32
    v_cvt_pk_bf16_f32 v20, v20, v20
    v_and_b32 v20, 0xffff0000, v20
    v_mul_f32 v20, v20, v36
    v_cvt_pk_bf16_f32 v20, v20, v20
    v_and_b32 v20, 0xffff0000, v20
    v_mul_f32 v20, v20, v68
    v_cvt_pk_bf16_f32 v20, v20, v20
    v_and_b32 v20, 0xffff0000, v20
    v_add_f32 v20, v20, v84
    v_sub_f32 v21, v21, v32
    v_cvt_pk_bf16_f32 v21, v21, v21
    v_and_b32 v21, 0xffff0000, v21
    v_mul_f32 v21, v21, v36
    v_cvt_pk_bf16_f32 v21, v21, v21
    v_and_b32 v21, 0xffff0000, v21
    v_mul_f32 v21, v21, v69
    v_cvt_pk_bf16_f32 v21, v21, v21
    v_and_b32 v21, 0xffff0000, v21
    v_add_f32 v21, v21, v85
    v_sub_f32 v22, v22, v32
    v_cvt_pk_bf16_f32 v22, v22, v22
    v_and_b32 v22, 0xffff0000, v22
    v_mul_f32 v22, v22, v36
    v_cvt_pk_bf16_f32 v22, v22, v22
    v_and_b32 v22, 0xffff0000, v22
    v_mul_f32 v22, v22, v70
    v_cvt_pk_bf16_f32 v22, v22, v22
    v_and_b32 v22, 0xffff0000, v22
    v_add_f32 v22, v22, v86
    v_sub_f32 v23, v23, v32
    v_cvt_pk_bf16_f32 v23, v23, v23
    v_and_b32 v23, 0xffff0000, v23
    v_mul_f32 v23, v23, v36
    v_cvt_pk_bf16_f32 v23, v23, v23
    v_and_b32 v23, 0xffff0000, v23
    v_mul_f32 v23, v23, v71
    v_cvt_pk_bf16_f32 v23, v23, v23
    v_and_b32 v23, 0xffff0000, v23
    v_add_f32 v23, v23, v87
    v_sub_f32 v24, v24, v32
    v_cvt_pk_bf16_f32 v24, v24, v24
    v_and_b32 v24, 0xffff0000, v24
    v_mul_f32 v24, v24, v36
    v_cvt_pk_bf16_f32 v24, v24, v24
    v_and_b32 v24, 0xffff0000, v24
    v_mul_f32 v24, v24, v72
    v_cvt_pk_bf16_f32 v24, v24, v24
    v_and_b32 v24, 0xffff0000, v24
    v_add_f32 v24, v24, v88
    v_sub_f32 v25, v25, v32
    v_cvt_pk_bf16_f32 v25, v25, v25
    v_and_b32 v25, 0xffff0000, v25
    v_mul_f32 v25, v25, v36
    v_cvt_pk_bf16_f32 v25, v25, v25
    v_and_b32 v25, 0xffff0000, v25
    v_mul_f32 v25, v25, v73
    v_cvt_pk_bf16_f32 v25, v25, v25
    v_and_b32 v25, 0xffff0000, v25
    v_add_f32 v25, v25, v89
    v_sub_f32 v26, v26, v32
    v_cvt_pk_bf16_f32 v26, v26, v26
    v_and_b32 v26, 0xffff0000, v26
    v_mul_f32 v26, v26, v36
    v_cvt_pk_bf16_f32 v26, v26, v26
    v_and_b32 v26, 0xffff0000, v26
    v_mul_f32 v26, v26, v74
    v_cvt_pk_bf16_f32 v26, v26, v26
    v_and_b32 v26, 0xffff0000, v26
    v_add_f32 v26, v26, v90
    v_sub_f32 v27, v27, v32
    v_cvt_pk_bf16_f32 v27, v27, v27
    v_and_b32 v27, 0xffff0000, v27
    v_mul_f32 v27, v27, v36
    v_cvt_pk_bf16_f32 v27, v27, v27
    v_and_b32 v27, 0xffff0000, v27
    v_mul_f32 v27, v27, v75
    v_cvt_pk_bf16_f32 v27, v27, v27
    v_and_b32 v27, 0xffff0000, v27
    v_add_f32 v27, v27, v91
    v_sub_f32 v28, v28, v32
    v_cvt_pk_bf16_f32 v28, v28, v28
    v_and_b32 v28, 0xffff0000, v28
    v_mul_f32 v28, v28, v36
    v_cvt_pk_bf16_f32 v28, v28, v28
    v_and_b32 v28, 0xffff0000, v28
    v_mul_f32 v28, v28, v76
    v_cvt_pk_bf16_f32 v28, v28, v28
    v_and_b32 v28, 0xffff0000, v28
    v_add_f32 v28, v28, v92
    v_sub_f32 v29, v29, v32
    v_cvt_pk_bf16_f32 v29, v29, v29
    v_and_b32 v29, 0xffff0000, v29
    v_mul_f32 v29, v29, v36
    v_cvt_pk_bf16_f32 v29, v29, v29
    v_and_b32 v29, 0xffff0000, v29
    v_mul_f32 v29, v29, v77
    v_cvt_pk_bf16_f32 v29, v29, v29
    v_and_b32 v29, 0xffff0000, v29
    v_add_f32 v29, v29, v93
    v_sub_f32 v30, v30, v32
    v_cvt_pk_bf16_f32 v30, v30, v30
    v_and_b32 v30, 0xffff0000, v30
    v_mul_f32 v30, v30, v36
    v_cvt_pk_bf16_f32 v30, v30, v30
    v_and_b32 v30, 0xffff0000, v30
    v_mul_f32 v30, v30, v78
    v_cvt_pk_bf16_f32 v30, v30, v30
    v_and_b32 v30, 0xffff0000, v30
    v_add_f32 v30, v30, v94
    v_sub_f32 v31, v31, v32
    v_cvt_pk_bf16_f32 v31, v31, v31
    v_and_b32 v31, 0xffff0000, v31
    v_mul_f32 v31, v31, v36
    v_cvt_pk_bf16_f32 v31, v31, v31
    v_and_b32 v31, 0xffff0000, v31
    v_mul_f32 v31, v31, v79
    v_cvt_pk_bf16_f32 v31, v31, v31
    v_and_b32 v31, 0xffff0000, v31
    v_add_f32 v31, v31, v95
    v_cvt_pk_bf16_f32 v8, v16, v17
    v_cvt_pk_bf16_f32 v9, v18, v19
    v_cvt_pk_bf16_f32 v10, v20, v21
    v_cvt_pk_bf16_f32 v11, v22, v23
    v_cvt_pk_bf16_f32 v12, v24, v25
    v_cvt_pk_bf16_f32 v13, v26, v27
    v_cvt_pk_bf16_f32 v14, v28, v29
    v_cvt_pk_bf16_f32 v15, v30, v31
    v_lshrrev_b32 v5, 2, v2
    v_lshlrev_b32 v5, 17, v5
    v_lshl_add_u32 v5, v1, 6, v5
    v_and_b32 v6, 3, v2
    v_lshl_add_u32 v5, v6, 4, v5
    v_add_u32 v6, 2097152, v5
    buffer_store_dwordx4 v[8:11], v5, s[44:47], 0 offen
    buffer_store_dwordx4 v[12:15], v6, s[44:47], 0 offen
ln2_kernel_end:
    s_endpgm
.p2align 8
.globl gateup_kernel
.type gateup_kernel,@function
gateup_kernel:
    s_cmp_ge_u32 s2, 256
    s_cbranch_scc1 gateup_kernel_end
    s_load_dwordx16 s[16:31], s[0:1], 0
    s_load_dwordx8 s[32:39], s[0:1], 64
    s_and_b32 s3, s2, 3
    s_lshl_b32 s3, s3, 2
    s_bfe_u32 s4, s2, 0x20003
    s_add_u32 s3, s3, s4
    s_bfe_u32 s4, s2, 0x10002
    s_lshl_b32 s4, s4, 3
    s_lshr_b32 s5, s2, 5
    s_add_u32 s4, s4, s5
    v_lshrrev_b32 v1, 6, v0
    s_nop 0
    v_readfirstlane_b32 s6, v1
    v_and_b32 v2, 63, v0
    s_and_b32 s7, s6, 3
    s_lshr_b32 s8, s6, 2
    s_waitcnt lgkmcnt(0)
    s_mul_i32 s9, s3, 8192
    s_add_u32 s10, s9, 29360128
    s_sub_u32 s11, 4194304, s9
    s_add_u32 s40, s38, s10
    s_addc_u32 s41, s39, 0
    s_and_b32 s41, s41, 0xffff
    s_mov_b32 s42, s11
    s_mov_b32 s43, 0x00020000
    s_mul_i32 s9, s4, 448
    s_add_u32 s9, s9, 0
    s_sub_u32 s11, 7340032, s9
    s_add_u32 s44, s24, s9
    s_addc_u32 s45, s25, 0
    s_and_b32 s45, s45, 0xffff
    s_mov_b32 s46, s11
    s_mov_b32 s47, 0x00020000
    s_mul_i32 s9, s4, 448
    s_add_u32 s9, s9, 0
    s_sub_u32 s11, 7340032, s9
    s_add_u32 s48, s26, s9
    s_addc_u32 s49, s27, 0
    s_and_b32 s49, s49, 0xffff
    s_mov_b32 s50, s11
    s_mov_b32 s51, 0x00020000
    v_lshrrev_b32 v10, 3, v2
    v_lshrrev_b32 v11, 4, v2
    v_bfe_u32 v12, v2, 2, 2
    v_and_b32 v15, 3, v2
    v_lshrrev_b32 v13, 1, v11
    v_xor_b32 v14, v13, v11
    v_and_b32 v14, 1, v14
    v_lshl_add_u32 v13, v14, 1, v13
    v_xor_b32 v13, v13, v15
    v_lshrrev_b32 v14, 2, v2
    v_lshlrev_b32 v14, 6, v14
    v_lshl_add_u32 v4, v13, 4, v14
    s_lshl_b32 s9, s6, 10
    v_add_u32 v4, s9, v4
    s_and_b32 s76, s6, 3
    s_cmp_lt_u32 s6, 4
    s_cselect_b32 s44, s44, s48
    s_cselect_b32 s45, s45, s49
    s_cselect_b32 s46, s46, s50
    s_cselect_b32 s47, s47, s51
    s_cselect_b32 s75, 0, 14336
    s_lshl_b32 s9, s76, 10
    s_add_u32 s75, s75, s9
    s_cmp_lt_u32 s76, 2
    s_cselect_b32 s77, 3, 2
    s_lshl_b32 s77, s77, 8
    s_lshl_b32 s79, s77, 4
    s_add_u32 s79, s79, s75
    s_mov_b32 s10, 37450
    s_mov_b32 s11, 7168
    s_lshl_b32 s9, s76, 6
    s_add_u32 s9, s9, 0
    v_add_u32 v13, s9, v2
    v_mul_lo_u32 v14, v13, s10
    v_lshrrev_b32 v14, 20, v14
    v_mul_u32_u24 v9, 28, v14
    v_sub_u32 v13, v13, v9
    v_bfe_u32 v9, v14, 3, 1
    v_lshlrev_b32 v9, 1, v9
    v_xor_b32 v13, v13, v9
    v_mul_lo_u32 v14, v14, s11
    v_lshl_add_u32 v32, v13, 4, v14
    s_lshl_b32 s9, s76, 6
    s_add_u32 s9, s9, 256
    v_add_u32 v13, s9, v2
    v_mul_lo_u32 v14, v13, s10
    v_lshrrev_b32 v14, 20, v14
    v_mul_u32_u24 v9, 28, v14
    v_sub_u32 v13, v13, v9
    v_bfe_u32 v9, v14, 3, 1
    v_lshlrev_b32 v9, 1, v9
    v_xor_b32 v13, v13, v9
    v_mul_lo_u32 v14, v14, s11
    v_lshl_add_u32 v33, v13, 4, v14
    s_lshl_b32 s9, s76, 6
    s_add_u32 s9, s9, 512
    v_add_u32 v13, s9, v2
    v_mul_lo_u32 v14, v13, s10
    v_lshrrev_b32 v14, 20, v14
    v_mul_u32_u24 v9, 28, v14
    v_sub_u32 v13, v13, v9
    v_bfe_u32 v9, v14, 3, 1
    v_lshlrev_b32 v9, 1, v9
    v_xor_b32 v13, v13, v9
    v_mul_lo_u32 v14, v14, s11
    v_lshl_add_u32 v34, v13, 4, v14
    s_lshl_b32 s9, s76, 6
    s_add_u32 s9, s9, s77
    v_add_u32 v13, s9, v2
    v_mul_lo_u32 v14, v13, s10
    v_lshrrev_b32 v14, 20, v14
    v_mul_u32_u24 v9, 28, v14
    v_sub_u32 v13, v13, v9
    v_bfe_u32 v9, v14, 3, 1
    v_lshlrev_b32 v9, 1, v9
    v_xor_b32 v13, v13, v9
    v_mul_lo_u32 v14, v14, s11
    v_lshl_add_u32 v35, v13, 4, v14
    v_lshrrev_b32 v13, 1, v12
    v_xor_b32 v14, v13, v12
    v_and_b32 v14, 1, v14
    v_lshl_add_u32 v13, v14, 1, v13
    v_xor_b32 v14, v13, v11
    v_and_b32 v13, 15, v2
    v_lshlrev_b32 v13, 6, v13
    v_lshl_add_u32 v13, v14, 4, v13
    s_lshl_b32 s9, s7, 11
    v_add_u32 v13, s9, v13
    v_add_u32 v16, 0, v13
    v_add_u32 v18, 36864, v13
    v_add_u32 v20, 73728, v13
    v_add_u32 v22, 110592, v13
    v_lshl_add_u32 v14, v11, 3, v12
    v_mul_u32_u24 v14, 448, v14
    v_lshl_add_u32 v14, v15, 3, v14
    s_mul_i32 s9, s8, 224
    v_add_u32 v14, s9, v14
    v_and_b32 v13, 1, v11
    v_lshlrev_b32 v13, 5, v13
    v_add_u32 v24, v14, v13
    v_sub_u32 v25, v14, v13
    s_cmp_eq_u32 s8, 0
    s_cbranch_scc1 gateup_kernel_wrs
    v_mov_b32 v13, v24
    v_mov_b32 v24, v25
    v_mov_b32 v25, v13
gateup_kernel_wrs:
    s_nop 1
    v_add_u32 v40, 8192, v24
    v_add_u32 v41, 8192, v25
    v_add_u32 v42, 45056, v24
    v_add_u32 v43, 45056, v25
    v_add_u32 v44, 81920, v24
    v_add_u32 v45, 81920, v25
    v_add_u32 v46, 118784, v24
    v_add_u32 v47, 118784, v25
    s_lshl_b32 s12, s6, 10
    s_mov_b32 s13, 0
    s_mov_b32 s14, 0
    s_add_u32 m0, s12, 0
    s_nop 0
    buffer_load_dwordx4 v4, s[40:43], s13 offen lds
    s_add_u32 m0, s75, 8192
    s_nop 0
    buffer_load_dwordx4 v32, s[44:47], s14 offen lds
    s_add_u32 m0, s75, 12288
    s_nop 0
    buffer_load_dwordx4 v33, s[44:47], s14 offen lds
    s_add_u32 m0, s75, 16384
    s_nop 0
    buffer_load_dwordx4 v34, s[44:47], s14 offen lds
    s_add_u32 m0, s79, 8192
    s_nop 0
    buffer_load_dwordx4 v35, s[44:47], s14 offen lds
    s_add_u32 s13, s13, 131072
    s_add_u32 s14, s14, 229376
    s_add_u32 m0, s12, 36864
    s_nop 0
    buffer_load_dwordx4 v4, s[40:43], s13 offen lds
    s_add_u32 m0, s75, 45056
    s_nop 0
    buffer_load_dwordx4 v32, s[44:47], s14 offen lds
    s_add_u32 m0, s75, 49152
    s_nop 0
    buffer_load_dwordx4 v33, s[44:47], s14 offen lds
    s_add_u32 m0, s75, 53248
    s_nop 0
    buffer_load_dwordx4 v34, s[44:47], s14 offen lds
    s_add_u32 m0, s79, 45056
    s_nop 0
    buffer_load_dwordx4 v35, s[44:47], s14 offen lds
    s_add_u32 s13, s13, 131072
    s_add_u32 s14, s14, 229376
    s_add_u32 m0, s12, 73728
    s_nop 0
    buffer_load_dwordx4 v4, s[40:43], s13 offen lds
    s_add_u32 m0, s75, 81920
    s_nop 0
    buffer_load_dwordx4 v32, s[44:47], s14 offen lds
    s_add_u32 m0, s75, 86016
    s_nop 0
    buffer_load_dwordx4 v33, s[44:47], s14 offen lds
    s_add_u32 m0, s75, 90112
    s_nop 0
    buffer_load_dwordx4 v34, s[44:47], s14 offen lds
    s_add_u32 m0, s79, 81920
    s_nop 0
    buffer_load_dwordx4 v35, s[44:47], s14 offen lds
    s_add_u32 s13, s13, 131072
    s_add_u32 s14, s14, 229376
    s_add_u32 m0, s12, 110592
    s_nop 0
    buffer_load_dwordx4 v4, s[40:43], s13 offen lds
    s_add_u32 m0, s75, 118784
    s_nop 0
    buffer_load_dwordx4 v32, s[44:47], s14 offen lds
    s_add_u32 m0, s75, 122880
    s_nop 0
    buffer_load_dwordx4 v33, s[44:47], s14 offen lds
    v_accvgpr_write_b32 a0, 0
    v_accvgpr_write_b32 a1, 0
    v_accvgpr_write_b32 a2, 0
    v_accvgpr_write_b32 a3, 0
    v_accvgpr_write_b32 a4, 0
    v_accvgpr_write_b32 a5, 0
    v_accvgpr_write_b32 a6, 0
    v_accvgpr_write_b32 a7, 0
    v_accvgpr_write_b32 a8, 0
    v_accvgpr_write_b32 a9, 0
    v_accvgpr_write_b32 a10, 0
    v_accvgpr_write_b32 a11, 0
    v_accvgpr_write_b32 a12, 0
    v_accvgpr_write_b32 a13, 0
    v_accvgpr_write_b32 a14, 0
    v_accvgpr_write_b32 a15, 0
    v_accvgpr_write_b32 a16, 0
    v_accvgpr_write_b32 a17, 0
    v_accvgpr_write_b32 a18, 0
    v_accvgpr_write_b32 a19, 0
    v_accvgpr_write_b32 a20, 0
    v_accvgpr_write_b32 a21, 0
    v_accvgpr_write_b32 a22, 0
    v_accvgpr_write_b32 a23, 0
    v_accvgpr_write_b32 a24, 0
    v_accvgpr_write_b32 a25, 0
    v_accvgpr_write_b32 a26, 0
    v_accvgpr_write_b32 a27, 0
    v_accvgpr_write_b32 a28, 0
    v_accvgpr_write_b32 a29, 0
    v_accvgpr_write_b32 a30, 0
    v_accvgpr_write_b32 a31, 0
    v_accvgpr_write_b32 a32, 0
    v_accvgpr_write_b32 a33, 0
    v_accvgpr_write_b32 a34, 0
    v_accvgpr_write_b32 a35, 0
    v_accvgpr_write_b32 a36, 0
    v_accvgpr_write_b32 a37, 0
    v_accvgpr_write_b32 a38, 0
    v_accvgpr_write_b32 a39, 0
    v_accvgpr_write_b32 a40, 0
    v_accvgpr_write_b32 a41, 0
    v_accvgpr_write_b32 a42, 0
    v_accvgpr_write_b32 a43, 0
    v_accvgpr_write_b32 a44, 0
    v_accvgpr_write_b32 a45, 0
    v_accvgpr_write_b32 a46, 0
    v_accvgpr_write_b32 a47, 0
    v_accvgpr_write_b32 a48, 0
    v_accvgpr_write_b32 a49, 0
    v_accvgpr_write_b32 a50, 0
    v_accvgpr_write_b32 a51, 0
    v_accvgpr_write_b32 a52, 0
    v_accvgpr_write_b32 a53, 0
    v_accvgpr_write_b32 a54, 0
    v_accvgpr_write_b32 a55, 0
    v_accvgpr_write_b32 a56, 0
    v_accvgpr_write_b32 a57, 0
    v_accvgpr_write_b32 a58, 0
    v_accvgpr_write_b32 a59, 0
    v_accvgpr_write_b32 a60, 0
    v_accvgpr_write_b32 a61, 0
    v_accvgpr_write_b32 a62, 0
    v_accvgpr_write_b32 a63, 0
    v_accvgpr_write_b32 a64, 0
    v_accvgpr_write_b32 a65, 0
    v_accvgpr_write_b32 a66, 0
    v_accvgpr_write_b32 a67, 0
    v_accvgpr_write_b32 a68, 0
    v_accvgpr_write_b32 a69, 0
    v_accvgpr_write_b32 a70, 0
    v_accvgpr_write_b32 a71, 0
    v_accvgpr_write_b32 a72, 0
    v_accvgpr_write_b32 a73, 0
    v_accvgpr_write_b32 a74, 0
    v_accvgpr_write_b32 a75, 0
    v_accvgpr_write_b32 a76, 0
    v_accvgpr_write_b32 a77, 0
    v_accvgpr_write_b32 a78, 0
    v_accvgpr_write_b32 a79, 0
    v_accvgpr_write_b32 a80, 0
    v_accvgpr_write_b32 a81, 0
    v_accvgpr_write_b32 a82, 0
    v_accvgpr_write_b32 a83, 0
    v_accvgpr_write_b32 a84, 0
    v_accvgpr_write_b32 a85, 0
    v_accvgpr_write_b32 a86, 0
    v_accvgpr_write_b32 a87, 0
    v_accvgpr_write_b32 a88, 0
    v_accvgpr_write_b32 a89, 0
    v_accvgpr_write_b32 a90, 0
    v_accvgpr_write_b32 a91, 0
    v_accvgpr_write_b32 a92, 0
    v_accvgpr_write_b32 a93, 0
    v_accvgpr_write_b32 a94, 0
    v_accvgpr_write_b32 a95, 0
    v_accvgpr_write_b32 a96, 0
    v_accvgpr_write_b32 a97, 0
    v_accvgpr_write_b32 a98, 0
    v_accvgpr_write_b32 a99, 0
    v_accvgpr_write_b32 a100, 0
    v_accvgpr_write_b32 a101, 0
    v_accvgpr_write_b32 a102, 0
    v_accvgpr_write_b32 a103, 0
    v_accvgpr_write_b32 a104, 0
    v_accvgpr_write_b32 a105, 0
    v_accvgpr_write_b32 a106, 0
    v_accvgpr_write_b32 a107, 0
    v_accvgpr_write_b32 a108, 0
    v_accvgpr_write_b32 a109, 0
    v_accvgpr_write_b32 a110, 0
    v_accvgpr_write_b32 a111, 0
    s_waitcnt vmcnt(13)
    s_barrier
    ds_read_b128 v[64:67], v16
    ds_read_b128 v[68:71], v16 offset:1024
    ds_read_b64_tr_b16 v[80:81], v40
    ds_read_b64_tr_b16 v[82:83], v40 offset:1792
    ds_read_b64_tr_b16 v[84:85], v41 offset:32
    ds_read_b64_tr_b16 v[86:87], v41 offset:1824
    ds_read_b64_tr_b16 v[88:89], v40 offset:64
    ds_read_b64_tr_b16 v[90:91], v40 offset:1856
    ds_read_b64_tr_b16 v[92:93], v41 offset:96
    ds_read_b64_tr_b16 v[94:95], v41 offset:1888
    ds_read_b64_tr_b16 v[96:97], v40 offset:128
    ds_read_b64_tr_b16 v[98:99], v40 offset:1920
    ds_read_b64_tr_b16 v[100:101], v41 offset:160
    ds_read_b64_tr_b16 v[102:103], v41 offset:1952
    ds_read_b64_tr_b16 v[104:105], v40 offset:192
    ds_read_b64_tr_b16 v[106:107], v40 offset:1984
    s_mov_b32 s15, 7
gateup_kernel_loop:
    s_waitcnt lgkmcnt(0)
    v_mfma_f32_16x16x32_bf16 a[0:3], v[80:83], v[64:67], a[0:3]
    ds_read_b64_tr_b16 v[108:109], v40 offset:14336
    v_mfma_f32_16x16x32_bf16 a[4:7], v[80:83], v[68:71], a[4:7]
    ds_read_b64_tr_b16 v[110:111], v40 offset:16128
    v_mfma_f32_16x16x32_bf16 a[8:11], v[84:87], v[64:67], a[8:11]
    ds_read_b64_tr_b16 v[112:113], v41 offset:14368
    v_mfma_f32_16x16x32_bf16 a[12:15], v[84:87], v[68:71], a[12:15]
    ds_read_b64_tr_b16 v[114:115], v41 offset:16160
    v_mfma_f32_16x16x32_bf16 a[16:19], v[88:91], v[64:67], a[16:19]
    ds_read_b64_tr_b16 v[116:117], v40 offset:14400
    v_mfma_f32_16x16x32_bf16 a[20:23], v[88:91], v[68:71], a[20:23]
    ds_read_b64_tr_b16 v[118:119], v40 offset:16192
    v_mfma_f32_16x16x32_bf16 a[24:27], v[92:95], v[64:67], a[24:27]
    ds_read_b64_tr_b16 v[120:121], v41 offset:14432
    v_mfma_f32_16x16x32_bf16 a[28:31], v[92:95], v[68:71], a[28:31]
    ds_read_b64_tr_b16 v[122:123], v41 offset:16224
    v_mfma_f32_16x16x32_bf16 a[32:35], v[96:99], v[64:67], a[32:35]
    ds_read_b64_tr_b16 v[124:125], v40 offset:14464
    v_mfma_f32_16x16x32_bf16 a[36:39], v[96:99], v[68:71], a[36:39]
    ds_read_b64_tr_b16 v[126:127], v40 offset:16256
    v_mfma_f32_16x16x32_bf16 a[40:43], v[100:103], v[64:67], a[40:43]
    ds_read_b64_tr_b16 v[128:129], v41 offset:14496
    v_mfma_f32_16x16x32_bf16 a[44:47], v[100:103], v[68:71], a[44:47]
    ds_read_b64_tr_b16 v[130:131], v41 offset:16288
    v_mfma_f32_16x16x32_bf16 a[48:51], v[104:107], v[64:67], a[48:51]
    ds_read_b64_tr_b16 v[132:133], v40 offset:14528
    v_mfma_f32_16x16x32_bf16 a[52:55], v[104:107], v[68:71], a[52:55]
    ds_read_b64_tr_b16 v[134:135], v40 offset:16320
    s_add_u32 m0, s75, 126976
    s_nop 0
    buffer_load_dwordx4 v34, s[44:47], s14 offen lds
    s_add_u32 m0, s79, 118784
    s_nop 0
    buffer_load_dwordx4 v35, s[44:47], s14 offen lds
    s_add_u32 s13, s13, 131072
    s_add_u32 s14, s14, 229376
    s_waitcnt lgkmcnt(0)
    s_waitcnt vmcnt(10)
    s_barrier
    v_mfma_f32_16x16x32_bf16 a[56:59], v[108:111], v[64:67], a[56:59]
    ds_read_b128 v[72:75], v18
    ds_read_b128 v[76:79], v18 offset:1024
    v_mfma_f32_16x16x32_bf16 a[60:63], v[108:111], v[68:71], a[60:63]
    ds_read_b64_tr_b16 v[80:81], v42
    ds_read_b64_tr_b16 v[82:83], v42 offset:1792
    v_mfma_f32_16x16x32_bf16 a[64:67], v[112:115], v[64:67], a[64:67]
    ds_read_b64_tr_b16 v[84:85], v43 offset:32
    ds_read_b64_tr_b16 v[86:87], v43 offset:1824
    v_mfma_f32_16x16x32_bf16 a[68:71], v[112:115], v[68:71], a[68:71]
    ds_read_b64_tr_b16 v[88:89], v42 offset:64
    ds_read_b64_tr_b16 v[90:91], v42 offset:1856
    v_mfma_f32_16x16x32_bf16 a[72:75], v[116:119], v[64:67], a[72:75]
    ds_read_b64_tr_b16 v[92:93], v43 offset:96
    ds_read_b64_tr_b16 v[94:95], v43 offset:1888
    v_mfma_f32_16x16x32_bf16 a[76:79], v[116:119], v[68:71], a[76:79]
    ds_read_b64_tr_b16 v[96:97], v42 offset:128
    ds_read_b64_tr_b16 v[98:99], v42 offset:1920
    v_mfma_f32_16x16x32_bf16 a[80:83], v[120:123], v[64:67], a[80:83]
    ds_read_b64_tr_b16 v[100:101], v43 offset:160
    ds_read_b64_tr_b16 v[102:103], v43 offset:1952
    v_mfma_f32_16x16x32_bf16 a[84:87], v[120:123], v[68:71], a[84:87]
    ds_read_b64_tr_b16 v[104:105], v42 offset:192
    ds_read_b64_tr_b16 v[106:107], v42 offset:1984
    s_add_u32 m0, s12, 0
    s_nop 0
    buffer_load_dwordx4 v4, s[40:43], s13 offen lds
    v_mfma_f32_16x16x32_bf16 a[88:91], v[124:127], v[64:67], a[88:91]
    s_add_u32 m0, s75, 8192
    s_nop 0
    buffer_load_dwordx4 v32, s[44:47], s14 offen lds
    v_mfma_f32_16x16x32_bf16 a[92:95], v[124:127], v[68:71], a[92:95]
    s_add_u32 m0, s75, 12288
    s_nop 0
    buffer_load_dwordx4 v33, s[44:47], s14 offen lds
    v_mfma_f32_16x16x32_bf16 a[96:99], v[128:131], v[64:67], a[96:99]
    v_mfma_f32_16x16x32_bf16 a[100:103], v[128:131], v[68:71], a[100:103]
    v_mfma_f32_16x16x32_bf16 a[104:107], v[132:135], v[64:67], a[104:107]
    v_mfma_f32_16x16x32_bf16 a[108:111], v[132:135], v[68:71], a[108:111]
    s_waitcnt lgkmcnt(0)
    v_mfma_f32_16x16x32_bf16 a[0:3], v[80:83], v[72:75], a[0:3]
    ds_read_b64_tr_b16 v[108:109], v42 offset:14336
    v_mfma_f32_16x16x32_bf16 a[4:7], v[80:83], v[76:79], a[4:7]
    ds_read_b64_tr_b16 v[110:111], v42 offset:16128
    v_mfma_f32_16x16x32_bf16 a[8:11], v[84:87], v[72:75], a[8:11]
    ds_read_b64_tr_b16 v[112:113], v43 offset:14368
    v_mfma_f32_16x16x32_bf16 a[12:15], v[84:87], v[76:79], a[12:15]
    ds_read_b64_tr_b16 v[114:115], v43 offset:16160
    v_mfma_f32_16x16x32_bf16 a[16:19], v[88:91], v[72:75], a[16:19]
    ds_read_b64_tr_b16 v[116:117], v42 offset:14400
    v_mfma_f32_16x16x32_bf16 a[20:23], v[88:91], v[76:79], a[20:23]
    ds_read_b64_tr_b16 v[118:119], v42 offset:16192
    v_mfma_f32_16x16x32_bf16 a[24:27], v[92:95], v[72:75], a[24:27]
    ds_read_b64_tr_b16 v[120:121], v43 offset:14432
    v_mfma_f32_16x16x32_bf16 a[28:31], v[92:95], v[76:79], a[28:31]
    ds_read_b64_tr_b16 v[122:123], v43 offset:16224
    v_mfma_f32_16x16x32_bf16 a[32:35], v[96:99], v[72:75], a[32:35]
    ds_read_b64_tr_b16 v[124:125], v42 offset:14464
    v_mfma_f32_16x16x32_bf16 a[36:39], v[96:99], v[76:79], a[36:39]
    ds_read_b64_tr_b16 v[126:127], v42 offset:16256
    v_mfma_f32_16x16x32_bf16 a[40:43], v[100:103], v[72:75], a[40:43]
    ds_read_b64_tr_b16 v[128:129], v43 offset:14496
    v_mfma_f32_16x16x32_bf16 a[44:47], v[100:103], v[76:79], a[44:47]
    ds_read_b64_tr_b16 v[130:131], v43 offset:16288
    v_mfma_f32_16x16x32_bf16 a[48:51], v[104:107], v[72:75], a[48:51]
    ds_read_b64_tr_b16 v[132:133], v42 offset:14528
    v_mfma_f32_16x16x32_bf16 a[52:55], v[104:107], v[76:79], a[52:55]
    ds_read_b64_tr_b16 v[134:135], v42 offset:16320
    s_add_u32 m0, s75, 16384
    s_nop 0
    buffer_load_dwordx4 v34, s[44:47], s14 offen lds
    s_add_u32 m0, s79, 8192
    s_nop 0
    buffer_load_dwordx4 v35, s[44:47], s14 offen lds
    s_add_u32 s13, s13, 131072
    s_add_u32 s14, s14, 229376
    s_waitcnt lgkmcnt(0)
    s_waitcnt vmcnt(10)
    s_barrier
    v_mfma_f32_16x16x32_bf16 a[56:59], v[108:111], v[72:75], a[56:59]
    ds_read_b128 v[64:67], v20
    ds_read_b128 v[68:71], v20 offset:1024
    v_mfma_f32_16x16x32_bf16 a[60:63], v[108:111], v[76:79], a[60:63]
    ds_read_b64_tr_b16 v[80:81], v44
    ds_read_b64_tr_b16 v[82:83], v44 offset:1792
    v_mfma_f32_16x16x32_bf16 a[64:67], v[112:115], v[72:75], a[64:67]
    ds_read_b64_tr_b16 v[84:85], v45 offset:32
    ds_read_b64_tr_b16 v[86:87], v45 offset:1824
    v_mfma_f32_16x16x32_bf16 a[68:71], v[112:115], v[76:79], a[68:71]
    ds_read_b64_tr_b16 v[88:89], v44 offset:64
    ds_read_b64_tr_b16 v[90:91], v44 offset:1856
    v_mfma_f32_16x16x32_bf16 a[72:75], v[116:119], v[72:75], a[72:75]
    ds_read_b64_tr_b16 v[92:93], v45 offset:96
    ds_read_b64_tr_b16 v[94:95], v45 offset:1888
    v_mfma_f32_16x16x32_bf16 a[76:79], v[116:119], v[76:79], a[76:79]
    ds_read_b64_tr_b16 v[96:97], v44 offset:128
    ds_read_b64_tr_b16 v[98:99], v44 offset:1920
    v_mfma_f32_16x16x32_bf16 a[80:83], v[120:123], v[72:75], a[80:83]
    ds_read_b64_tr_b16 v[100:101], v45 offset:160
    ds_read_b64_tr_b16 v[102:103], v45 offset:1952
    v_mfma_f32_16x16x32_bf16 a[84:87], v[120:123], v[76:79], a[84:87]
    ds_read_b64_tr_b16 v[104:105], v44 offset:192
    ds_read_b64_tr_b16 v[106:107], v44 offset:1984
    s_add_u32 m0, s12, 36864
    s_nop 0
    buffer_load_dwordx4 v4, s[40:43], s13 offen lds
    v_mfma_f32_16x16x32_bf16 a[88:91], v[124:127], v[72:75], a[88:91]
    s_add_u32 m0, s75, 45056
    s_nop 0
    buffer_load_dwordx4 v32, s[44:47], s14 offen lds
    v_mfma_f32_16x16x32_bf16 a[92:95], v[124:127], v[76:79], a[92:95]
    s_add_u32 m0, s75, 49152
    s_nop 0
    buffer_load_dwordx4 v33, s[44:47], s14 offen lds
    v_mfma_f32_16x16x32_bf16 a[96:99], v[128:131], v[72:75], a[96:99]
    v_mfma_f32_16x16x32_bf16 a[100:103], v[128:131], v[76:79], a[100:103]
    v_mfma_f32_16x16x32_bf16 a[104:107], v[132:135], v[72:75], a[104:107]
    v_mfma_f32_16x16x32_bf16 a[108:111], v[132:135], v[76:79], a[108:111]
    s_waitcnt lgkmcnt(0)
    v_mfma_f32_16x16x32_bf16 a[0:3], v[80:83], v[64:67], a[0:3]
    ds_read_b64_tr_b16 v[108:109], v44 offset:14336
    v_mfma_f32_16x16x32_bf16 a[4:7], v[80:83], v[68:71], a[4:7]
    ds_read_b64_tr_b16 v[110:111], v44 offset:16128
    v_mfma_f32_16x16x32_bf16 a[8:11], v[84:87], v[64:67], a[8:11]
    ds_read_b64_tr_b16 v[112:113], v45 offset:14368
    v_mfma_f32_16x16x32_bf16 a[12:15], v[84:87], v[68:71], a[12:15]
    ds_read_b64_tr_b16 v[114:115], v45 offset:16160
    v_mfma_f32_16x16x32_bf16 a[16:19], v[88:91], v[64:67], a[16:19]
    ds_read_b64_tr_b16 v[116:117], v44 offset:14400
    v_mfma_f32_16x16x32_bf16 a[20:23], v[88:91], v[68:71], a[20:23]
    ds_read_b64_tr_b16 v[118:119], v44 offset:16192
    v_mfma_f32_16x16x32_bf16 a[24:27], v[92:95], v[64:67], a[24:27]
    ds_read_b64_tr_b16 v[120:121], v45 offset:14432
    v_mfma_f32_16x16x32_bf16 a[28:31], v[92:95], v[68:71], a[28:31]
    ds_read_b64_tr_b16 v[122:123], v45 offset:16224
    v_mfma_f32_16x16x32_bf16 a[32:35], v[96:99], v[64:67], a[32:35]
    ds_read_b64_tr_b16 v[124:125], v44 offset:14464
    v_mfma_f32_16x16x32_bf16 a[36:39], v[96:99], v[68:71], a[36:39]
    ds_read_b64_tr_b16 v[126:127], v44 offset:16256
    v_mfma_f32_16x16x32_bf16 a[40:43], v[100:103], v[64:67], a[40:43]
    ds_read_b64_tr_b16 v[128:129], v45 offset:14496
    v_mfma_f32_16x16x32_bf16 a[44:47], v[100:103], v[68:71], a[44:47]
    ds_read_b64_tr_b16 v[130:131], v45 offset:16288
    v_mfma_f32_16x16x32_bf16 a[48:51], v[104:107], v[64:67], a[48:51]
    ds_read_b64_tr_b16 v[132:133], v44 offset:14528
    v_mfma_f32_16x16x32_bf16 a[52:55], v[104:107], v[68:71], a[52:55]
    ds_read_b64_tr_b16 v[134:135], v44 offset:16320
    s_add_u32 m0, s75, 53248
    s_nop 0
    buffer_load_dwordx4 v34, s[44:47], s14 offen lds
    s_add_u32 m0, s79, 45056
    s_nop 0
    buffer_load_dwordx4 v35, s[44:47], s14 offen lds
    s_add_u32 s13, s13, 131072
    s_add_u32 s14, s14, 229376
    s_waitcnt lgkmcnt(0)
    s_waitcnt vmcnt(10)
    s_barrier
    v_mfma_f32_16x16x32_bf16 a[56:59], v[108:111], v[64:67], a[56:59]
    ds_read_b128 v[72:75], v22
    ds_read_b128 v[76:79], v22 offset:1024
    v_mfma_f32_16x16x32_bf16 a[60:63], v[108:111], v[68:71], a[60:63]
    ds_read_b64_tr_b16 v[80:81], v46
    ds_read_b64_tr_b16 v[82:83], v46 offset:1792
    v_mfma_f32_16x16x32_bf16 a[64:67], v[112:115], v[64:67], a[64:67]
    ds_read_b64_tr_b16 v[84:85], v47 offset:32
    ds_read_b64_tr_b16 v[86:87], v47 offset:1824
    v_mfma_f32_16x16x32_bf16 a[68:71], v[112:115], v[68:71], a[68:71]
    ds_read_b64_tr_b16 v[88:89], v46 offset:64
    ds_read_b64_tr_b16 v[90:91], v46 offset:1856
    v_mfma_f32_16x16x32_bf16 a[72:75], v[116:119], v[64:67], a[72:75]
    ds_read_b64_tr_b16 v[92:93], v47 offset:96
    ds_read_b64_tr_b16 v[94:95], v47 offset:1888
    v_mfma_f32_16x16x32_bf16 a[76:79], v[116:119], v[68:71], a[76:79]
    ds_read_b64_tr_b16 v[96:97], v46 offset:128
    ds_read_b64_tr_b16 v[98:99], v46 offset:1920
    v_mfma_f32_16x16x32_bf16 a[80:83], v[120:123], v[64:67], a[80:83]
    ds_read_b64_tr_b16 v[100:101], v47 offset:160
    ds_read_b64_tr_b16 v[102:103], v47 offset:1952
    v_mfma_f32_16x16x32_bf16 a[84:87], v[120:123], v[68:71], a[84:87]
    ds_read_b64_tr_b16 v[104:105], v46 offset:192
    ds_read_b64_tr_b16 v[106:107], v46 offset:1984
    s_add_u32 m0, s12, 73728
    s_nop 0
    buffer_load_dwordx4 v4, s[40:43], s13 offen lds
    v_mfma_f32_16x16x32_bf16 a[88:91], v[124:127], v[64:67], a[88:91]
    s_add_u32 m0, s75, 81920
    s_nop 0
    buffer_load_dwordx4 v32, s[44:47], s14 offen lds
    v_mfma_f32_16x16x32_bf16 a[92:95], v[124:127], v[68:71], a[92:95]
    s_add_u32 m0, s75, 86016
    s_nop 0
    buffer_load_dwordx4 v33, s[44:47], s14 offen lds
    v_mfma_f32_16x16x32_bf16 a[96:99], v[128:131], v[64:67], a[96:99]
    v_mfma_f32_16x16x32_bf16 a[100:103], v[128:131], v[68:71], a[100:103]
    v_mfma_f32_16x16x32_bf16 a[104:107], v[132:135], v[64:67], a[104:107]
    v_mfma_f32_16x16x32_bf16 a[108:111], v[132:135], v[68:71], a[108:111]
    s_waitcnt lgkmcnt(0)
    v_mfma_f32_16x16x32_bf16 a[0:3], v[80:83], v[72:75], a[0:3]
    ds_read_b64_tr_b16 v[108:109], v46 offset:14336
    v_mfma_f32_16x16x32_bf16 a[4:7], v[80:83], v[76:79], a[4:7]
    ds_read_b64_tr_b16 v[110:111], v46 offset:16128
    v_mfma_f32_16x16x32_bf16 a[8:11], v[84:87], v[72:75], a[8:11]
    ds_read_b64_tr_b16 v[112:113], v47 offset:14368
    v_mfma_f32_16x16x32_bf16 a[12:15], v[84:87], v[76:79], a[12:15]
    ds_read_b64_tr_b16 v[114:115], v47 offset:16160
    v_mfma_f32_16x16x32_bf16 a[16:19], v[88:91], v[72:75], a[16:19]
    ds_read_b64_tr_b16 v[116:117], v46 offset:14400
    v_mfma_f32_16x16x32_bf16 a[20:23], v[88:91], v[76:79], a[20:23]
    ds_read_b64_tr_b16 v[118:119], v46 offset:16192
    v_mfma_f32_16x16x32_bf16 a[24:27], v[92:95], v[72:75], a[24:27]
    ds_read_b64_tr_b16 v[120:121], v47 offset:14432
    v_mfma_f32_16x16x32_bf16 a[28:31], v[92:95], v[76:79], a[28:31]
    ds_read_b64_tr_b16 v[122:123], v47 offset:16224
    v_mfma_f32_16x16x32_bf16 a[32:35], v[96:99], v[72:75], a[32:35]
    ds_read_b64_tr_b16 v[124:125], v46 offset:14464
    v_mfma_f32_16x16x32_bf16 a[36:39], v[96:99], v[76:79], a[36:39]
    ds_read_b64_tr_b16 v[126:127], v46 offset:16256
    v_mfma_f32_16x16x32_bf16 a[40:43], v[100:103], v[72:75], a[40:43]
    ds_read_b64_tr_b16 v[128:129], v47 offset:14496
    v_mfma_f32_16x16x32_bf16 a[44:47], v[100:103], v[76:79], a[44:47]
    ds_read_b64_tr_b16 v[130:131], v47 offset:16288
    v_mfma_f32_16x16x32_bf16 a[48:51], v[104:107], v[72:75], a[48:51]
    ds_read_b64_tr_b16 v[132:133], v46 offset:14528
    v_mfma_f32_16x16x32_bf16 a[52:55], v[104:107], v[76:79], a[52:55]
    ds_read_b64_tr_b16 v[134:135], v46 offset:16320
    s_add_u32 m0, s75, 90112
    s_nop 0
    buffer_load_dwordx4 v34, s[44:47], s14 offen lds
    s_add_u32 m0, s79, 81920
    s_nop 0
    buffer_load_dwordx4 v35, s[44:47], s14 offen lds
    s_add_u32 s13, s13, 131072
    s_add_u32 s14, s14, 229376
    s_waitcnt lgkmcnt(0)
    s_waitcnt vmcnt(10)
    s_barrier
    v_mfma_f32_16x16x32_bf16 a[56:59], v[108:111], v[72:75], a[56:59]
    ds_read_b128 v[64:67], v16
    ds_read_b128 v[68:71], v16 offset:1024
    v_mfma_f32_16x16x32_bf16 a[60:63], v[108:111], v[76:79], a[60:63]
    ds_read_b64_tr_b16 v[80:81], v40
    ds_read_b64_tr_b16 v[82:83], v40 offset:1792
    v_mfma_f32_16x16x32_bf16 a[64:67], v[112:115], v[72:75], a[64:67]
    ds_read_b64_tr_b16 v[84:85], v41 offset:32
    ds_read_b64_tr_b16 v[86:87], v41 offset:1824
    v_mfma_f32_16x16x32_bf16 a[68:71], v[112:115], v[76:79], a[68:71]
    ds_read_b64_tr_b16 v[88:89], v40 offset:64
    ds_read_b64_tr_b16 v[90:91], v40 offset:1856
    v_mfma_f32_16x16x32_bf16 a[72:75], v[116:119], v[72:75], a[72:75]
    ds_read_b64_tr_b16 v[92:93], v41 offset:96
    ds_read_b64_tr_b16 v[94:95], v41 offset:1888
    v_mfma_f32_16x16x32_bf16 a[76:79], v[116:119], v[76:79], a[76:79]
    ds_read_b64_tr_b16 v[96:97], v40 offset:128
    ds_read_b64_tr_b16 v[98:99], v40 offset:1920
    v_mfma_f32_16x16x32_bf16 a[80:83], v[120:123], v[72:75], a[80:83]
    ds_read_b64_tr_b16 v[100:101], v41 offset:160
    ds_read_b64_tr_b16 v[102:103], v41 offset:1952
    v_mfma_f32_16x16x32_bf16 a[84:87], v[120:123], v[76:79], a[84:87]
    ds_read_b64_tr_b16 v[104:105], v40 offset:192
    ds_read_b64_tr_b16 v[106:107], v40 offset:1984
    s_add_u32 m0, s12, 110592
    s_nop 0
    buffer_load_dwordx4 v4, s[40:43], s13 offen lds
    v_mfma_f32_16x16x32_bf16 a[88:91], v[124:127], v[72:75], a[88:91]
    s_add_u32 m0, s75, 118784
    s_nop 0
    buffer_load_dwordx4 v32, s[44:47], s14 offen lds
    v_mfma_f32_16x16x32_bf16 a[92:95], v[124:127], v[76:79], a[92:95]
    s_add_u32 m0, s75, 122880
    s_nop 0
    buffer_load_dwordx4 v33, s[44:47], s14 offen lds
    v_mfma_f32_16x16x32_bf16 a[96:99], v[128:131], v[72:75], a[96:99]
    v_mfma_f32_16x16x32_bf16 a[100:103], v[128:131], v[76:79], a[100:103]
    v_mfma_f32_16x16x32_bf16 a[104:107], v[132:135], v[72:75], a[104:107]
    v_mfma_f32_16x16x32_bf16 a[108:111], v[132:135], v[76:79], a[108:111]
    s_sub_u32 s15, s15, 1
    s_cmp_lg_u32 s15, 0
    s_cbranch_scc1 gateup_kernel_loop
    s_waitcnt lgkmcnt(0)
    v_mfma_f32_16x16x32_bf16 a[0:3], v[80:83], v[64:67], a[0:3]
    ds_read_b64_tr_b16 v[108:109], v40 offset:14336
    v_mfma_f32_16x16x32_bf16 a[4:7], v[80:83], v[68:71], a[4:7]
    ds_read_b64_tr_b16 v[110:111], v40 offset:16128
    v_mfma_f32_16x16x32_bf16 a[8:11], v[84:87], v[64:67], a[8:11]
    ds_read_b64_tr_b16 v[112:113], v41 offset:14368
    v_mfma_f32_16x16x32_bf16 a[12:15], v[84:87], v[68:71], a[12:15]
    ds_read_b64_tr_b16 v[114:115], v41 offset:16160
    v_mfma_f32_16x16x32_bf16 a[16:19], v[88:91], v[64:67], a[16:19]
    ds_read_b64_tr_b16 v[116:117], v40 offset:14400
    v_mfma_f32_16x16x32_bf16 a[20:23], v[88:91], v[68:71], a[20:23]
    ds_read_b64_tr_b16 v[118:119], v40 offset:16192
    v_mfma_f32_16x16x32_bf16 a[24:27], v[92:95], v[64:67], a[24:27]
    ds_read_b64_tr_b16 v[120:121], v41 offset:14432
    v_mfma_f32_16x16x32_bf16 a[28:31], v[92:95], v[68:71], a[28:31]
    ds_read_b64_tr_b16 v[122:123], v41 offset:16224
    v_mfma_f32_16x16x32_bf16 a[32:35], v[96:99], v[64:67], a[32:35]
    ds_read_b64_tr_b16 v[124:125], v40 offset:14464
    v_mfma_f32_16x16x32_bf16 a[36:39], v[96:99], v[68:71], a[36:39]
    ds_read_b64_tr_b16 v[126:127], v40 offset:16256
    v_mfma_f32_16x16x32_bf16 a[40:43], v[100:103], v[64:67], a[40:43]
    ds_read_b64_tr_b16 v[128:129], v41 offset:14496
    v_mfma_f32_16x16x32_bf16 a[44:47], v[100:103], v[68:71], a[44:47]
    ds_read_b64_tr_b16 v[130:131], v41 offset:16288
    v_mfma_f32_16x16x32_bf16 a[48:51], v[104:107], v[64:67], a[48:51]
    ds_read_b64_tr_b16 v[132:133], v40 offset:14528
    v_mfma_f32_16x16x32_bf16 a[52:55], v[104:107], v[68:71], a[52:55]
    ds_read_b64_tr_b16 v[134:135], v40 offset:16320
    s_add_u32 m0, s75, 126976
    s_nop 0
    buffer_load_dwordx4 v34, s[44:47], s14 offen lds
    s_add_u32 m0, s79, 118784
    s_nop 0
    buffer_load_dwordx4 v35, s[44:47], s14 offen lds
    s_add_u32 s13, s13, 131072
    s_add_u32 s14, s14, 229376
    s_waitcnt lgkmcnt(0)
    s_waitcnt vmcnt(10)
    s_barrier
    v_mfma_f32_16x16x32_bf16 a[56:59], v[108:111], v[64:67], a[56:59]
    ds_read_b128 v[72:75], v18
    ds_read_b128 v[76:79], v18 offset:1024
    v_mfma_f32_16x16x32_bf16 a[60:63], v[108:111], v[68:71], a[60:63]
    ds_read_b64_tr_b16 v[80:81], v42
    ds_read_b64_tr_b16 v[82:83], v42 offset:1792
    v_mfma_f32_16x16x32_bf16 a[64:67], v[112:115], v[64:67], a[64:67]
    ds_read_b64_tr_b16 v[84:85], v43 offset:32
    ds_read_b64_tr_b16 v[86:87], v43 offset:1824
    v_mfma_f32_16x16x32_bf16 a[68:71], v[112:115], v[68:71], a[68:71]
    ds_read_b64_tr_b16 v[88:89], v42 offset:64
    ds_read_b64_tr_b16 v[90:91], v42 offset:1856
    v_mfma_f32_16x16x32_bf16 a[72:75], v[116:119], v[64:67], a[72:75]
    ds_read_b64_tr_b16 v[92:93], v43 offset:96
    ds_read_b64_tr_b16 v[94:95], v43 offset:1888
    v_mfma_f32_16x16x32_bf16 a[76:79], v[116:119], v[68:71], a[76:79]
    ds_read_b64_tr_b16 v[96:97], v42 offset:128
    ds_read_b64_tr_b16 v[98:99], v42 offset:1920
    v_mfma_f32_16x16x32_bf16 a[80:83], v[120:123], v[64:67], a[80:83]
    ds_read_b64_tr_b16 v[100:101], v43 offset:160
    ds_read_b64_tr_b16 v[102:103], v43 offset:1952
    v_mfma_f32_16x16x32_bf16 a[84:87], v[120:123], v[68:71], a[84:87]
    ds_read_b64_tr_b16 v[104:105], v42 offset:192
    ds_read_b64_tr_b16 v[106:107], v42 offset:1984
    v_mfma_f32_16x16x32_bf16 a[88:91], v[124:127], v[64:67], a[88:91]
    v_mfma_f32_16x16x32_bf16 a[92:95], v[124:127], v[68:71], a[92:95]
    v_mfma_f32_16x16x32_bf16 a[96:99], v[128:131], v[64:67], a[96:99]
    v_mfma_f32_16x16x32_bf16 a[100:103], v[128:131], v[68:71], a[100:103]
    v_mfma_f32_16x16x32_bf16 a[104:107], v[132:135], v[64:67], a[104:107]
    v_mfma_f32_16x16x32_bf16 a[108:111], v[132:135], v[68:71], a[108:111]
    s_waitcnt lgkmcnt(0)
    v_mfma_f32_16x16x32_bf16 a[0:3], v[80:83], v[72:75], a[0:3]
    ds_read_b64_tr_b16 v[108:109], v42 offset:14336
    v_mfma_f32_16x16x32_bf16 a[4:7], v[80:83], v[76:79], a[4:7]
    ds_read_b64_tr_b16 v[110:111], v42 offset:16128
    v_mfma_f32_16x16x32_bf16 a[8:11], v[84:87], v[72:75], a[8:11]
    ds_read_b64_tr_b16 v[112:113], v43 offset:14368
    v_mfma_f32_16x16x32_bf16 a[12:15], v[84:87], v[76:79], a[12:15]
    ds_read_b64_tr_b16 v[114:115], v43 offset:16160
    v_mfma_f32_16x16x32_bf16 a[16:19], v[88:91], v[72:75], a[16:19]
    ds_read_b64_tr_b16 v[116:117], v42 offset:14400
    v_mfma_f32_16x16x32_bf16 a[20:23], v[88:91], v[76:79], a[20:23]
    ds_read_b64_tr_b16 v[118:119], v42 offset:16192
    v_mfma_f32_16x16x32_bf16 a[24:27], v[92:95], v[72:75], a[24:27]
    ds_read_b64_tr_b16 v[120:121], v43 offset:14432
    v_mfma_f32_16x16x32_bf16 a[28:31], v[92:95], v[76:79], a[28:31]
    ds_read_b64_tr_b16 v[122:123], v43 offset:16224
    v_mfma_f32_16x16x32_bf16 a[32:35], v[96:99], v[72:75], a[32:35]
    ds_read_b64_tr_b16 v[124:125], v42 offset:14464
    v_mfma_f32_16x16x32_bf16 a[36:39], v[96:99], v[76:79], a[36:39]
    ds_read_b64_tr_b16 v[126:127], v42 offset:16256
    v_mfma_f32_16x16x32_bf16 a[40:43], v[100:103], v[72:75], a[40:43]
    ds_read_b64_tr_b16 v[128:129], v43 offset:14496
    v_mfma_f32_16x16x32_bf16 a[44:47], v[100:103], v[76:79], a[44:47]
    ds_read_b64_tr_b16 v[130:131], v43 offset:16288
    v_mfma_f32_16x16x32_bf16 a[48:51], v[104:107], v[72:75], a[48:51]
    ds_read_b64_tr_b16 v[132:133], v42 offset:14528
    v_mfma_f32_16x16x32_bf16 a[52:55], v[104:107], v[76:79], a[52:55]
    ds_read_b64_tr_b16 v[134:135], v42 offset:16320
    s_waitcnt lgkmcnt(0)
    s_waitcnt vmcnt(5)
    s_barrier
    v_mfma_f32_16x16x32_bf16 a[56:59], v[108:111], v[72:75], a[56:59]
    ds_read_b128 v[64:67], v20
    ds_read_b128 v[68:71], v20 offset:1024
    v_mfma_f32_16x16x32_bf16 a[60:63], v[108:111], v[76:79], a[60:63]
    ds_read_b64_tr_b16 v[80:81], v44
    ds_read_b64_tr_b16 v[82:83], v44 offset:1792
    v_mfma_f32_16x16x32_bf16 a[64:67], v[112:115], v[72:75], a[64:67]
    ds_read_b64_tr_b16 v[84:85], v45 offset:32
    ds_read_b64_tr_b16 v[86:87], v45 offset:1824
    v_mfma_f32_16x16x32_bf16 a[68:71], v[112:115], v[76:79], a[68:71]
    ds_read_b64_tr_b16 v[88:89], v44 offset:64
    ds_read_b64_tr_b16 v[90:91], v44 offset:1856
    v_mfma_f32_16x16x32_bf16 a[72:75], v[116:119], v[72:75], a[72:75]
    ds_read_b64_tr_b16 v[92:93], v45 offset:96
    ds_read_b64_tr_b16 v[94:95], v45 offset:1888
    v_mfma_f32_16x16x32_bf16 a[76:79], v[116:119], v[76:79], a[76:79]
    ds_read_b64_tr_b16 v[96:97], v44 offset:128
    ds_read_b64_tr_b16 v[98:99], v44 offset:1920
    v_mfma_f32_16x16x32_bf16 a[80:83], v[120:123], v[72:75], a[80:83]
    ds_read_b64_tr_b16 v[100:101], v45 offset:160
    ds_read_b64_tr_b16 v[102:103], v45 offset:1952
    v_mfma_f32_16x16x32_bf16 a[84:87], v[120:123], v[76:79], a[84:87]
    ds_read_b64_tr_b16 v[104:105], v44 offset:192
    ds_read_b64_tr_b16 v[106:107], v44 offset:1984
    v_mfma_f32_16x16x32_bf16 a[88:91], v[124:127], v[72:75], a[88:91]
    v_mfma_f32_16x16x32_bf16 a[92:95], v[124:127], v[76:79], a[92:95]
    v_mfma_f32_16x16x32_bf16 a[96:99], v[128:131], v[72:75], a[96:99]
    v_mfma_f32_16x16x32_bf16 a[100:103], v[128:131], v[76:79], a[100:103]
    v_mfma_f32_16x16x32_bf16 a[104:107], v[132:135], v[72:75], a[104:107]
    v_mfma_f32_16x16x32_bf16 a[108:111], v[132:135], v[76:79], a[108:111]
    s_waitcnt lgkmcnt(0)
    v_mfma_f32_16x16x32_bf16 a[0:3], v[80:83], v[64:67], a[0:3]
    ds_read_b64_tr_b16 v[108:109], v44 offset:14336
    v_mfma_f32_16x16x32_bf16 a[4:7], v[80:83], v[68:71], a[4:7]
    ds_read_b64_tr_b16 v[110:111], v44 offset:16128
    v_mfma_f32_16x16x32_bf16 a[8:11], v[84:87], v[64:67], a[8:11]
    ds_read_b64_tr_b16 v[112:113], v45 offset:14368
    v_mfma_f32_16x16x32_bf16 a[12:15], v[84:87], v[68:71], a[12:15]
    ds_read_b64_tr_b16 v[114:115], v45 offset:16160
    v_mfma_f32_16x16x32_bf16 a[16:19], v[88:91], v[64:67], a[16:19]
    ds_read_b64_tr_b16 v[116:117], v44 offset:14400
    v_mfma_f32_16x16x32_bf16 a[20:23], v[88:91], v[68:71], a[20:23]
    ds_read_b64_tr_b16 v[118:119], v44 offset:16192
    v_mfma_f32_16x16x32_bf16 a[24:27], v[92:95], v[64:67], a[24:27]
    ds_read_b64_tr_b16 v[120:121], v45 offset:14432
    v_mfma_f32_16x16x32_bf16 a[28:31], v[92:95], v[68:71], a[28:31]
    ds_read_b64_tr_b16 v[122:123], v45 offset:16224
    v_mfma_f32_16x16x32_bf16 a[32:35], v[96:99], v[64:67], a[32:35]
    ds_read_b64_tr_b16 v[124:125], v44 offset:14464
    v_mfma_f32_16x16x32_bf16 a[36:39], v[96:99], v[68:71], a[36:39]
    ds_read_b64_tr_b16 v[126:127], v44 offset:16256
    v_mfma_f32_16x16x32_bf16 a[40:43], v[100:103], v[64:67], a[40:43]
    ds_read_b64_tr_b16 v[128:129], v45 offset:14496
    v_mfma_f32_16x16x32_bf16 a[44:47], v[100:103], v[68:71], a[44:47]
    ds_read_b64_tr_b16 v[130:131], v45 offset:16288
    v_mfma_f32_16x16x32_bf16 a[48:51], v[104:107], v[64:67], a[48:51]
    ds_read_b64_tr_b16 v[132:133], v44 offset:14528
    v_mfma_f32_16x16x32_bf16 a[52:55], v[104:107], v[68:71], a[52:55]
    ds_read_b64_tr_b16 v[134:135], v44 offset:16320
    s_waitcnt lgkmcnt(0)
    s_waitcnt vmcnt(0)
    s_barrier
    v_mfma_f32_16x16x32_bf16 a[56:59], v[108:111], v[64:67], a[56:59]
    ds_read_b128 v[72:75], v22
    ds_read_b128 v[76:79], v22 offset:1024
    v_mfma_f32_16x16x32_bf16 a[60:63], v[108:111], v[68:71], a[60:63]
    ds_read_b64_tr_b16 v[80:81], v46
    ds_read_b64_tr_b16 v[82:83], v46 offset:1792
    v_mfma_f32_16x16x32_bf16 a[64:67], v[112:115], v[64:67], a[64:67]
    ds_read_b64_tr_b16 v[84:85], v47 offset:32
    ds_read_b64_tr_b16 v[86:87], v47 offset:1824
    v_mfma_f32_16x16x32_bf16 a[68:71], v[112:115], v[68:71], a[68:71]
    ds_read_b64_tr_b16 v[88:89], v46 offset:64
    ds_read_b64_tr_b16 v[90:91], v46 offset:1856
    v_mfma_f32_16x16x32_bf16 a[72:75], v[116:119], v[64:67], a[72:75]
    ds_read_b64_tr_b16 v[92:93], v47 offset:96
    ds_read_b64_tr_b16 v[94:95], v47 offset:1888
    v_mfma_f32_16x16x32_bf16 a[76:79], v[116:119], v[68:71], a[76:79]
    ds_read_b64_tr_b16 v[96:97], v46 offset:128
    ds_read_b64_tr_b16 v[98:99], v46 offset:1920
    v_mfma_f32_16x16x32_bf16 a[80:83], v[120:123], v[64:67], a[80:83]
    ds_read_b64_tr_b16 v[100:101], v47 offset:160
    ds_read_b64_tr_b16 v[102:103], v47 offset:1952
    v_mfma_f32_16x16x32_bf16 a[84:87], v[120:123], v[68:71], a[84:87]
    ds_read_b64_tr_b16 v[104:105], v46 offset:192
    ds_read_b64_tr_b16 v[106:107], v46 offset:1984
    v_mfma_f32_16x16x32_bf16 a[88:91], v[124:127], v[64:67], a[88:91]
    v_mfma_f32_16x16x32_bf16 a[92:95], v[124:127], v[68:71], a[92:95]
    v_mfma_f32_16x16x32_bf16 a[96:99], v[128:131], v[64:67], a[96:99]
    v_mfma_f32_16x16x32_bf16 a[100:103], v[128:131], v[68:71], a[100:103]
    v_mfma_f32_16x16x32_bf16 a[104:107], v[132:135], v[64:67], a[104:107]
    v_mfma_f32_16x16x32_bf16 a[108:111], v[132:135], v[68:71], a[108:111]
    s_waitcnt lgkmcnt(0)
    v_mfma_f32_16x16x32_bf16 a[0:3], v[80:83], v[72:75], a[0:3]
    ds_read_b64_tr_b16 v[108:109], v46 offset:14336
    v_mfma_f32_16x16x32_bf16 a[4:7], v[80:83], v[76:79], a[4:7]
    ds_read_b64_tr_b16 v[110:111], v46 offset:16128
    v_mfma_f32_16x16x32_bf16 a[8:11], v[84:87], v[72:75], a[8:11]
    ds_read_b64_tr_b16 v[112:113], v47 offset:14368
    v_mfma_f32_16x16x32_bf16 a[12:15], v[84:87], v[76:79], a[12:15]
    ds_read_b64_tr_b16 v[114:115], v47 offset:16160
    v_mfma_f32_16x16x32_bf16 a[16:19], v[88:91], v[72:75], a[16:19]
    ds_read_b64_tr_b16 v[116:117], v46 offset:14400
    v_mfma_f32_16x16x32_bf16 a[20:23], v[88:91], v[76:79], a[20:23]
    ds_read_b64_tr_b16 v[118:119], v46 offset:16192
    v_mfma_f32_16x16x32_bf16 a[24:27], v[92:95], v[72:75], a[24:27]
    ds_read_b64_tr_b16 v[120:121], v47 offset:14432
    v_mfma_f32_16x16x32_bf16 a[28:31], v[92:95], v[76:79], a[28:31]
    ds_read_b64_tr_b16 v[122:123], v47 offset:16224
    v_mfma_f32_16x16x32_bf16 a[32:35], v[96:99], v[72:75], a[32:35]
    ds_read_b64_tr_b16 v[124:125], v46 offset:14464
    v_mfma_f32_16x16x32_bf16 a[36:39], v[96:99], v[76:79], a[36:39]
    ds_read_b64_tr_b16 v[126:127], v46 offset:16256
    v_mfma_f32_16x16x32_bf16 a[40:43], v[100:103], v[72:75], a[40:43]
    ds_read_b64_tr_b16 v[128:129], v47 offset:14496
    v_mfma_f32_16x16x32_bf16 a[44:47], v[100:103], v[76:79], a[44:47]
    ds_read_b64_tr_b16 v[130:131], v47 offset:16288
    v_mfma_f32_16x16x32_bf16 a[48:51], v[104:107], v[72:75], a[48:51]
    ds_read_b64_tr_b16 v[132:133], v46 offset:14528
    v_mfma_f32_16x16x32_bf16 a[52:55], v[104:107], v[76:79], a[52:55]
    ds_read_b64_tr_b16 v[134:135], v46 offset:16320
    s_waitcnt lgkmcnt(0)
    v_mfma_f32_16x16x32_bf16 a[56:59], v[108:111], v[72:75], a[56:59]
    v_mfma_f32_16x16x32_bf16 a[60:63], v[108:111], v[76:79], a[60:63]
    v_mfma_f32_16x16x32_bf16 a[64:67], v[112:115], v[72:75], a[64:67]
    v_mfma_f32_16x16x32_bf16 a[68:71], v[112:115], v[76:79], a[68:71]
    v_mfma_f32_16x16x32_bf16 a[72:75], v[116:119], v[72:75], a[72:75]
    v_mfma_f32_16x16x32_bf16 a[76:79], v[116:119], v[76:79], a[76:79]
    v_mfma_f32_16x16x32_bf16 a[80:83], v[120:123], v[72:75], a[80:83]
    v_mfma_f32_16x16x32_bf16 a[84:87], v[120:123], v[76:79], a[84:87]
    v_mfma_f32_16x16x32_bf16 a[88:91], v[124:127], v[72:75], a[88:91]
    v_mfma_f32_16x16x32_bf16 a[92:95], v[124:127], v[76:79], a[92:95]
    v_mfma_f32_16x16x32_bf16 a[96:99], v[128:131], v[72:75], a[96:99]
    v_mfma_f32_16x16x32_bf16 a[100:103], v[128:131], v[76:79], a[100:103]
    v_mfma_f32_16x16x32_bf16 a[104:107], v[132:135], v[72:75], a[104:107]
    v_mfma_f32_16x16x32_bf16 a[108:111], v[132:135], v[76:79], a[108:111]
    s_nop 11
    v_and_b32 v10, 15, v2
    v_lshrrev_b32 v11, 4, v2
    v_and_b32 v12, 1, v11
    v_lshlrev_b32 v12, 5, v12
    v_lshrrev_b32 v13, 1, v11
    v_lshl_add_u32 v12, v13, 4, v12
    s_mul_i32 s9, s4, 224
    s_mul_i32 s10, s8, 112
    s_add_u32 s9, s9, s10
    s_lshl_b32 s10, s3, 7
    s_lshl_b32 s11, s7, 5
    s_add_u32 s10, s10, s11
    s_add_u32 s60, s38, 33554432
    s_addc_u32 s61, s39, 0
    s_and_b32 s61, s61, 0xffff
    s_mov_b32 s62, 14680064
    s_mov_b32 s63, 0x00020000
    v_add_u32 v14, s10, v10
    s_mov_b32 s11, 7168
    v_mul_lo_u32 v14, v14, s11
    s_lshl_b32 s11, s9, 1
    v_add_u32 v14, s11, v14
    v_lshl_add_u32 v15, v11, 3, v14
    v_add_u32 v16, v14, v12
    s_mov_b32 s12, 0
    v_accvgpr_read_b32 v32, a0
    v_accvgpr_read_b32 v33, a1
    v_accvgpr_read_b32 v34, a2
    v_accvgpr_read_b32 v35, a3
    v_accvgpr_read_b32 v44, a56
    v_accvgpr_read_b32 v45, a57
    v_accvgpr_read_b32 v46, a58
    v_accvgpr_read_b32 v47, a59
    v_accvgpr_read_b32 v36, a8
    v_accvgpr_read_b32 v37, a9
    v_accvgpr_read_b32 v38, a10
    v_accvgpr_read_b32 v39, a11
    v_accvgpr_read_b32 v48, a64
    v_accvgpr_read_b32 v49, a65
    v_accvgpr_read_b32 v50, a66
    v_accvgpr_read_b32 v51, a67
    v_cvt_pk_bf16_f32 v32, v32, v32
    v_and_b32 v32, 0xffff0000, v32
    v_cvt_pk_bf16_f32 v44, v44, v44
    v_and_b32 v44, 0xffff0000, v44
    v_mul_f32 v32, v32, v44
    v_cvt_pk_bf16_f32 v33, v33, v33
    v_and_b32 v33, 0xffff0000, v33
    v_cvt_pk_bf16_f32 v45, v45, v45
    v_and_b32 v45, 0xffff0000, v45
    v_mul_f32 v33, v33, v45
    v_cvt_pk_bf16_f32 v34, v34, v34
    v_and_b32 v34, 0xffff0000, v34
    v_cvt_pk_bf16_f32 v46, v46, v46
    v_and_b32 v46, 0xffff0000, v46
    v_mul_f32 v34, v34, v46
    v_cvt_pk_bf16_f32 v35, v35, v35
    v_and_b32 v35, 0xffff0000, v35
    v_cvt_pk_bf16_f32 v47, v47, v47
    v_and_b32 v47, 0xffff0000, v47
    v_mul_f32 v35, v35, v47
    v_cvt_pk_bf16_f32 v36, v36, v36
    v_and_b32 v36, 0xffff0000, v36
    v_cvt_pk_bf16_f32 v48, v48, v48
    v_and_b32 v48, 0xffff0000, v48
    v_mul_f32 v36, v36, v48
    v_cvt_pk_bf16_f32 v37, v37, v37
    v_and_b32 v37, 0xffff0000, v37
    v_cvt_pk_bf16_f32 v49, v49, v49
    v_and_b32 v49, 0xffff0000, v49
    v_mul_f32 v37, v37, v49
    v_cvt_pk_bf16_f32 v38, v38, v38
    v_and_b32 v38, 0xffff0000, v38
    v_cvt_pk_bf16_f32 v50, v50, v50
    v_and_b32 v50, 0xffff0000, v50
    v_mul_f32 v38, v38, v50
    v_cvt_pk_bf16_f32 v39, v39, v39
    v_and_b32 v39, 0xffff0000, v39
    v_cvt_pk_bf16_f32 v51, v51, v51
    v_and_b32 v51, 0xffff0000, v51
    v_mul_f32 v39, v39, v51
    v_cvt_pk_bf16_f32 v40, v32, v33
    v_cvt_pk_bf16_f32 v41, v34, v35
    v_cvt_pk_bf16_f32 v42, v36, v37
    v_cvt_pk_bf16_f32 v43, v38, v39
    s_nop 0
    v_permlane16_swap_b32 v40, v42
    v_permlane16_swap_b32 v41, v43
    buffer_store_dwordx4 v[40:43], v16, s[60:63], s12 offen
    v_accvgpr_read_b32 v56, a16
    v_accvgpr_read_b32 v57, a17
    v_accvgpr_read_b32 v58, a18
    v_accvgpr_read_b32 v59, a19
    v_accvgpr_read_b32 v68, a72
    v_accvgpr_read_b32 v69, a73
    v_accvgpr_read_b32 v70, a74
    v_accvgpr_read_b32 v71, a75
    v_accvgpr_read_b32 v60, a24
    v_accvgpr_read_b32 v61, a25
    v_accvgpr_read_b32 v62, a26
    v_accvgpr_read_b32 v63, a27
    v_accvgpr_read_b32 v72, a80
    v_accvgpr_read_b32 v73, a81
    v_accvgpr_read_b32 v74, a82
    v_accvgpr_read_b32 v75, a83
    v_cvt_pk_bf16_f32 v56, v56, v56
    v_and_b32 v56, 0xffff0000, v56
    v_cvt_pk_bf16_f32 v68, v68, v68
    v_and_b32 v68, 0xffff0000, v68
    v_mul_f32 v56, v56, v68
    v_cvt_pk_bf16_f32 v57, v57, v57
    v_and_b32 v57, 0xffff0000, v57
    v_cvt_pk_bf16_f32 v69, v69, v69
    v_and_b32 v69, 0xffff0000, v69
    v_mul_f32 v57, v57, v69
    v_cvt_pk_bf16_f32 v58, v58, v58
    v_and_b32 v58, 0xffff0000, v58
    v_cvt_pk_bf16_f32 v70, v70, v70
    v_and_b32 v70, 0xffff0000, v70
    v_mul_f32 v58, v58, v70
    v_cvt_pk_bf16_f32 v59, v59, v59
    v_and_b32 v59, 0xffff0000, v59
    v_cvt_pk_bf16_f32 v71, v71, v71
    v_and_b32 v71, 0xffff0000, v71
    v_mul_f32 v59, v59, v71
    v_cvt_pk_bf16_f32 v60, v60, v60
    v_and_b32 v60, 0xffff0000, v60
    v_cvt_pk_bf16_f32 v72, v72, v72
    v_and_b32 v72, 0xffff0000, v72
    v_mul_f32 v60, v60, v72
    v_cvt_pk_bf16_f32 v61, v61, v61
    v_and_b32 v61, 0xffff0000, v61
    v_cvt_pk_bf16_f32 v73, v73, v73
    v_and_b32 v73, 0xffff0000, v73
    v_mul_f32 v61, v61, v73
    v_cvt_pk_bf16_f32 v62, v62, v62
    v_and_b32 v62, 0xffff0000, v62
    v_cvt_pk_bf16_f32 v74, v74, v74
    v_and_b32 v74, 0xffff0000, v74
    v_mul_f32 v62, v62, v74
    v_cvt_pk_bf16_f32 v63, v63, v63
    v_and_b32 v63, 0xffff0000, v63
    v_cvt_pk_bf16_f32 v75, v75, v75
    v_and_b32 v75, 0xffff0000, v75
    v_mul_f32 v63, v63, v75
    v_cvt_pk_bf16_f32 v64, v56, v57
    v_cvt_pk_bf16_f32 v65, v58, v59
    v_cvt_pk_bf16_f32 v66, v60, v61
    v_cvt_pk_bf16_f32 v67, v62, v63
    s_nop 0
    v_permlane16_swap_b32 v64, v66
    v_permlane16_swap_b32 v65, v67
    buffer_store_dwordx4 v[64:67], v16, s[60:63], s12 offen offset:64
    v_accvgpr_read_b32 v80, a32
    v_accvgpr_read_b32 v81, a33
    v_accvgpr_read_b32 v82, a34
    v_accvgpr_read_b32 v83, a35
    v_accvgpr_read_b32 v92, a88
    v_accvgpr_read_b32 v93, a89
    v_accvgpr_read_b32 v94, a90
    v_accvgpr_read_b32 v95, a91
    v_accvgpr_read_b32 v84, a40
    v_accvgpr_read_b32 v85, a41
    v_accvgpr_read_b32 v86, a42
    v_accvgpr_read_b32 v87, a43
    v_accvgpr_read_b32 v96, a96
    v_accvgpr_read_b32 v97, a97
    v_accvgpr_read_b32 v98, a98
    v_accvgpr_read_b32 v99, a99
    v_cvt_pk_bf16_f32 v80, v80, v80
    v_and_b32 v80, 0xffff0000, v80
    v_cvt_pk_bf16_f32 v92, v92, v92
    v_and_b32 v92, 0xffff0000, v92
    v_mul_f32 v80, v80, v92
    v_cvt_pk_bf16_f32 v81, v81, v81
    v_and_b32 v81, 0xffff0000, v81
    v_cvt_pk_bf16_f32 v93, v93, v93
    v_and_b32 v93, 0xffff0000, v93
    v_mul_f32 v81, v81, v93
    v_cvt_pk_bf16_f32 v82, v82, v82
    v_and_b32 v82, 0xffff0000, v82
    v_cvt_pk_bf16_f32 v94, v94, v94
    v_and_b32 v94, 0xffff0000, v94
    v_mul_f32 v82, v82, v94
    v_cvt_pk_bf16_f32 v83, v83, v83
    v_and_b32 v83, 0xffff0000, v83
    v_cvt_pk_bf16_f32 v95, v95, v95
    v_and_b32 v95, 0xffff0000, v95
    v_mul_f32 v83, v83, v95
    v_cvt_pk_bf16_f32 v84, v84, v84
    v_and_b32 v84, 0xffff0000, v84
    v_cvt_pk_bf16_f32 v96, v96, v96
    v_and_b32 v96, 0xffff0000, v96
    v_mul_f32 v84, v84, v96
    v_cvt_pk_bf16_f32 v85, v85, v85
    v_and_b32 v85, 0xffff0000, v85
    v_cvt_pk_bf16_f32 v97, v97, v97
    v_and_b32 v97, 0xffff0000, v97
    v_mul_f32 v85, v85, v97
    v_cvt_pk_bf16_f32 v86, v86, v86
    v_and_b32 v86, 0xffff0000, v86
    v_cvt_pk_bf16_f32 v98, v98, v98
    v_and_b32 v98, 0xffff0000, v98
    v_mul_f32 v86, v86, v98
    v_cvt_pk_bf16_f32 v87, v87, v87
    v_and_b32 v87, 0xffff0000, v87
    v_cvt_pk_bf16_f32 v99, v99, v99
    v_and_b32 v99, 0xffff0000, v99
    v_mul_f32 v87, v87, v99
    v_cvt_pk_bf16_f32 v88, v80, v81
    v_cvt_pk_bf16_f32 v89, v82, v83
    v_cvt_pk_bf16_f32 v90, v84, v85
    v_cvt_pk_bf16_f32 v91, v86, v87
    s_nop 0
    v_permlane16_swap_b32 v88, v90
    v_permlane16_swap_b32 v89, v91
    buffer_store_dwordx4 v[88:91], v16, s[60:63], s12 offen offset:128
    v_accvgpr_read_b32 v104, a48
    v_accvgpr_read_b32 v105, a49
    v_accvgpr_read_b32 v106, a50
    v_accvgpr_read_b32 v107, a51
    v_accvgpr_read_b32 v116, a104
    v_accvgpr_read_b32 v117, a105
    v_accvgpr_read_b32 v118, a106
    v_accvgpr_read_b32 v119, a107
    v_cvt_pk_bf16_f32 v104, v104, v104
    v_and_b32 v104, 0xffff0000, v104
    v_cvt_pk_bf16_f32 v116, v116, v116
    v_and_b32 v116, 0xffff0000, v116
    v_mul_f32 v104, v104, v116
    v_cvt_pk_bf16_f32 v105, v105, v105
    v_and_b32 v105, 0xffff0000, v105
    v_cvt_pk_bf16_f32 v117, v117, v117
    v_and_b32 v117, 0xffff0000, v117
    v_mul_f32 v105, v105, v117
    v_cvt_pk_bf16_f32 v106, v106, v106
    v_and_b32 v106, 0xffff0000, v106
    v_cvt_pk_bf16_f32 v118, v118, v118
    v_and_b32 v118, 0xffff0000, v118
    v_mul_f32 v106, v106, v118
    v_cvt_pk_bf16_f32 v107, v107, v107
    v_and_b32 v107, 0xffff0000, v107
    v_cvt_pk_bf16_f32 v119, v119, v119
    v_and_b32 v119, 0xffff0000, v119
    v_mul_f32 v107, v107, v119
    v_cvt_pk_bf16_f32 v112, v104, v105
    v_cvt_pk_bf16_f32 v113, v106, v107
    buffer_store_dwordx2 v[112:113], v15, s[60:63], s12 offen offset:192
    s_mov_b32 s12, 114688
    v_accvgpr_read_b32 v32, a4
    v_accvgpr_read_b32 v33, a5
    v_accvgpr_read_b32 v34, a6
    v_accvgpr_read_b32 v35, a7
    v_accvgpr_read_b32 v44, a60
    v_accvgpr_read_b32 v45, a61
    v_accvgpr_read_b32 v46, a62
    v_accvgpr_read_b32 v47, a63
    v_accvgpr_read_b32 v36, a12
    v_accvgpr_read_b32 v37, a13
    v_accvgpr_read_b32 v38, a14
    v_accvgpr_read_b32 v39, a15
    v_accvgpr_read_b32 v48, a68
    v_accvgpr_read_b32 v49, a69
    v_accvgpr_read_b32 v50, a70
    v_accvgpr_read_b32 v51, a71
    v_cvt_pk_bf16_f32 v32, v32, v32
    v_and_b32 v32, 0xffff0000, v32
    v_cvt_pk_bf16_f32 v44, v44, v44
    v_and_b32 v44, 0xffff0000, v44
    v_mul_f32 v32, v32, v44
    v_cvt_pk_bf16_f32 v33, v33, v33
    v_and_b32 v33, 0xffff0000, v33
    v_cvt_pk_bf16_f32 v45, v45, v45
    v_and_b32 v45, 0xffff0000, v45
    v_mul_f32 v33, v33, v45
    v_cvt_pk_bf16_f32 v34, v34, v34
    v_and_b32 v34, 0xffff0000, v34
    v_cvt_pk_bf16_f32 v46, v46, v46
    v_and_b32 v46, 0xffff0000, v46
    v_mul_f32 v34, v34, v46
    v_cvt_pk_bf16_f32 v35, v35, v35
    v_and_b32 v35, 0xffff0000, v35
    v_cvt_pk_bf16_f32 v47, v47, v47
    v_and_b32 v47, 0xffff0000, v47
    v_mul_f32 v35, v35, v47
    v_cvt_pk_bf16_f32 v36, v36, v36
    v_and_b32 v36, 0xffff0000, v36
    v_cvt_pk_bf16_f32 v48, v48, v48
    v_and_b32 v48, 0xffff0000, v48
    v_mul_f32 v36, v36, v48
    v_cvt_pk_bf16_f32 v37, v37, v37
    v_and_b32 v37, 0xffff0000, v37
    v_cvt_pk_bf16_f32 v49, v49, v49
    v_and_b32 v49, 0xffff0000, v49
    v_mul_f32 v37, v37, v49
    v_cvt_pk_bf16_f32 v38, v38, v38
    v_and_b32 v38, 0xffff0000, v38
    v_cvt_pk_bf16_f32 v50, v50, v50
    v_and_b32 v50, 0xffff0000, v50
    v_mul_f32 v38, v38, v50
    v_cvt_pk_bf16_f32 v39, v39, v39
    v_and_b32 v39, 0xffff0000, v39
    v_cvt_pk_bf16_f32 v51, v51, v51
    v_and_b32 v51, 0xffff0000, v51
    v_mul_f32 v39, v39, v51
    v_cvt_pk_bf16_f32 v40, v32, v33
    v_cvt_pk_bf16_f32 v41, v34, v35
    v_cvt_pk_bf16_f32 v42, v36, v37
    v_cvt_pk_bf16_f32 v43, v38, v39
    s_nop 0
    v_permlane16_swap_b32 v40, v42
    v_permlane16_swap_b32 v41, v43
    buffer_store_dwordx4 v[40:43], v16, s[60:63], s12 offen
    v_accvgpr_read_b32 v56, a20
    v_accvgpr_read_b32 v57, a21
    v_accvgpr_read_b32 v58, a22
    v_accvgpr_read_b32 v59, a23
    v_accvgpr_read_b32 v68, a76
    v_accvgpr_read_b32 v69, a77
    v_accvgpr_read_b32 v70, a78
    v_accvgpr_read_b32 v71, a79
    v_accvgpr_read_b32 v60, a28
    v_accvgpr_read_b32 v61, a29
    v_accvgpr_read_b32 v62, a30
    v_accvgpr_read_b32 v63, a31
    v_accvgpr_read_b32 v72, a84
    v_accvgpr_read_b32 v73, a85
    v_accvgpr_read_b32 v74, a86
    v_accvgpr_read_b32 v75, a87
    v_cvt_pk_bf16_f32 v56, v56, v56
    v_and_b32 v56, 0xffff0000, v56
    v_cvt_pk_bf16_f32 v68, v68, v68
    v_and_b32 v68, 0xffff0000, v68
    v_mul_f32 v56, v56, v68
    v_cvt_pk_bf16_f32 v57, v57, v57
    v_and_b32 v57, 0xffff0000, v57
    v_cvt_pk_bf16_f32 v69, v69, v69
    v_and_b32 v69, 0xffff0000, v69
    v_mul_f32 v57, v57, v69
    v_cvt_pk_bf16_f32 v58, v58, v58
    v_and_b32 v58, 0xffff0000, v58
    v_cvt_pk_bf16_f32 v70, v70, v70
    v_and_b32 v70, 0xffff0000, v70
    v_mul_f32 v58, v58, v70
    v_cvt_pk_bf16_f32 v59, v59, v59
    v_and_b32 v59, 0xffff0000, v59
    v_cvt_pk_bf16_f32 v71, v71, v71
    v_and_b32 v71, 0xffff0000, v71
    v_mul_f32 v59, v59, v71
    v_cvt_pk_bf16_f32 v60, v60, v60
    v_and_b32 v60, 0xffff0000, v60
    v_cvt_pk_bf16_f32 v72, v72, v72
    v_and_b32 v72, 0xffff0000, v72
    v_mul_f32 v60, v60, v72
    v_cvt_pk_bf16_f32 v61, v61, v61
    v_and_b32 v61, 0xffff0000, v61
    v_cvt_pk_bf16_f32 v73, v73, v73
    v_and_b32 v73, 0xffff0000, v73
    v_mul_f32 v61, v61, v73
    v_cvt_pk_bf16_f32 v62, v62, v62
    v_and_b32 v62, 0xffff0000, v62
    v_cvt_pk_bf16_f32 v74, v74, v74
    v_and_b32 v74, 0xffff0000, v74
    v_mul_f32 v62, v62, v74
    v_cvt_pk_bf16_f32 v63, v63, v63
    v_and_b32 v63, 0xffff0000, v63
    v_cvt_pk_bf16_f32 v75, v75, v75
    v_and_b32 v75, 0xffff0000, v75
    v_mul_f32 v63, v63, v75
    v_cvt_pk_bf16_f32 v64, v56, v57
    v_cvt_pk_bf16_f32 v65, v58, v59
    v_cvt_pk_bf16_f32 v66, v60, v61
    v_cvt_pk_bf16_f32 v67, v62, v63
    s_nop 0
    v_permlane16_swap_b32 v64, v66
    v_permlane16_swap_b32 v65, v67
    buffer_store_dwordx4 v[64:67], v16, s[60:63], s12 offen offset:64
    v_accvgpr_read_b32 v80, a36
    v_accvgpr_read_b32 v81, a37
    v_accvgpr_read_b32 v82, a38
    v_accvgpr_read_b32 v83, a39
    v_accvgpr_read_b32 v92, a92
    v_accvgpr_read_b32 v93, a93
    v_accvgpr_read_b32 v94, a94
    v_accvgpr_read_b32 v95, a95
    v_accvgpr_read_b32 v84, a44
    v_accvgpr_read_b32 v85, a45
    v_accvgpr_read_b32 v86, a46
    v_accvgpr_read_b32 v87, a47
    v_accvgpr_read_b32 v96, a100
    v_accvgpr_read_b32 v97, a101
    v_accvgpr_read_b32 v98, a102
    v_accvgpr_read_b32 v99, a103
    v_cvt_pk_bf16_f32 v80, v80, v80
    v_and_b32 v80, 0xffff0000, v80
    v_cvt_pk_bf16_f32 v92, v92, v92
    v_and_b32 v92, 0xffff0000, v92
    v_mul_f32 v80, v80, v92
    v_cvt_pk_bf16_f32 v81, v81, v81
    v_and_b32 v81, 0xffff0000, v81
    v_cvt_pk_bf16_f32 v93, v93, v93
    v_and_b32 v93, 0xffff0000, v93
    v_mul_f32 v81, v81, v93
    v_cvt_pk_bf16_f32 v82, v82, v82
    v_and_b32 v82, 0xffff0000, v82
    v_cvt_pk_bf16_f32 v94, v94, v94
    v_and_b32 v94, 0xffff0000, v94
    v_mul_f32 v82, v82, v94
    v_cvt_pk_bf16_f32 v83, v83, v83
    v_and_b32 v83, 0xffff0000, v83
    v_cvt_pk_bf16_f32 v95, v95, v95
    v_and_b32 v95, 0xffff0000, v95
    v_mul_f32 v83, v83, v95
    v_cvt_pk_bf16_f32 v84, v84, v84
    v_and_b32 v84, 0xffff0000, v84
    v_cvt_pk_bf16_f32 v96, v96, v96
    v_and_b32 v96, 0xffff0000, v96
    v_mul_f32 v84, v84, v96
    v_cvt_pk_bf16_f32 v85, v85, v85
    v_and_b32 v85, 0xffff0000, v85
    v_cvt_pk_bf16_f32 v97, v97, v97
    v_and_b32 v97, 0xffff0000, v97
    v_mul_f32 v85, v85, v97
    v_cvt_pk_bf16_f32 v86, v86, v86
    v_and_b32 v86, 0xffff0000, v86
    v_cvt_pk_bf16_f32 v98, v98, v98
    v_and_b32 v98, 0xffff0000, v98
    v_mul_f32 v86, v86, v98
    v_cvt_pk_bf16_f32 v87, v87, v87
    v_and_b32 v87, 0xffff0000, v87
    v_cvt_pk_bf16_f32 v99, v99, v99
    v_and_b32 v99, 0xffff0000, v99
    v_mul_f32 v87, v87, v99
    v_cvt_pk_bf16_f32 v88, v80, v81
    v_cvt_pk_bf16_f32 v89, v82, v83
    v_cvt_pk_bf16_f32 v90, v84, v85
    v_cvt_pk_bf16_f32 v91, v86, v87
    s_nop 0
    v_permlane16_swap_b32 v88, v90
    v_permlane16_swap_b32 v89, v91
    buffer_store_dwordx4 v[88:91], v16, s[60:63], s12 offen offset:128
    v_accvgpr_read_b32 v104, a52
    v_accvgpr_read_b32 v105, a53
    v_accvgpr_read_b32 v106, a54
    v_accvgpr_read_b32 v107, a55
    v_accvgpr_read_b32 v116, a108
    v_accvgpr_read_b32 v117, a109
    v_accvgpr_read_b32 v118, a110
    v_accvgpr_read_b32 v119, a111
    v_cvt_pk_bf16_f32 v104, v104, v104
    v_and_b32 v104, 0xffff0000, v104
    v_cvt_pk_bf16_f32 v116, v116, v116
    v_and_b32 v116, 0xffff0000, v116
    v_mul_f32 v104, v104, v116
    v_cvt_pk_bf16_f32 v105, v105, v105
    v_and_b32 v105, 0xffff0000, v105
    v_cvt_pk_bf16_f32 v117, v117, v117
    v_and_b32 v117, 0xffff0000, v117
    v_mul_f32 v105, v105, v117
    v_cvt_pk_bf16_f32 v106, v106, v106
    v_and_b32 v106, 0xffff0000, v106
    v_cvt_pk_bf16_f32 v118, v118, v118
    v_and_b32 v118, 0xffff0000, v118
    v_mul_f32 v106, v106, v118
    v_cvt_pk_bf16_f32 v107, v107, v107
    v_and_b32 v107, 0xffff0000, v107
    v_cvt_pk_bf16_f32 v119, v119, v119
    v_and_b32 v119, 0xffff0000, v119
    v_mul_f32 v107, v107, v119
    v_cvt_pk_bf16_f32 v112, v104, v105
    v_cvt_pk_bf16_f32 v113, v106, v107
    buffer_store_dwordx2 v[112:113], v15, s[60:63], s12 offen offset:192
    s_waitcnt vmcnt(0)
gateup_kernel_end:
    s_endpgm
.p2align 8
.globl down_kernel
.type down_kernel,@function
down_kernel:
    s_cmp_ge_u32 s2, 256
    s_cbranch_scc1 down_kernel_end
    s_load_dwordx16 s[16:31], s[0:1], 0
    s_load_dwordx8 s[32:39], s[0:1], 64
    s_and_b32 s3, s2, 3
    s_lshl_b32 s3, s3, 2
    s_bfe_u32 s4, s2, 0x20003
    s_add_u32 s3, s3, s4
    s_bfe_u32 s4, s2, 0x10002
    s_lshl_b32 s4, s4, 3
    s_lshr_b32 s5, s2, 5
    s_add_u32 s4, s4, s5
    v_lshrrev_b32 v1, 6, v0
    s_nop 0
    v_readfirstlane_b32 s6, v1
    v_and_b32 v2, 63, v0
    s_and_b32 s7, s6, 3
    s_lshr_b32 s8, s6, 2
    s_waitcnt lgkmcnt(0)
    s_mul_i32 s9, s3, 917504
    s_add_u32 s10, s9, 33554432
    s_sub_u32 s11, 14680064, s9
    s_add_u32 s40, s38, s10
    s_addc_u32 s41, s39, 0
    s_and_b32 s41, s41, 0xffff
    s_mov_b32 s42, s11
    s_mov_b32 s43, 0x00020000
    s_mul_i32 s9, s4, 128
    s_add_u32 s9, s9, 0
    s_sub_u32 s11, 7340032, s9
    s_add_u32 s44, s28, s9
    s_addc_u32 s45, s29, 0
    s_and_b32 s45, s45, 0xffff
    s_mov_b32 s46, s11
    s_mov_b32 s47, 0x00020000
    v_lshrrev_b32 v10, 3, v2
    v_lshrrev_b32 v11, 4, v2
    v_bfe_u32 v12, v2, 2, 2
    v_and_b32 v15, 3, v2
    s_and_b32 s9, s6, 1
    s_lshl_b32 s9, s9, 2
    v_add_u32 v13, s9, v11
    v_and_b32 v14, 7, v2
    v_xor_b32 v13, v13, v14
    s_lshl_b32 s9, s6, 3
    v_add_u32 v14, s9, v10
    s_mov_b32 s9, 7168
    v_mul_lo_u32 v14, v14, s9
    v_lshl_add_u32 v4, v13, 4, v14
    v_add_u32 v5, 458752, v4
    v_and_b32 v13, 1, v11
    s_and_b32 s9, s6, 1
    s_lshl_b32 s9, s9, 1
    v_add_u32 v13, s9, v13
    v_bfe_u32 v14, v2, 1, 2
    v_xor_b32 v13, v13, v14
    v_lshlrev_b32 v13, 5, v13
    v_and_b32 v14, 1, v2
    v_lshl_add_u32 v13, v14, 4, v13
    s_lshl_b32 s9, s6, 3
    v_add_u32 v14, s9, v10
    s_mov_b32 s9, 2048
    v_mul_lo_u32 v14, v14, s9
    v_add_u32 v32, v13, v14
    s_lshl_b32 s75, s6, 10
    v_and_b32 v13, 15, v2
    v_lshrrev_b32 v14, 1, v13
    v_xor_b32 v14, v14, v11
    v_lshlrev_b32 v13, 7, v13
    v_lshl_add_u32 v13, v14, 4, v13
    s_lshl_b32 s9, s7, 12
    v_add_u32 v13, s9, v13
    v_add_u32 v16, 0, v13
    v_xor_b32 v17, 64, v16
    v_add_u32 v18, 24576, v13
    v_xor_b32 v19, 64, v18
    v_add_u32 v20, 49152, v13
    v_xor_b32 v21, 64, v20
    v_add_u32 v22, 73728, v13
    v_xor_b32 v23, 64, v22
    v_lshrrev_b32 v13, 1, v12
    v_and_b32 v14, 1, v11
    v_lshl_add_u32 v13, v14, 1, v13
    s_lshl_b32 s9, s8, 1
    v_xor_b32 v13, s9, v13
    v_lshl_add_u32 v14, v11, 3, v12
    v_lshlrev_b32 v14, 7, v14
    v_lshl_add_u32 v14, v15, 3, v14
    v_lshl_add_u32 v24, v13, 5, v14
    v_xor_b32 v25, 32, v24
    v_add_u32 v40, 16384, v24
    v_add_u32 v41, 16384, v25
    v_add_u32 v42, 40960, v24
    v_add_u32 v43, 40960, v25
    v_add_u32 v44, 65536, v24
    v_add_u32 v45, 65536, v25
    v_add_u32 v46, 90112, v24
    v_add_u32 v47, 90112, v25
    s_lshl_b32 s12, s6, 10
    s_mov_b32 s13, 0
    s_mov_b32 s14, 0
    s_add_u32 m0, s12, 0
    s_nop 0
    buffer_load_dwordx4 v4, s[40:43], s13 offen lds
    s_add_u32 m0, s12, 8192
    s_nop 0
    buffer_load_dwordx4 v5, s[40:43], s13 offen lds
    s_add_u32 m0, s75, 16384
    s_nop 0
    buffer_load_dwordx4 v32, s[44:47], s14 offen lds
    s_add_u32 s13, s13, 128
    s_add_u32 s14, s14, 131072
    s_add_u32 m0, s12, 24576
    s_nop 0
    buffer_load_dwordx4 v4, s[40:43], s13 offen lds
    s_add_u32 m0, s12, 32768
    s_nop 0
    buffer_load_dwordx4 v5, s[40:43], s13 offen lds
    s_add_u32 m0, s75, 40960
    s_nop 0
    buffer_load_dwordx4 v32, s[44:47], s14 offen lds
    s_add_u32 s13, s13, 128
    s_add_u32 s14, s14, 131072
    s_add_u32 m0, s12, 49152
    s_nop 0
    buffer_load_dwordx4 v4, s[40:43], s13 offen lds
    s_add_u32 m0, s12, 57344
    s_nop 0
    buffer_load_dwordx4 v5, s[40:43], s13 offen lds
    s_add_u32 m0, s75, 65536
    s_nop 0
    buffer_load_dwordx4 v32, s[44:47], s14 offen lds
    s_add_u32 s13, s13, 128
    s_add_u32 s14, s14, 131072
    s_add_u32 m0, s12, 73728
    s_nop 0
    buffer_load_dwordx4 v4, s[40:43], s13 offen lds
    s_add_u32 m0, s12, 81920
    s_nop 0
    buffer_load_dwordx4 v5, s[40:43], s13 offen lds
    s_add_u32 m0, s75, 90112
    s_nop 0
    buffer_load_dwordx4 v32, s[44:47], s14 offen lds
    s_add_u32 s13, s13, 128
    s_add_u32 s14, s14, 131072
    v_accvgpr_write_b32 a0, 0
    v_accvgpr_write_b32 a1, 0
    v_accvgpr_write_b32 a2, 0
    v_accvgpr_write_b32 a3, 0
    v_accvgpr_write_b32 a4, 0
    v_accvgpr_write_b32 a5, 0
    v_accvgpr_write_b32 a6, 0
    v_accvgpr_write_b32 a7, 0
    v_accvgpr_write_b32 a8, 0
    v_accvgpr_write_b32 a9, 0
    v_accvgpr_write_b32 a10, 0
    v_accvgpr_write_b32 a11, 0
    v_accvgpr_write_b32 a12, 0
    v_accvgpr_write_b32 a13, 0
    v_accvgpr_write_b32 a14, 0
    v_accvgpr_write_b32 a15, 0
    s_waitcnt vmcnt(9)
    s_barrier
    ds_read_b128 v[64:67], v16
    ds_read_b128 v[68:71], v16 offset:2048
    ds_read_b64_tr_b16 v[72:73], v40
    ds_read_b64_tr_b16 v[74:75], v40 offset:512
    ds_read_b64_tr_b16 v[76:77], v41
    ds_read_b64_tr_b16 v[78:79], v41 offset:512
    ds_read_b128 v[80:83], v17
    ds_read_b128 v[84:87], v17 offset:2048
    ds_read_b64_tr_b16 v[88:89], v40 offset:4096
    ds_read_b64_tr_b16 v[90:91], v40 offset:4608
    ds_read_b64_tr_b16 v[92:93], v41 offset:4096
    ds_read_b64_tr_b16 v[94:95], v41 offset:4608
    s_mov_b32 s15, 13
down_kernel_loop:
    s_waitcnt vmcnt(6) lgkmcnt(0)
    s_barrier
    v_mfma_f32_16x16x32_bf16 a[0:3], v[72:75], v[64:67], a[0:3]
    ds_read_b128 v[96:99], v18
    ds_read_b128 v[100:103], v18 offset:2048
    v_mfma_f32_16x16x32_bf16 a[4:7], v[72:75], v[68:71], a[4:7]
    ds_read_b64_tr_b16 v[104:105], v42
    s_add_u32 m0, s12, 0
    s_nop 0
    buffer_load_dwordx4 v4, s[40:43], s13 offen lds
    v_mfma_f32_16x16x32_bf16 a[8:11], v[76:79], v[64:67], a[8:11]
    ds_read_b64_tr_b16 v[106:107], v42 offset:512
    ds_read_b64_tr_b16 v[108:109], v43
    v_mfma_f32_16x16x32_bf16 a[12:15], v[76:79], v[68:71], a[12:15]
    ds_read_b64_tr_b16 v[110:111], v43 offset:512
    s_add_u32 m0, s12, 8192
    s_nop 0
    buffer_load_dwordx4 v5, s[40:43], s13 offen lds
    v_mfma_f32_16x16x32_bf16 a[0:3], v[88:91], v[80:83], a[0:3]
    ds_read_b128 v[112:115], v19
    ds_read_b128 v[116:119], v19 offset:2048
    v_mfma_f32_16x16x32_bf16 a[4:7], v[88:91], v[84:87], a[4:7]
    ds_read_b64_tr_b16 v[120:121], v42 offset:4096
    s_add_u32 m0, s75, 16384
    s_nop 0
    buffer_load_dwordx4 v32, s[44:47], s14 offen lds
    v_mfma_f32_16x16x32_bf16 a[8:11], v[92:95], v[80:83], a[8:11]
    ds_read_b64_tr_b16 v[122:123], v42 offset:4608
    ds_read_b64_tr_b16 v[124:125], v43 offset:4096
    v_mfma_f32_16x16x32_bf16 a[12:15], v[92:95], v[84:87], a[12:15]
    ds_read_b64_tr_b16 v[126:127], v43 offset:4608
    s_add_u32 s13, s13, 128
    s_add_u32 s14, s14, 131072
    s_waitcnt vmcnt(6) lgkmcnt(0)
    s_barrier
    v_mfma_f32_16x16x32_bf16 a[0:3], v[104:107], v[96:99], a[0:3]
    ds_read_b128 v[64:67], v20
    ds_read_b128 v[68:71], v20 offset:2048
    v_mfma_f32_16x16x32_bf16 a[4:7], v[104:107], v[100:103], a[4:7]
    ds_read_b64_tr_b16 v[72:73], v44
    s_add_u32 m0, s12, 24576
    s_nop 0
    buffer_load_dwordx4 v4, s[40:43], s13 offen lds
    v_mfma_f32_16x16x32_bf16 a[8:11], v[108:111], v[96:99], a[8:11]
    ds_read_b64_tr_b16 v[74:75], v44 offset:512
    ds_read_b64_tr_b16 v[76:77], v45
    v_mfma_f32_16x16x32_bf16 a[12:15], v[108:111], v[100:103], a[12:15]
    ds_read_b64_tr_b16 v[78:79], v45 offset:512
    s_add_u32 m0, s12, 32768
    s_nop 0
    buffer_load_dwordx4 v5, s[40:43], s13 offen lds
    v_mfma_f32_16x16x32_bf16 a[0:3], v[120:123], v[112:115], a[0:3]
    ds_read_b128 v[80:83], v21
    ds_read_b128 v[84:87], v21 offset:2048
    v_mfma_f32_16x16x32_bf16 a[4:7], v[120:123], v[116:119], a[4:7]
    ds_read_b64_tr_b16 v[88:89], v44 offset:4096
    s_add_u32 m0, s75, 40960
    s_nop 0
    buffer_load_dwordx4 v32, s[44:47], s14 offen lds
    v_mfma_f32_16x16x32_bf16 a[8:11], v[124:127], v[112:115], a[8:11]
    ds_read_b64_tr_b16 v[90:91], v44 offset:4608
    ds_read_b64_tr_b16 v[92:93], v45 offset:4096
    v_mfma_f32_16x16x32_bf16 a[12:15], v[124:127], v[116:119], a[12:15]
    ds_read_b64_tr_b16 v[94:95], v45 offset:4608
    s_add_u32 s13, s13, 128
    s_add_u32 s14, s14, 131072
    s_waitcnt vmcnt(6) lgkmcnt(0)
    s_barrier
    v_mfma_f32_16x16x32_bf16 a[0:3], v[72:75], v[64:67], a[0:3]
    ds_read_b128 v[96:99], v22
    ds_read_b128 v[100:103], v22 offset:2048
    v_mfma_f32_16x16x32_bf16 a[4:7], v[72:75], v[68:71], a[4:7]
    ds_read_b64_tr_b16 v[104:105], v46
    s_add_u32 m0, s12, 49152
    s_nop 0
    buffer_load_dwordx4 v4, s[40:43], s13 offen lds
    v_mfma_f32_16x16x32_bf16 a[8:11], v[76:79], v[64:67], a[8:11]
    ds_read_b64_tr_b16 v[106:107], v46 offset:512
    ds_read_b64_tr_b16 v[108:109], v47
    v_mfma_f32_16x16x32_bf16 a[12:15], v[76:79], v[68:71], a[12:15]
    ds_read_b64_tr_b16 v[110:111], v47 offset:512
    s_add_u32 m0, s12, 57344
    s_nop 0
    buffer_load_dwordx4 v5, s[40:43], s13 offen lds
    v_mfma_f32_16x16x32_bf16 a[0:3], v[88:91], v[80:83], a[0:3]
    ds_read_b128 v[112:115], v23
    ds_read_b128 v[116:119], v23 offset:2048
    v_mfma_f32_16x16x32_bf16 a[4:7], v[88:91], v[84:87], a[4:7]
    ds_read_b64_tr_b16 v[120:121], v46 offset:4096
    s_add_u32 m0, s75, 65536
    s_nop 0
    buffer_load_dwordx4 v32, s[44:47], s14 offen lds
    v_mfma_f32_16x16x32_bf16 a[8:11], v[92:95], v[80:83], a[8:11]
    ds_read_b64_tr_b16 v[122:123], v46 offset:4608
    ds_read_b64_tr_b16 v[124:125], v47 offset:4096
    v_mfma_f32_16x16x32_bf16 a[12:15], v[92:95], v[84:87], a[12:15]
    ds_read_b64_tr_b16 v[126:127], v47 offset:4608
    s_add_u32 s13, s13, 128
    s_add_u32 s14, s14, 131072
    s_waitcnt vmcnt(6) lgkmcnt(0)
    s_barrier
    v_mfma_f32_16x16x32_bf16 a[0:3], v[104:107], v[96:99], a[0:3]
    ds_read_b128 v[64:67], v16
    ds_read_b128 v[68:71], v16 offset:2048
    v_mfma_f32_16x16x32_bf16 a[4:7], v[104:107], v[100:103], a[4:7]
    ds_read_b64_tr_b16 v[72:73], v40
    s_add_u32 m0, s12, 73728
    s_nop 0
    buffer_load_dwordx4 v4, s[40:43], s13 offen lds
    v_mfma_f32_16x16x32_bf16 a[8:11], v[108:111], v[96:99], a[8:11]
    ds_read_b64_tr_b16 v[74:75], v40 offset:512
    ds_read_b64_tr_b16 v[76:77], v41
    v_mfma_f32_16x16x32_bf16 a[12:15], v[108:111], v[100:103], a[12:15]
    ds_read_b64_tr_b16 v[78:79], v41 offset:512
    s_add_u32 m0, s12, 81920
    s_nop 0
    buffer_load_dwordx4 v5, s[40:43], s13 offen lds
    v_mfma_f32_16x16x32_bf16 a[0:3], v[120:123], v[112:115], a[0:3]
    ds_read_b128 v[80:83], v17
    ds_read_b128 v[84:87], v17 offset:2048
    v_mfma_f32_16x16x32_bf16 a[4:7], v[120:123], v[116:119], a[4:7]
    ds_read_b64_tr_b16 v[88:89], v40 offset:4096
    s_add_u32 m0, s75, 90112
    s_nop 0
    buffer_load_dwordx4 v32, s[44:47], s14 offen lds
    v_mfma_f32_16x16x32_bf16 a[8:11], v[124:127], v[112:115], a[8:11]
    ds_read_b64_tr_b16 v[90:91], v40 offset:4608
    ds_read_b64_tr_b16 v[92:93], v41 offset:4096
    v_mfma_f32_16x16x32_bf16 a[12:15], v[124:127], v[116:119], a[12:15]
    ds_read_b64_tr_b16 v[94:95], v41 offset:4608
    s_add_u32 s13, s13, 128
    s_add_u32 s14, s14, 131072
    s_sub_u32 s15, s15, 1
    s_cmp_lg_u32 s15, 0
    s_cbranch_scc1 down_kernel_loop
    s_nop 3
    v_and_b32 v10, 15, v2
    v_lshrrev_b32 v11, 4, v2
    v_and_b32 v12, 1, v11
    v_lshlrev_b32 v12, 5, v12
    v_lshrrev_b32 v13, 1, v11
    v_lshl_add_u32 v12, v13, 4, v12
    s_lshl_b32 s9, s4, 6
    s_lshl_b32 s10, s8, 5
    s_add_u32 s9, s9, s10
    s_lshl_b32 s10, s3, 7
    s_lshl_b32 s11, s7, 5
    s_add_u32 s10, s10, s11
    s_add_u32 s60, s38, 25165824
    s_addc_u32 s61, s39, 0
    s_and_b32 s61, s61, 0xffff
    s_mov_b32 s62, 4194304
    s_mov_b32 s63, 0x00020000
    s_add_u32 s64, s34, 0
    s_addc_u32 s65, s35, 0
    s_and_b32 s65, s65, 0xffff
    s_mov_b32 s66, 4194304
    s_mov_b32 s67, 0x00020000
    s_add_u32 s68, s38, 0
    s_addc_u32 s69, s39, 0
    s_and_b32 s69, s69, 0xffff
    s_mov_b32 s70, 24576
    s_mov_b32 s71, 0x00020000
    v_add_u32 v14, s10, v10
    v_lshlrev_b32 v14, 11, v14
    s_lshl_b32 s11, s9, 1
    v_add_u32 v14, s11, v14
    v_lshl_add_u32 v15, v11, 3, v14
    v_add_u32 v144, v14, v12
    s_lshl_b32 s11, s9, 2
    s_add_u32 s11, s11, 20480
    v_lshlrev_b32 v13, 4, v11
    buffer_load_dwordx4 v[128:131], v13, s[68:71], s11 offen
    buffer_load_dwordx4 v[132:135], v13, s[68:71], s11 offen offset:64
    s_mov_b32 s9, 0
    buffer_load_dwordx2 v[136:137], v15, s[60:63], s9 offen
    buffer_load_dwordx2 v[138:139], v15, s[60:63], s9 offen offset:32
    s_mov_b32 s9, 32768
    buffer_load_dwordx2 v[140:141], v15, s[60:63], s9 offen
    buffer_load_dwordx2 v[142:143], v15, s[60:63], s9 offen offset:32
    s_waitcnt vmcnt(12) lgkmcnt(0)
    s_barrier
    v_mfma_f32_16x16x32_bf16 a[0:3], v[72:75], v[64:67], a[0:3]
    ds_read_b128 v[96:99], v18
    ds_read_b128 v[100:103], v18 offset:2048
    v_mfma_f32_16x16x32_bf16 a[4:7], v[72:75], v[68:71], a[4:7]
    ds_read_b64_tr_b16 v[104:105], v42
    ds_read_b64_tr_b16 v[106:107], v42 offset:512
    v_mfma_f32_16x16x32_bf16 a[8:11], v[76:79], v[64:67], a[8:11]
    ds_read_b64_tr_b16 v[108:109], v43
    ds_read_b64_tr_b16 v[110:111], v43 offset:512
    v_mfma_f32_16x16x32_bf16 a[12:15], v[76:79], v[68:71], a[12:15]
    ds_read_b128 v[112:115], v19
    ds_read_b128 v[116:119], v19 offset:2048
    v_mfma_f32_16x16x32_bf16 a[0:3], v[88:91], v[80:83], a[0:3]
    ds_read_b64_tr_b16 v[120:121], v42 offset:4096
    v_mfma_f32_16x16x32_bf16 a[4:7], v[88:91], v[84:87], a[4:7]
    ds_read_b64_tr_b16 v[122:123], v42 offset:4608
    v_mfma_f32_16x16x32_bf16 a[8:11], v[92:95], v[80:83], a[8:11]
    ds_read_b64_tr_b16 v[124:125], v43 offset:4096
    v_mfma_f32_16x16x32_bf16 a[12:15], v[92:95], v[84:87], a[12:15]
    ds_read_b64_tr_b16 v[126:127], v43 offset:4608
    s_waitcnt vmcnt(9) lgkmcnt(0)
    s_barrier
    v_mfma_f32_16x16x32_bf16 a[0:3], v[104:107], v[96:99], a[0:3]
    ds_read_b128 v[64:67], v20
    ds_read_b128 v[68:71], v20 offset:2048
    v_mfma_f32_16x16x32_bf16 a[4:7], v[104:107], v[100:103], a[4:7]
    ds_read_b64_tr_b16 v[72:73], v44
    ds_read_b64_tr_b16 v[74:75], v44 offset:512
    v_mfma_f32_16x16x32_bf16 a[8:11], v[108:111], v[96:99], a[8:11]
    ds_read_b64_tr_b16 v[76:77], v45
    ds_read_b64_tr_b16 v[78:79], v45 offset:512
    v_mfma_f32_16x16x32_bf16 a[12:15], v[108:111], v[100:103], a[12:15]
    ds_read_b128 v[80:83], v21
    ds_read_b128 v[84:87], v21 offset:2048
    v_mfma_f32_16x16x32_bf16 a[0:3], v[120:123], v[112:115], a[0:3]
    ds_read_b64_tr_b16 v[88:89], v44 offset:4096
    v_mfma_f32_16x16x32_bf16 a[4:7], v[120:123], v[116:119], a[4:7]
    ds_read_b64_tr_b16 v[90:91], v44 offset:4608
    v_mfma_f32_16x16x32_bf16 a[8:11], v[124:127], v[112:115], a[8:11]
    ds_read_b64_tr_b16 v[92:93], v45 offset:4096
    v_mfma_f32_16x16x32_bf16 a[12:15], v[124:127], v[116:119], a[12:15]
    ds_read_b64_tr_b16 v[94:95], v45 offset:4608
    s_waitcnt vmcnt(6) lgkmcnt(0)
    s_barrier
    v_mfma_f32_16x16x32_bf16 a[0:3], v[72:75], v[64:67], a[0:3]
    ds_read_b128 v[96:99], v22
    ds_read_b128 v[100:103], v22 offset:2048
    v_mfma_f32_16x16x32_bf16 a[4:7], v[72:75], v[68:71], a[4:7]
    ds_read_b64_tr_b16 v[104:105], v46
    ds_read_b64_tr_b16 v[106:107], v46 offset:512
    v_mfma_f32_16x16x32_bf16 a[8:11], v[76:79], v[64:67], a[8:11]
    ds_read_b64_tr_b16 v[108:109], v47
    ds_read_b64_tr_b16 v[110:111], v47 offset:512
    v_mfma_f32_16x16x32_bf16 a[12:15], v[76:79], v[68:71], a[12:15]
    ds_read_b128 v[112:115], v23
    ds_read_b128 v[116:119], v23 offset:2048
    v_mfma_f32_16x16x32_bf16 a[0:3], v[88:91], v[80:83], a[0:3]
    ds_read_b64_tr_b16 v[120:121], v46 offset:4096
    v_mfma_f32_16x16x32_bf16 a[4:7], v[88:91], v[84:87], a[4:7]
    ds_read_b64_tr_b16 v[122:123], v46 offset:4608
    v_mfma_f32_16x16x32_bf16 a[8:11], v[92:95], v[80:83], a[8:11]
    ds_read_b64_tr_b16 v[124:125], v47 offset:4096
    v_mfma_f32_16x16x32_bf16 a[12:15], v[92:95], v[84:87], a[12:15]
    ds_read_b64_tr_b16 v[126:127], v47 offset:4608
    s_waitcnt lgkmcnt(0)
    v_mfma_f32_16x16x32_bf16 a[0:3], v[104:107], v[96:99], a[0:3]
    v_mfma_f32_16x16x32_bf16 a[4:7], v[104:107], v[100:103], a[4:7]
    v_mfma_f32_16x16x32_bf16 a[8:11], v[108:111], v[96:99], a[8:11]
    v_mfma_f32_16x16x32_bf16 a[12:15], v[108:111], v[100:103], a[12:15]
    v_mfma_f32_16x16x32_bf16 a[0:3], v[120:123], v[112:115], a[0:3]
    v_mfma_f32_16x16x32_bf16 a[4:7], v[120:123], v[116:119], a[4:7]
    v_mfma_f32_16x16x32_bf16 a[8:11], v[124:127], v[112:115], a[8:11]
    v_mfma_f32_16x16x32_bf16 a[12:15], v[124:127], v[116:119], a[12:15]
    s_nop 11
    s_waitcnt vmcnt(0)
    v_accvgpr_read_b32 v64, a0
    v_accvgpr_read_b32 v65, a1
    v_accvgpr_read_b32 v66, a2
    v_accvgpr_read_b32 v67, a3
    v_accvgpr_read_b32 v68, a8
    v_accvgpr_read_b32 v69, a9
    v_accvgpr_read_b32 v70, a10
    v_accvgpr_read_b32 v71, a11
    v_cvt_pk_bf16_f32 v64, v64, v64
    v_and_b32 v64, 0xffff0000, v64
    v_mul_f32 v64, v64, v128
    v_cvt_pk_bf16_f32 v64, v64, v64
    v_and_b32 v64, 0xffff0000, v64
    v_cvt_pk_bf16_f32 v65, v65, v65
    v_and_b32 v65, 0xffff0000, v65
    v_mul_f32 v65, v65, v129
    v_cvt_pk_bf16_f32 v65, v65, v65
    v_and_b32 v65, 0xffff0000, v65
    v_cvt_pk_bf16_f32 v66, v66, v66
    v_and_b32 v66, 0xffff0000, v66
    v_mul_f32 v66, v66, v130
    v_cvt_pk_bf16_f32 v66, v66, v66
    v_and_b32 v66, 0xffff0000, v66
    v_cvt_pk_bf16_f32 v67, v67, v67
    v_and_b32 v67, 0xffff0000, v67
    v_mul_f32 v67, v67, v131
    v_cvt_pk_bf16_f32 v67, v67, v67
    v_and_b32 v67, 0xffff0000, v67
    v_cvt_pk_bf16_f32 v68, v68, v68
    v_and_b32 v68, 0xffff0000, v68
    v_mul_f32 v68, v68, v132
    v_cvt_pk_bf16_f32 v68, v68, v68
    v_and_b32 v68, 0xffff0000, v68
    v_cvt_pk_bf16_f32 v69, v69, v69
    v_and_b32 v69, 0xffff0000, v69
    v_mul_f32 v69, v69, v133
    v_cvt_pk_bf16_f32 v69, v69, v69
    v_and_b32 v69, 0xffff0000, v69
    v_cvt_pk_bf16_f32 v70, v70, v70
    v_and_b32 v70, 0xffff0000, v70
    v_mul_f32 v70, v70, v134
    v_cvt_pk_bf16_f32 v70, v70, v70
    v_and_b32 v70, 0xffff0000, v70
    v_cvt_pk_bf16_f32 v71, v71, v71
    v_and_b32 v71, 0xffff0000, v71
    v_mul_f32 v71, v71, v135
    v_cvt_pk_bf16_f32 v71, v71, v71
    v_and_b32 v71, 0xffff0000, v71
    v_lshlrev_b32 v76, 16, v136
    v_and_b32 v77, 0xffff0000, v136
    v_lshlrev_b32 v78, 16, v137
    v_and_b32 v79, 0xffff0000, v137
    v_lshlrev_b32 v80, 16, v138
    v_and_b32 v81, 0xffff0000, v138
    v_lshlrev_b32 v82, 16, v139
    v_and_b32 v83, 0xffff0000, v139
    v_add_f32 v64, v64, v76
    v_add_f32 v65, v65, v77
    v_add_f32 v66, v66, v78
    v_add_f32 v67, v67, v79
    v_add_f32 v68, v68, v80
    v_add_f32 v69, v69, v81
    v_add_f32 v70, v70, v82
    v_add_f32 v71, v71, v83
    v_cvt_pk_bf16_f32 v72, v64, v65
    v_cvt_pk_bf16_f32 v73, v66, v67
    v_cvt_pk_bf16_f32 v74, v68, v69
    v_cvt_pk_bf16_f32 v75, v70, v71
    s_nop 0
    v_permlane16_swap_b32 v72, v74
    v_permlane16_swap_b32 v73, v75
    s_mov_b32 s12, 0
    buffer_store_dwordx4 v[72:75], v144, s[64:67], s12 offen
    v_accvgpr_read_b32 v88, a4
    v_accvgpr_read_b32 v89, a5
    v_accvgpr_read_b32 v90, a6
    v_accvgpr_read_b32 v91, a7
    v_accvgpr_read_b32 v92, a12
    v_accvgpr_read_b32 v93, a13
    v_accvgpr_read_b32 v94, a14
    v_accvgpr_read_b32 v95, a15
    v_cvt_pk_bf16_f32 v88, v88, v88
    v_and_b32 v88, 0xffff0000, v88
    v_mul_f32 v88, v88, v128
    v_cvt_pk_bf16_f32 v88, v88, v88
    v_and_b32 v88, 0xffff0000, v88
    v_cvt_pk_bf16_f32 v89, v89, v89
    v_and_b32 v89, 0xffff0000, v89
    v_mul_f32 v89, v89, v129
    v_cvt_pk_bf16_f32 v89, v89, v89
    v_and_b32 v89, 0xffff0000, v89
    v_cvt_pk_bf16_f32 v90, v90, v90
    v_and_b32 v90, 0xffff0000, v90
    v_mul_f32 v90, v90, v130
    v_cvt_pk_bf16_f32 v90, v90, v90
    v_and_b32 v90, 0xffff0000, v90
    v_cvt_pk_bf16_f32 v91, v91, v91
    v_and_b32 v91, 0xffff0000, v91
    v_mul_f32 v91, v91, v131
    v_cvt_pk_bf16_f32 v91, v91, v91
    v_and_b32 v91, 0xffff0000, v91
    v_cvt_pk_bf16_f32 v92, v92, v92
    v_and_b32 v92, 0xffff0000, v92
    v_mul_f32 v92, v92, v132
    v_cvt_pk_bf16_f32 v92, v92, v92
    v_and_b32 v92, 0xffff0000, v92
    v_cvt_pk_bf16_f32 v93, v93, v93
    v_and_b32 v93, 0xffff0000, v93
    v_mul_f32 v93, v93, v133
    v_cvt_pk_bf16_f32 v93, v93, v93
    v_and_b32 v93, 0xffff0000, v93
    v_cvt_pk_bf16_f32 v94, v94, v94
    v_and_b32 v94, 0xffff0000, v94
    v_mul_f32 v94, v94, v134
    v_cvt_pk_bf16_f32 v94, v94, v94
    v_and_b32 v94, 0xffff0000, v94
    v_cvt_pk_bf16_f32 v95, v95, v95
    v_and_b32 v95, 0xffff0000, v95
    v_mul_f32 v95, v95, v135
    v_cvt_pk_bf16_f32 v95, v95, v95
    v_and_b32 v95, 0xffff0000, v95
    v_lshlrev_b32 v100, 16, v140
    v_and_b32 v101, 0xffff0000, v140
    v_lshlrev_b32 v102, 16, v141
    v_and_b32 v103, 0xffff0000, v141
    v_lshlrev_b32 v104, 16, v142
    v_and_b32 v105, 0xffff0000, v142
    v_lshlrev_b32 v106, 16, v143
    v_and_b32 v107, 0xffff0000, v143
    v_add_f32 v88, v88, v100
    v_add_f32 v89, v89, v101
    v_add_f32 v90, v90, v102
    v_add_f32 v91, v91, v103
    v_add_f32 v92, v92, v104
    v_add_f32 v93, v93, v105
    v_add_f32 v94, v94, v106
    v_add_f32 v95, v95, v107
    v_cvt_pk_bf16_f32 v96, v88, v89
    v_cvt_pk_bf16_f32 v97, v90, v91
    v_cvt_pk_bf16_f32 v98, v92, v93
    v_cvt_pk_bf16_f32 v99, v94, v95
    s_nop 0
    v_permlane16_swap_b32 v96, v98
    v_permlane16_swap_b32 v97, v99
    s_mov_b32 s12, 32768
    buffer_store_dwordx4 v[96:99], v144, s[64:67], s12 offen
    s_waitcnt vmcnt(0)
down_kernel_end:
    s_endpgm
.section .rodata,"a"
.p2align 6
.amdhsa_kernel mod_kernel
  .amdhsa_next_free_vgpr 128
  .amdhsa_next_free_sgpr 96
  .amdhsa_accum_offset 128
  .amdhsa_group_segment_fixed_size 0
  .amdhsa_kernarg_size 96
  .amdhsa_user_sgpr_count 2
  .amdhsa_user_sgpr_kernarg_segment_ptr 1
  .amdhsa_system_sgpr_workgroup_id_x 1
  .amdhsa_float_denorm_mode_32 3
  .amdhsa_float_denorm_mode_16_64 3
.end_amdhsa_kernel
.p2align 6
.amdhsa_kernel ln1_kernel
  .amdhsa_next_free_vgpr 96
  .amdhsa_next_free_sgpr 96
  .amdhsa_accum_offset 96
  .amdhsa_group_segment_fixed_size 0
  .amdhsa_kernarg_size 96
  .amdhsa_user_sgpr_count 2
  .amdhsa_user_sgpr_kernarg_segment_ptr 1
  .amdhsa_system_sgpr_workgroup_id_x 1
  .amdhsa_float_denorm_mode_32 3
  .amdhsa_float_denorm_mode_16_64 3
.end_amdhsa_kernel
.p2align 6
.amdhsa_kernel qkv_kernel
  .amdhsa_next_free_vgpr 240
  .amdhsa_next_free_sgpr 96
  .amdhsa_accum_offset 192
  .amdhsa_group_segment_fixed_size 0
  .amdhsa_kernarg_size 96
  .amdhsa_user_sgpr_count 2
  .amdhsa_user_sgpr_kernarg_segment_ptr 1
  .amdhsa_system_sgpr_workgroup_id_x 1
  .amdhsa_float_denorm_mode_32 3
  .amdhsa_float_denorm_mode_16_64 3
.end_amdhsa_kernel
.p2align 6
.amdhsa_kernel attn_kernel
  .amdhsa_next_free_vgpr 220
  .amdhsa_next_free_sgpr 96
  .amdhsa_accum_offset 220
  .amdhsa_group_segment_fixed_size 0
  .amdhsa_kernarg_size 96
  .amdhsa_user_sgpr_count 2
  .amdhsa_user_sgpr_kernarg_segment_ptr 1
  .amdhsa_system_sgpr_workgroup_id_x 1
  .amdhsa_float_denorm_mode_32 3
  .amdhsa_float_denorm_mode_16_64 3
.end_amdhsa_kernel
.p2align 6
.amdhsa_kernel wo_kernel
  .amdhsa_next_free_vgpr 164
  .amdhsa_next_free_sgpr 96
  .amdhsa_accum_offset 148
  .amdhsa_group_segment_fixed_size 0
  .amdhsa_kernarg_size 96
  .amdhsa_user_sgpr_count 2
  .amdhsa_user_sgpr_kernarg_segment_ptr 1
  .amdhsa_system_sgpr_workgroup_id_x 1
  .amdhsa_float_denorm_mode_32 3
  .amdhsa_float_denorm_mode_16_64 3
.end_amdhsa_kernel
.p2align 6
.amdhsa_kernel ln2_kernel
  .amdhsa_next_free_vgpr 96
  .amdhsa_next_free_sgpr 96
  .amdhsa_accum_offset 96
  .amdhsa_group_segment_fixed_size 0
  .amdhsa_kernarg_size 96
  .amdhsa_user_sgpr_count 2
  .amdhsa_user_sgpr_kernarg_segment_ptr 1
  .amdhsa_system_sgpr_workgroup_id_x 1
  .amdhsa_float_denorm_mode_32 3
  .amdhsa_float_denorm_mode_16_64 3
.end_amdhsa_kernel
.p2align 6
.amdhsa_kernel gateup_kernel
  .amdhsa_next_free_vgpr 248
  .amdhsa_next_free_sgpr 96
  .amdhsa_accum_offset 136
  .amdhsa_group_segment_fixed_size 0
  .amdhsa_kernarg_size 96
  .amdhsa_user_sgpr_count 2
  .amdhsa_user_sgpr_kernarg_segment_ptr 1
  .amdhsa_system_sgpr_workgroup_id_x 1
  .amdhsa_float_denorm_mode_32 3
  .amdhsa_float_denorm_mode_16_64 3
.end_amdhsa_kernel
.p2align 6
.amdhsa_kernel down_kernel
  .amdhsa_next_free_vgpr 164
  .amdhsa_next_free_sgpr 96
  .amdhsa_accum_offset 148
  .amdhsa_group_segment_fixed_size 0
  .amdhsa_kernarg_size 96
  .amdhsa_user_sgpr_count 2
  .amdhsa_user_sgpr_kernarg_segment_ptr 1
  .amdhsa_system_sgpr_workgroup_id_x 1
  .amdhsa_float_denorm_mode_32 3
  .amdhsa_float_denorm_mode_16_64 3
.end_amdhsa_kernel
```
